```python
import torch

def _softmax(x, axis=-1):
    return torch.softmax(x, dim=axis)

def _gelu(x):
    return torch.nn.functional.gelu(x, approximate='tanh')

def _silu(x):
    return torch.nn.functional.silu(x)

def _sigmoid(x):
    return torch.sigmoid(x)

def _layernorm(x, axis=-1, eps=1e-05):
    m = x.mean(dim=axis, keepdim=True)
    v = x.var(dim=axis, keepdim=True, unbiased=False)
    return (x - m) / torch.sqrt(v + eps)

def _scatter_add(tgt, idx, src, axis=0):
    return tgt.clone().index_add_(axis, idx, src)

def _segment_sum(src, seg, n):
    out = torch.zeros((n,) + src.shape[1:], dtype=src.dtype)
    return out.index_add_(0, seg, src)

def _pad(x, pw):
    flat = tuple((v for pair in reversed(pw) for v in pair))
    return torch.nn.functional.pad(x, flat)
kernel_name = 'standalone__varlen_attn_packed__ragged'

def setup_inputs():

    _w = lambda a: (lambda t: t.to(torch.bfloat16) if t.is_floating_point() else t)(torch.as_tensor(a))
    cu = torch.tensor([0, 828, 1660, 3299, 3744], dtype=torch.int64)
    T, H, D = (int(cu[-1]), 16, 128)
    return {'q': _w((lambda *s: torch.randn(*s, dtype=torch.bfloat16) * 0.8)(T, H, D)), 'k': _w((lambda *s: torch.randn(*s, dtype=torch.bfloat16) * 0.8)(T, H, D)), 'v': _w((lambda *s: torch.randn(*s, dtype=torch.bfloat16) * 0.05)(T, H, D)), 'cu': _w(cu)}

def reference(q, k, v, cu):
    T, H, D = q.shape
    out = torch.zeros_like(q)
    scale = D ** (-0.5)
    outs = []
    for i in range(len(cu) - 1):
        s, e = (int(cu[i]), int(cu[i + 1]))
        qi, ki, vi = (q[s:e].clone(), k[s:e].clone(), v[s:e].clone())
        p = _softmax(torch.einsum('qhd,khd->hqk', qi, ki) * scale, axis=-1)
        outs.append(torch.einsum('hqk,khd->qhd', p, vi))
    return torch.concatenate(outs, axis=0)
```

```asm
; @launch grid=(256,1,1) block=(256,1,1) lds=163840
.amdgcn_target "amdgcn-amd-amdhsa--gfx950"
.text
.globl standalone__varlen_attn_packed__ragged_kernel
.p2align 8
.type standalone__varlen_attn_packed__ragged_kernel,@function
standalone__varlen_attn_packed__ragged_kernel:
    s_cmp_ge_u32 s2, 256
    s_cbranch_scc1 L_end
    s_load_dwordx8 s[64:71], s[0:1], 0
    s_load_dwordx4 s[72:75], s[0:1], 32
    s_load_dwordx2 s[76:77], s[0:1], 48
    s_getpc_b64 s[78:79]
L_pc0:
    v_lshlrev_b32 v2, 7, v0
    v_min_u32 v3, L_codeend-L_pc0-4, v2
    global_load_dword v252, v3, s[78:79]
    v_add_u32 v2, 0x8000, v2
    v_min_u32 v2, L_codeend-L_pc0-4, v2
    global_load_dword v252, v2, s[78:79]
    v_lshrrev_b32 v1, 6, v0
    s_getpc_b64 s[62:63]
    s_add_u32 s62, s62, L_table@rel32@lo+4
    s_addc_u32 s63, s63, L_table@rel32@hi+12
    v_readfirstlane_b32 s28, v1
    v_and_b32 v0, 63, v0
    s_lshl_b32 s29, s2, 8
    s_lshr_b32 s48, s28, 1
    s_lshl_b32 s48, s48, 5
    s_add_u32 s29, s29, s48
    s_load_dwordx8 s[32:39], s[62:63], s29
    s_mov_b32 s44, 0x4b800000
    s_mov_b32 s46, 0x3e0293ee
    s_mov_b32 s47, 0x3e0293ee
    v_and_b32 v1, 31, v0
    v_lshrrev_b32 v2, 5, v0
    v_lshrrev_b32 v3, 4, v0
    v_and_b32 v4, 15, v0
    v_lshlrev_b32 v180, 12, v1
    v_lshl_add_u32 v180, v2, 4, v180
    v_lshlrev_b32 v181, 4, v0
    v_lshlrev_b32 v186, 2, v2
    v_lshrrev_b32 v5, 2, v0
    v_and_b32 v6, 3, v0
    v_lshlrev_b32 v5, 12, v5
    v_lshl_add_u32 v250, v6, 6, v5
    v_add_u32 v5, 0, v3
    v_xor_b32 v6, v4, v5
    v_lshlrev_b32 v7, 12, v5
    v_lshl_add_u32 v172, v6, 4, v7
    v_lshlrev_b32 v6, 2, v3
    v_xor_b32 v6, v4, v6
    v_lshl_add_u32 v176, v6, 4, v7
    v_add_u32 v5, 4, v3
    v_xor_b32 v6, v4, v5
    v_lshlrev_b32 v7, 12, v5
    v_lshl_add_u32 v173, v6, 4, v7
    v_lshlrev_b32 v6, 2, v3
    v_xor_b32 v6, v4, v6
    v_lshl_add_u32 v177, v6, 4, v7
    v_subrev_u32 v173, 1024, v173
    v_subrev_u32 v177, 1024, v177
    v_add_u32 v5, 8, v3
    v_xor_b32 v6, v4, v5
    v_lshlrev_b32 v7, 12, v5
    v_lshl_add_u32 v174, v6, 4, v7
    v_lshlrev_b32 v6, 2, v3
    v_xor_b32 v6, v4, v6
    v_lshl_add_u32 v178, v6, 4, v7
    v_subrev_u32 v174, 2048, v174
    v_subrev_u32 v178, 2048, v178
    v_add_u32 v5, 12, v3
    v_xor_b32 v6, v4, v5
    v_lshlrev_b32 v7, 12, v5
    v_lshl_add_u32 v175, v6, 4, v7
    v_lshlrev_b32 v6, 2, v3
    v_xor_b32 v6, v4, v6
    v_lshl_add_u32 v179, v6, 4, v7
    v_subrev_u32 v175, 3072, v175
    v_subrev_u32 v179, 3072, v179
    s_waitcnt lgkmcnt(0)
    s_mov_b32 s4, s64
    s_and_b32 s5, s65, 0xffff
    s_mov_b32 s6, 0
    s_mov_b32 s7, 0x00020000
    s_mov_b32 s8, s66
    s_and_b32 s9, s67, 0xffff
    s_mov_b32 s10, 0
    s_mov_b32 s11, 0x00020000
    s_mov_b32 s12, s68
    s_and_b32 s13, s69, 0xffff
    s_mov_b32 s14, 0
    s_mov_b32 s15, 0x00020000
    s_mov_b32 s16, s72
    s_and_b32 s17, s73, 0xffff
    s_mov_b32 s18, 0
    s_mov_b32 s19, 0x00020000
    s_mov_b32 s20, s76
    s_and_b32 s21, s77, 0xffff
    s_mov_b32 s22, 268435456
    s_mov_b32 s23, 0x00020000
    s_mov_b32 s24, s74
    s_and_b32 s25, s75, 0xffff
    s_mov_b32 s26, 256
    s_mov_b32 s27, 0x00020000
    s_mov_b32 s31, 0x8000000
    s_mov_b32 s87, 0
    s_mov_b32 s82, 0
    s_mov_b32 s81, 0
    v_mov_b32 v253, 0
    s_mov_b32 s80, 0
    s_call_b64 s[60:61], L_setup
    s_branch L_seg
L_setup:
L_su_fin:
    s_cmp_eq_u32 s82, 4
    s_cbranch_scc0 L_su_go
    s_call_b64 s[72:73], L_event
    s_branch L_su_fin
L_su_go:
    s_mov_b32 s6, s33
    s_mov_b32 s10, s33
    s_mov_b32 s14, s33
    s_and_b32 s48, s28, 1
    s_cmp_eq_u32 s48, 1
    s_cselect_b32 s55, s38, s37
    s_lshl_b32 s49, s48, 18
    s_add_u32 s32, s32, s49
    s_and_b32 s42, s36, 0xff
    s_bfe_u32 s54, s36, 0x80008
    s_bfe_u32 s52, s36, 0x80010
    s_lshr_b32 s53, s36, 24
    s_sub_u32 s53, s53, s52
    s_lshl_b32 s49, s28, 4
    s_lshl_b32 s56, s48, 5
    s_lshr_b32 s57, s28, 1
    s_lshl_b32 s57, s57, 16
    s_cmp_eq_u32 s54, 0
    s_cselect_b32 s49, s49, s56
    s_cselect_b32 s51, 0, s57
    s_lshl_b32 s50, s49, 12
    s_lshl_b32 s43, s49, 8
    s_add_u32 s43, s43, s51
    s_lshl_b32 s49, s28, 14
    s_add_u32 s49, s49, 65536
    s_lshr_b32 s56, s51, 2
    s_add_u32 s56, s56, 131072
    s_add_u32 s57, s51, 49152
    s_cmp_eq_u32 s48, 1
    s_cselect_b32 s56, s56, s57
    s_cmp_eq_u32 s54, 0
    s_cselect_b32 s86, s49, s56
    s_add_u32 s34, s34, s50
    s_add_u32 s41, s35, s50
    s_add_u32 s40, s41, 262144
    s_sub_u32 s45, s35, 262144
    s_cmp_eq_u32 s87, 0
    s_cbranch_scc1 L_set_ret
    s_add_u32 m0, s43, 0
    s_nop 0
    buffer_load_dwordx4 v172, s[8:11], s34 offen offset:0 lds
    buffer_load_dwordx4 v173, s[8:11], s34 offen offset:1024 lds
    buffer_load_dwordx4 v174, s[8:11], s34 offen offset:2048 lds
    buffer_load_dwordx4 v175, s[8:11], s34 offen offset:3072 lds
L_set_ret:
    s_setpc_b64 s[60:61]
L_seg:
    s_mov_b32 s18, s33
    s_add_u32 s29, s29, 64
    s_load_dwordx8 s[64:71], s[62:63], s29
    s_barrier
    s_cmp_eq_u32 s87, 0
    s_cbranch_scc0 L_qpf
    s_mov_b32 s84, s32
    s_mov_b32 s85, s86
    s_mov_b32 s83, 4
    s_mov_b32 s82, 4
    s_call_b64 s[72:73], L_event
    s_call_b64 s[72:73], L_event
L_qpf:
    v_lshrrev_b32 v0, 4, v181
    v_and_b32 v1, 31, v0
    v_lshrrev_b32 v2, 5, v0
    v_and_b32 v4, 15, v0
    v_lshlrev_b32 v5, 8, v1
    v_add_u32 v5, s51, v5
    v_add_u32 v6, 0, v2
    v_xor_b32 v6, v6, v4
    v_lshl_add_u32 v160, v6, 4, v5
    v_add_u32 v6, 2, v2
    v_xor_b32 v6, v6, v4
    v_lshl_add_u32 v161, v6, 4, v5
    v_add_u32 v6, 4, v2
    v_xor_b32 v6, v6, v4
    v_lshl_add_u32 v162, v6, 4, v5
    v_add_u32 v6, 6, v2
    v_xor_b32 v6, v6, v4
    v_lshl_add_u32 v163, v6, 4, v5
    v_add_u32 v6, 8, v2
    v_xor_b32 v6, v6, v4
    v_lshl_add_u32 v164, v6, 4, v5
    v_add_u32 v6, 10, v2
    v_xor_b32 v6, v6, v4
    v_lshl_add_u32 v165, v6, 4, v5
    v_add_u32 v6, 12, v2
    v_xor_b32 v6, v6, v4
    v_lshl_add_u32 v166, v6, 4, v5
    v_add_u32 v6, 14, v2
    v_xor_b32 v6, v6, v4
    v_lshl_add_u32 v167, v6, 4, v5
    v_lshrrev_b32 v3, 2, v4
    v_lshl_add_u32 v5, v2, 2, v3
    v_lshlrev_b32 v5, 8, v5
    v_add_u32 v5, s51, v5
    v_and_b32 v6, 1, v0
    v_lshl_add_u32 v5, v6, 3, v5
    v_bfe_u32 v6, v0, 1, 1
    v_bfe_u32 v7, v0, 4, 1
    v_lshl_add_u32 v6, v7, 1, v6
    v_lshl_add_u32 v5, v6, 4, v5
    v_xor_b32 v6, 0, v3
    v_lshl_add_u32 v168, v6, 6, v5
    v_xor_b32 v6, 1, v3
    v_lshl_add_u32 v169, v6, 6, v5
    v_xor_b32 v6, 2, v3
    v_lshl_add_u32 v170, v6, 6, v5
    v_xor_b32 v6, 3, v3
    v_lshl_add_u32 v171, v6, 6, v5
    v_mov_b32 v8, 0
    v_mov_b32 v9, 0
    v_mov_b32 v10, 0
    v_mov_b32 v11, 0
    v_mov_b32 v182, 0
    v_mov_b32 v183, 0
    s_lshr_b32 s56, s55, 6
    v_mov_b32 v253, s56
    v_mov_b32 v187, 0
    s_sub_u32 s56, s86, s51
    v_add_u32 v136, s56, v160
    v_add_u32 v137, s56, v161
    v_add_u32 v138, s56, v162
    v_add_u32 v139, s56, v163
    v_add_u32 v140, s56, v164
    v_add_u32 v141, s56, v165
    v_add_u32 v142, s56, v166
    v_add_u32 v143, s56, v167
    v_mfma_f32_32x32x16_bf16 a[0:15], v[8:11], v[8:11], 0
    v_mfma_f32_32x32x16_bf16 a[16:31], v[8:11], v[8:11], 0
    v_mfma_f32_32x32x16_bf16 a[32:47], v[8:11], v[8:11], 0
    v_mfma_f32_32x32x16_bf16 a[48:63], v[8:11], v[8:11], 0
    v_mfma_f32_32x32x16_bf16 a[64:79], v[8:11], v[8:11], 0
    v_mfma_f32_32x32x16_bf16 a[80:95], v[8:11], v[8:11], 0
    v_mfma_f32_32x32x16_bf16 a[96:111], v[8:11], v[8:11], 0
    v_mfma_f32_32x32x16_bf16 a[112:127], v[8:11], v[8:11], 0
    s_cmp_eq_u32 s87, 0
    s_cbranch_scc0 L_k0J
    s_call_b64 s[72:73], L_event
    s_call_b64 s[72:73], L_event
    s_cmp_eq_u32 s54, 0
    s_cbranch_scc0 L_k0B
    s_add_u32 m0, s43, 0
    s_nop 0
    buffer_load_dwordx4 v172, s[8:11], s34 offen offset:0 lds
    buffer_load_dwordx4 v173, s[8:11], s34 offen offset:1024 lds
    buffer_load_dwordx4 v174, s[8:11], s34 offen offset:2048 lds
    buffer_load_dwordx4 v175, s[8:11], s34 offen offset:3072 lds
    s_branch L_k0J
L_k0B:
    s_add_u32 m0, s43, 0
    s_nop 0
    buffer_load_dwordx4 v172, s[8:11], s34 offen offset:0 lds
    buffer_load_dwordx4 v173, s[8:11], s34 offen offset:1024 lds
    buffer_load_dwordx4 v174, s[8:11], s34 offen offset:2048 lds
    buffer_load_dwordx4 v175, s[8:11], s34 offen offset:3072 lds
    s_add_u32 s49, s34, 65536
    s_add_u32 m0, s43, 4096
    s_nop 0
    buffer_load_dwordx4 v172, s[8:11], s49 offen offset:0 lds
    buffer_load_dwordx4 v173, s[8:11], s49 offen offset:1024 lds
    buffer_load_dwordx4 v174, s[8:11], s49 offen offset:2048 lds
    buffer_load_dwordx4 v175, s[8:11], s49 offen offset:3072 lds
L_k0J:
    s_cmp_eq_u32 s87, 0
    s_cbranch_scc0 L_wq0p
    s_cmp_eq_u32 s54, 0
    s_cbranch_scc0 L_wq0b
    s_waitcnt vmcnt(12)
    s_branch L_wq0j
L_wq0b:
    s_waitcnt vmcnt(16)
    s_branch L_wq0j
L_wq0p:
L_wq0j:
    ds_read_b128 v[96:99], v136 offset:0
    ds_read_b128 v[100:103], v137 offset:0
    ds_read_b128 v[104:107], v138 offset:0
    ds_read_b128 v[108:111], v139 offset:0
    ds_read_b128 v[112:115], v140 offset:0
    ds_read_b128 v[116:119], v141 offset:0
    ds_read_b128 v[120:123], v142 offset:0
    ds_read_b128 v[124:127], v143 offset:0
    s_waitcnt lgkmcnt(7)
    v_lshlrev_b32 v76, 16, v96
    v_and_b32 v77, 0xffff0000, v96
    v_mul_f32 v76, s46, v76
    v_mul_f32 v77, s46, v77
    v_cvt_pk_bf16_f32 v64, v76, v77
    v_lshlrev_b32 v78, 16, v97
    v_and_b32 v79, 0xffff0000, v97
    v_mul_f32 v78, s46, v78
    v_mul_f32 v79, s46, v79
    v_cvt_pk_bf16_f32 v65, v78, v79
    v_lshlrev_b32 v80, 16, v98
    v_and_b32 v81, 0xffff0000, v98
    v_mul_f32 v80, s46, v80
    v_mul_f32 v81, s46, v81
    v_cvt_pk_bf16_f32 v66, v80, v81
    v_lshlrev_b32 v82, 16, v99
    v_and_b32 v83, 0xffff0000, v99
    v_mul_f32 v82, s46, v82
    v_mul_f32 v83, s46, v83
    v_cvt_pk_bf16_f32 v67, v82, v83
    v_accvgpr_write_b32 a128, v64
    v_accvgpr_write_b32 a129, v65
    v_accvgpr_write_b32 a130, v66
    v_accvgpr_write_b32 a131, v67
    s_waitcnt lgkmcnt(6)
    v_lshlrev_b32 v84, 16, v100
    v_and_b32 v85, 0xffff0000, v100
    v_mul_f32 v84, s46, v84
    v_mul_f32 v85, s46, v85
    v_cvt_pk_bf16_f32 v68, v84, v85
    v_lshlrev_b32 v86, 16, v101
    v_and_b32 v87, 0xffff0000, v101
    v_mul_f32 v86, s46, v86
    v_mul_f32 v87, s46, v87
    v_cvt_pk_bf16_f32 v69, v86, v87
    v_lshlrev_b32 v88, 16, v102
    v_and_b32 v89, 0xffff0000, v102
    v_mul_f32 v88, s46, v88
    v_mul_f32 v89, s46, v89
    v_cvt_pk_bf16_f32 v70, v88, v89
    v_lshlrev_b32 v90, 16, v103
    v_and_b32 v91, 0xffff0000, v103
    v_mul_f32 v90, s46, v90
    v_mul_f32 v91, s46, v91
    v_cvt_pk_bf16_f32 v71, v90, v91
    v_accvgpr_write_b32 a132, v68
    v_accvgpr_write_b32 a133, v69
    v_accvgpr_write_b32 a134, v70
    v_accvgpr_write_b32 a135, v71
    s_waitcnt lgkmcnt(5)
    v_lshlrev_b32 v76, 16, v104
    v_and_b32 v77, 0xffff0000, v104
    v_mul_f32 v76, s46, v76
    v_mul_f32 v77, s46, v77
    v_cvt_pk_bf16_f32 v72, v76, v77
    v_lshlrev_b32 v78, 16, v105
    v_and_b32 v79, 0xffff0000, v105
    v_mul_f32 v78, s46, v78
    v_mul_f32 v79, s46, v79
    v_cvt_pk_bf16_f32 v73, v78, v79
    v_lshlrev_b32 v80, 16, v106
    v_and_b32 v81, 0xffff0000, v106
    v_mul_f32 v80, s46, v80
    v_mul_f32 v81, s46, v81
    v_cvt_pk_bf16_f32 v74, v80, v81
    v_lshlrev_b32 v82, 16, v107
    v_and_b32 v83, 0xffff0000, v107
    v_mul_f32 v82, s46, v82
    v_mul_f32 v83, s46, v83
    v_cvt_pk_bf16_f32 v75, v82, v83
    v_accvgpr_write_b32 a136, v72
    v_accvgpr_write_b32 a137, v73
    v_accvgpr_write_b32 a138, v74
    v_accvgpr_write_b32 a139, v75
    s_waitcnt lgkmcnt(4)
    v_lshlrev_b32 v84, 16, v108
    v_and_b32 v85, 0xffff0000, v108
    v_mul_f32 v84, s46, v84
    v_mul_f32 v85, s46, v85
    v_cvt_pk_bf16_f32 v64, v84, v85
    v_lshlrev_b32 v86, 16, v109
    v_and_b32 v87, 0xffff0000, v109
    v_mul_f32 v86, s46, v86
    v_mul_f32 v87, s46, v87
    v_cvt_pk_bf16_f32 v65, v86, v87
    v_lshlrev_b32 v88, 16, v110
    v_and_b32 v89, 0xffff0000, v110
    v_mul_f32 v88, s46, v88
    v_mul_f32 v89, s46, v89
    v_cvt_pk_bf16_f32 v66, v88, v89
    v_lshlrev_b32 v90, 16, v111
    v_and_b32 v91, 0xffff0000, v111
    v_mul_f32 v90, s46, v90
    v_mul_f32 v91, s46, v91
    v_cvt_pk_bf16_f32 v67, v90, v91
    v_accvgpr_write_b32 a140, v64
    v_accvgpr_write_b32 a141, v65
    v_accvgpr_write_b32 a142, v66
    v_accvgpr_write_b32 a143, v67
    s_waitcnt lgkmcnt(3)
    v_lshlrev_b32 v76, 16, v112
    v_and_b32 v77, 0xffff0000, v112
    v_mul_f32 v76, s46, v76
    v_mul_f32 v77, s46, v77
    v_cvt_pk_bf16_f32 v68, v76, v77
    v_lshlrev_b32 v78, 16, v113
    v_and_b32 v79, 0xffff0000, v113
    v_mul_f32 v78, s46, v78
    v_mul_f32 v79, s46, v79
    v_cvt_pk_bf16_f32 v69, v78, v79
    v_lshlrev_b32 v80, 16, v114
    v_and_b32 v81, 0xffff0000, v114
    v_mul_f32 v80, s46, v80
    v_mul_f32 v81, s46, v81
    v_cvt_pk_bf16_f32 v70, v80, v81
    v_lshlrev_b32 v82, 16, v115
    v_and_b32 v83, 0xffff0000, v115
    v_mul_f32 v82, s46, v82
    v_mul_f32 v83, s46, v83
    v_cvt_pk_bf16_f32 v71, v82, v83
    v_accvgpr_write_b32 a144, v68
    v_accvgpr_write_b32 a145, v69
    v_accvgpr_write_b32 a146, v70
    v_accvgpr_write_b32 a147, v71
    s_waitcnt lgkmcnt(2)
    v_lshlrev_b32 v84, 16, v116
    v_and_b32 v85, 0xffff0000, v116
    v_mul_f32 v84, s46, v84
    v_mul_f32 v85, s46, v85
    v_cvt_pk_bf16_f32 v72, v84, v85
    v_lshlrev_b32 v86, 16, v117
    v_and_b32 v87, 0xffff0000, v117
    v_mul_f32 v86, s46, v86
    v_mul_f32 v87, s46, v87
    v_cvt_pk_bf16_f32 v73, v86, v87
    v_lshlrev_b32 v88, 16, v118
    v_and_b32 v89, 0xffff0000, v118
    v_mul_f32 v88, s46, v88
    v_mul_f32 v89, s46, v89
    v_cvt_pk_bf16_f32 v74, v88, v89
    v_lshlrev_b32 v90, 16, v119
    v_and_b32 v91, 0xffff0000, v119
    v_mul_f32 v90, s46, v90
    v_mul_f32 v91, s46, v91
    v_cvt_pk_bf16_f32 v75, v90, v91
    v_accvgpr_write_b32 a148, v72
    v_accvgpr_write_b32 a149, v73
    v_accvgpr_write_b32 a150, v74
    v_accvgpr_write_b32 a151, v75
    s_waitcnt lgkmcnt(1)
    v_lshlrev_b32 v76, 16, v120
    v_and_b32 v77, 0xffff0000, v120
    v_mul_f32 v76, s46, v76
    v_mul_f32 v77, s46, v77
    v_cvt_pk_bf16_f32 v64, v76, v77
    v_lshlrev_b32 v78, 16, v121
    v_and_b32 v79, 0xffff0000, v121
    v_mul_f32 v78, s46, v78
    v_mul_f32 v79, s46, v79
    v_cvt_pk_bf16_f32 v65, v78, v79
    v_lshlrev_b32 v80, 16, v122
    v_and_b32 v81, 0xffff0000, v122
    v_mul_f32 v80, s46, v80
    v_mul_f32 v81, s46, v81
    v_cvt_pk_bf16_f32 v66, v80, v81
    v_lshlrev_b32 v82, 16, v123
    v_and_b32 v83, 0xffff0000, v123
    v_mul_f32 v82, s46, v82
    v_mul_f32 v83, s46, v83
    v_cvt_pk_bf16_f32 v67, v82, v83
    v_accvgpr_write_b32 a152, v64
    v_accvgpr_write_b32 a153, v65
    v_accvgpr_write_b32 a154, v66
    v_accvgpr_write_b32 a155, v67
    s_waitcnt lgkmcnt(0)
    v_lshlrev_b32 v84, 16, v124
    v_and_b32 v85, 0xffff0000, v124
    v_mul_f32 v84, s46, v84
    v_mul_f32 v85, s46, v85
    v_cvt_pk_bf16_f32 v68, v84, v85
    v_lshlrev_b32 v86, 16, v125
    v_and_b32 v87, 0xffff0000, v125
    v_mul_f32 v86, s46, v86
    v_mul_f32 v87, s46, v87
    v_cvt_pk_bf16_f32 v69, v86, v87
    v_lshlrev_b32 v88, 16, v126
    v_and_b32 v89, 0xffff0000, v126
    v_mul_f32 v88, s46, v88
    v_mul_f32 v89, s46, v89
    v_cvt_pk_bf16_f32 v70, v88, v89
    v_lshlrev_b32 v90, 16, v127
    v_and_b32 v91, 0xffff0000, v127
    v_mul_f32 v90, s46, v90
    v_mul_f32 v91, s46, v91
    v_cvt_pk_bf16_f32 v71, v90, v91
    v_accvgpr_write_b32 a156, v68
    v_accvgpr_write_b32 a157, v69
    v_accvgpr_write_b32 a158, v70
    v_accvgpr_write_b32 a159, v71
    s_cmp_eq_u32 s54, 0
    s_cbranch_scc0 L_vB
    s_add_u32 m0, s43, 16384
    s_nop 0
    buffer_load_dwordx4 v172, s[8:11], s41 offen offset:0 lds
    buffer_load_dwordx4 v173, s[8:11], s41 offen offset:1024 lds
    buffer_load_dwordx4 v174, s[8:11], s41 offen offset:2048 lds
    buffer_load_dwordx4 v175, s[8:11], s41 offen offset:3072 lds
    s_add_u32 m0, s43, 32768
    s_nop 0
    buffer_load_dwordx4 v176, s[12:15], s34 offen offset:0 lds
    buffer_load_dwordx4 v177, s[12:15], s34 offen offset:1024 lds
    buffer_load_dwordx4 v178, s[12:15], s34 offen offset:2048 lds
    buffer_load_dwordx4 v179, s[12:15], s34 offen offset:3072 lds
    s_branch L_vJ
L_vB:
    s_add_u32 m0, s43, 16384
    s_nop 0
    buffer_load_dwordx4 v172, s[8:11], s41 offen offset:0 lds
    buffer_load_dwordx4 v173, s[8:11], s41 offen offset:1024 lds
    buffer_load_dwordx4 v174, s[8:11], s41 offen offset:2048 lds
    buffer_load_dwordx4 v175, s[8:11], s41 offen offset:3072 lds
    s_add_u32 s49, s41, 65536
    s_add_u32 m0, s43, 20480
    s_nop 0
    buffer_load_dwordx4 v172, s[8:11], s49 offen offset:0 lds
    buffer_load_dwordx4 v173, s[8:11], s49 offen offset:1024 lds
    buffer_load_dwordx4 v174, s[8:11], s49 offen offset:2048 lds
    buffer_load_dwordx4 v175, s[8:11], s49 offen offset:3072 lds
    s_add_u32 m0, s43, 32768
    s_nop 0
    buffer_load_dwordx4 v176, s[12:15], s34 offen offset:0 lds
    buffer_load_dwordx4 v177, s[12:15], s34 offen offset:1024 lds
    buffer_load_dwordx4 v178, s[12:15], s34 offen offset:2048 lds
    buffer_load_dwordx4 v179, s[12:15], s34 offen offset:3072 lds
    s_add_u32 s49, s34, 65536
    s_add_u32 m0, s43, 36864
    s_nop 0
    buffer_load_dwordx4 v176, s[12:15], s49 offen offset:0 lds
    buffer_load_dwordx4 v177, s[12:15], s49 offen offset:1024 lds
    buffer_load_dwordx4 v178, s[12:15], s49 offen offset:2048 lds
    buffer_load_dwordx4 v179, s[12:15], s49 offen offset:3072 lds
L_vJ:
    s_cmp_eq_u32 s87, 0
    s_cbranch_scc0 L_wk0p
    s_cmp_eq_u32 s54, 0
    s_cbranch_scc0 L_wk0b
    s_waitcnt vmcnt(8)
    s_branch L_wk0j
L_wk0b:
    s_waitcnt vmcnt(16)
    s_branch L_wk0j
L_wk0p:
    s_waitcnt vmcnt(24)
L_wk0j:
    s_barrier
    ds_read_b128 a[192:195], v160 offset:0
    ds_read_b128 a[196:199], v161 offset:0
    ds_read_b128 a[200:203], v162 offset:0
    ds_read_b128 a[204:207], v163 offset:0
    ds_read_b128 a[208:211], v164 offset:0
    ds_read_b128 a[212:215], v165 offset:0
    ds_read_b128 a[216:219], v166 offset:0
    ds_read_b128 a[220:223], v167 offset:0
    ds_read_b128 a[224:227], v160 offset:8192
    ds_read_b128 a[228:231], v161 offset:8192
    ds_read_b128 a[232:235], v162 offset:8192
    ds_read_b128 a[236:239], v163 offset:8192
    ds_read_b128 a[240:243], v164 offset:8192
    ds_read_b128 a[244:247], v165 offset:8192
    ds_read_b128 a[248:251], v166 offset:8192
    ds_read_b128 a[252:255], v167 offset:8192
    ds_read_b128 v[96:99], v136 offset:8192
    ds_read_b128 v[100:103], v137 offset:8192
    ds_read_b128 v[104:107], v138 offset:8192
    ds_read_b128 v[108:111], v139 offset:8192
    ds_read_b128 v[112:115], v140 offset:8192
    ds_read_b128 v[116:119], v141 offset:8192
    ds_read_b128 v[120:123], v142 offset:8192
    ds_read_b128 v[124:127], v143 offset:8192
    s_waitcnt lgkmcnt(7)
    v_mfma_f32_32x32x16_bf16 v[0:15], a[192:195], a[128:131], 0
    v_lshlrev_b32 v76, 16, v96
    v_and_b32 v77, 0xffff0000, v96
    v_mul_f32 v76, s46, v76
    v_mul_f32 v77, s46, v77
    v_cvt_pk_bf16_f32 v72, v76, v77
    v_lshlrev_b32 v78, 16, v97
    v_and_b32 v79, 0xffff0000, v97
    v_mul_f32 v78, s46, v78
    v_mul_f32 v79, s46, v79
    v_cvt_pk_bf16_f32 v73, v78, v79
    v_lshlrev_b32 v80, 16, v98
    v_and_b32 v81, 0xffff0000, v98
    v_mfma_f32_32x32x16_bf16 v[16:31], a[224:227], a[128:131], 0
    v_mul_f32 v80, s46, v80
    v_mul_f32 v81, s46, v81
    v_cvt_pk_bf16_f32 v74, v80, v81
    v_lshlrev_b32 v82, 16, v99
    v_and_b32 v83, 0xffff0000, v99
    v_mul_f32 v82, s46, v82
    v_mul_f32 v83, s46, v83
    v_cvt_pk_bf16_f32 v75, v82, v83
    v_accvgpr_write_b32 a160, v72
    v_accvgpr_write_b32 a161, v73
    v_accvgpr_write_b32 a162, v74
    v_accvgpr_write_b32 a163, v75
    s_waitcnt lgkmcnt(6)
    v_mfma_f32_32x32x16_bf16 v[0:15], a[196:199], a[132:135], v[0:15]
    v_lshlrev_b32 v84, 16, v100
    v_and_b32 v85, 0xffff0000, v100
    v_mul_f32 v84, s46, v84
    v_mul_f32 v85, s46, v85
    v_cvt_pk_bf16_f32 v64, v84, v85
    v_lshlrev_b32 v86, 16, v101
    v_mfma_f32_32x32x16_bf16 v[16:31], a[228:231], a[132:135], v[16:31]
    v_and_b32 v87, 0xffff0000, v101
    v_mul_f32 v86, s46, v86
    v_mul_f32 v87, s46, v87
    v_cvt_pk_bf16_f32 v65, v86, v87
    v_lshlrev_b32 v88, 16, v102
    v_and_b32 v89, 0xffff0000, v102
    v_mfma_f32_32x32x16_bf16 v[32:47], a[192:195], v[72:75], 0
    v_mul_f32 v88, s46, v88
    v_mul_f32 v89, s46, v89
    v_cvt_pk_bf16_f32 v66, v88, v89
    v_lshlrev_b32 v90, 16, v103
    v_and_b32 v91, 0xffff0000, v103
    v_mul_f32 v90, s46, v90
    v_mfma_f32_32x32x16_bf16 v[48:63], a[224:227], v[72:75], 0
    v_mul_f32 v91, s46, v91
    v_cvt_pk_bf16_f32 v67, v90, v91
    v_accvgpr_write_b32 a164, v64
    v_accvgpr_write_b32 a165, v65
    v_accvgpr_write_b32 a166, v66
    v_accvgpr_write_b32 a167, v67
    s_waitcnt lgkmcnt(5)
    v_mfma_f32_32x32x16_bf16 v[0:15], a[200:203], a[136:139], v[0:15]
    v_lshlrev_b32 v76, 16, v104
    v_and_b32 v77, 0xffff0000, v104
    v_mul_f32 v76, s46, v76
    v_mul_f32 v77, s46, v77
    v_cvt_pk_bf16_f32 v68, v76, v77
    v_lshlrev_b32 v78, 16, v105
    v_mfma_f32_32x32x16_bf16 v[16:31], a[232:235], a[136:139], v[16:31]
    v_and_b32 v79, 0xffff0000, v105
    v_mul_f32 v78, s46, v78
    v_mul_f32 v79, s46, v79
    v_cvt_pk_bf16_f32 v69, v78, v79
    v_lshlrev_b32 v80, 16, v106
    v_and_b32 v81, 0xffff0000, v106
    v_mfma_f32_32x32x16_bf16 v[32:47], a[196:199], v[64:67], v[32:47]
    v_mul_f32 v80, s46, v80
    v_mul_f32 v81, s46, v81
    v_cvt_pk_bf16_f32 v70, v80, v81
    v_lshlrev_b32 v82, 16, v107
    v_and_b32 v83, 0xffff0000, v107
    v_mul_f32 v82, s46, v82
    v_mfma_f32_32x32x16_bf16 v[48:63], a[228:231], v[64:67], v[48:63]
    v_mul_f32 v83, s46, v83
    v_cvt_pk_bf16_f32 v71, v82, v83
    v_accvgpr_write_b32 a168, v68
    v_accvgpr_write_b32 a169, v69
    v_accvgpr_write_b32 a170, v70
    v_accvgpr_write_b32 a171, v71
    s_waitcnt lgkmcnt(4)
    v_mfma_f32_32x32x16_bf16 v[0:15], a[204:207], a[140:143], v[0:15]
    v_lshlrev_b32 v84, 16, v108
    v_and_b32 v85, 0xffff0000, v108
    v_mul_f32 v84, s46, v84
    v_mul_f32 v85, s46, v85
    v_cvt_pk_bf16_f32 v72, v84, v85
    v_lshlrev_b32 v86, 16, v109
    v_mfma_f32_32x32x16_bf16 v[16:31], a[236:239], a[140:143], v[16:31]
    v_and_b32 v87, 0xffff0000, v109
    v_mul_f32 v86, s46, v86
    v_mul_f32 v87, s46, v87
    v_cvt_pk_bf16_f32 v73, v86, v87
    v_lshlrev_b32 v88, 16, v110
    v_and_b32 v89, 0xffff0000, v110
    v_mfma_f32_32x32x16_bf16 v[32:47], a[200:203], v[68:71], v[32:47]
    v_mul_f32 v88, s46, v88
    v_mul_f32 v89, s46, v89
    v_cvt_pk_bf16_f32 v74, v88, v89
    v_lshlrev_b32 v90, 16, v111
    v_and_b32 v91, 0xffff0000, v111
    v_mul_f32 v90, s46, v90
    v_mfma_f32_32x32x16_bf16 v[48:63], a[232:235], v[68:71], v[48:63]
    v_mul_f32 v91, s46, v91
    v_cvt_pk_bf16_f32 v75, v90, v91
    v_accvgpr_write_b32 a172, v72
    v_accvgpr_write_b32 a173, v73
    v_accvgpr_write_b32 a174, v74
    v_accvgpr_write_b32 a175, v75
    s_waitcnt lgkmcnt(3)
    v_mfma_f32_32x32x16_bf16 v[0:15], a[208:211], a[144:147], v[0:15]
    v_lshlrev_b32 v76, 16, v112
    v_and_b32 v77, 0xffff0000, v112
    v_mul_f32 v76, s46, v76
    v_mul_f32 v77, s46, v77
    v_cvt_pk_bf16_f32 v64, v76, v77
    v_lshlrev_b32 v78, 16, v113
    v_mfma_f32_32x32x16_bf16 v[16:31], a[240:243], a[144:147], v[16:31]
    v_and_b32 v79, 0xffff0000, v113
    v_mul_f32 v78, s46, v78
    v_mul_f32 v79, s46, v79
    v_cvt_pk_bf16_f32 v65, v78, v79
    v_lshlrev_b32 v80, 16, v114
    v_and_b32 v81, 0xffff0000, v114
    v_mfma_f32_32x32x16_bf16 v[32:47], a[204:207], v[72:75], v[32:47]
    v_mul_f32 v80, s46, v80
    v_mul_f32 v81, s46, v81
    v_cvt_pk_bf16_f32 v66, v80, v81
    v_lshlrev_b32 v82, 16, v115
    v_and_b32 v83, 0xffff0000, v115
    v_mul_f32 v82, s46, v82
    v_mfma_f32_32x32x16_bf16 v[48:63], a[236:239], v[72:75], v[48:63]
    v_mul_f32 v83, s46, v83
    v_cvt_pk_bf16_f32 v67, v82, v83
    v_accvgpr_write_b32 a176, v64
    v_accvgpr_write_b32 a177, v65
    v_accvgpr_write_b32 a178, v66
    v_accvgpr_write_b32 a179, v67
    s_waitcnt lgkmcnt(2)
    v_mfma_f32_32x32x16_bf16 v[0:15], a[212:215], a[148:151], v[0:15]
    v_lshlrev_b32 v84, 16, v116
    v_and_b32 v85, 0xffff0000, v116
    v_mul_f32 v84, s46, v84
    v_mul_f32 v85, s46, v85
    v_cvt_pk_bf16_f32 v68, v84, v85
    v_lshlrev_b32 v86, 16, v117
    v_mfma_f32_32x32x16_bf16 v[16:31], a[244:247], a[148:151], v[16:31]
    v_and_b32 v87, 0xffff0000, v117
    v_mul_f32 v86, s46, v86
    v_mul_f32 v87, s46, v87
    v_cvt_pk_bf16_f32 v69, v86, v87
    v_lshlrev_b32 v88, 16, v118
    v_and_b32 v89, 0xffff0000, v118
    v_mfma_f32_32x32x16_bf16 v[32:47], a[208:211], v[64:67], v[32:47]
    v_mul_f32 v88, s46, v88
    v_mul_f32 v89, s46, v89
    v_cvt_pk_bf16_f32 v70, v88, v89
    v_lshlrev_b32 v90, 16, v119
    v_and_b32 v91, 0xffff0000, v119
    v_mul_f32 v90, s46, v90
    v_mfma_f32_32x32x16_bf16 v[48:63], a[240:243], v[64:67], v[48:63]
    v_mul_f32 v91, s46, v91
    v_cvt_pk_bf16_f32 v71, v90, v91
    v_accvgpr_write_b32 a180, v68
    v_accvgpr_write_b32 a181, v69
    v_accvgpr_write_b32 a182, v70
    v_accvgpr_write_b32 a183, v71
    s_waitcnt lgkmcnt(1)
    v_mfma_f32_32x32x16_bf16 v[0:15], a[216:219], a[152:155], v[0:15]
    v_lshlrev_b32 v76, 16, v120
    v_and_b32 v77, 0xffff0000, v120
    v_mul_f32 v76, s46, v76
    v_mul_f32 v77, s46, v77
    v_cvt_pk_bf16_f32 v72, v76, v77
    v_lshlrev_b32 v78, 16, v121
    v_mfma_f32_32x32x16_bf16 v[16:31], a[248:251], a[152:155], v[16:31]
    v_and_b32 v79, 0xffff0000, v121
    v_mul_f32 v78, s46, v78
    v_mul_f32 v79, s46, v79
    v_cvt_pk_bf16_f32 v73, v78, v79
    v_lshlrev_b32 v80, 16, v122
    v_and_b32 v81, 0xffff0000, v122
    v_mfma_f32_32x32x16_bf16 v[32:47], a[212:215], v[68:71], v[32:47]
    v_mul_f32 v80, s46, v80
    v_mul_f32 v81, s46, v81
    v_cvt_pk_bf16_f32 v74, v80, v81
    v_lshlrev_b32 v82, 16, v123
    v_and_b32 v83, 0xffff0000, v123
    v_mul_f32 v82, s46, v82
    v_mfma_f32_32x32x16_bf16 v[48:63], a[244:247], v[68:71], v[48:63]
    v_mul_f32 v83, s46, v83
    v_cvt_pk_bf16_f32 v75, v82, v83
    v_accvgpr_write_b32 a184, v72
    v_accvgpr_write_b32 a185, v73
    v_accvgpr_write_b32 a186, v74
    v_accvgpr_write_b32 a187, v75
    s_waitcnt lgkmcnt(0)
    v_mfma_f32_32x32x16_bf16 v[0:15], a[220:223], a[156:159], v[0:15]
    v_lshlrev_b32 v84, 16, v124
    v_and_b32 v85, 0xffff0000, v124
    v_mul_f32 v84, s46, v84
    v_mul_f32 v85, s46, v85
    v_cvt_pk_bf16_f32 v64, v84, v85
    v_lshlrev_b32 v86, 16, v125
    v_mfma_f32_32x32x16_bf16 v[16:31], a[252:255], a[156:159], v[16:31]
    v_and_b32 v87, 0xffff0000, v125
    v_mul_f32 v86, s46, v86
    v_mul_f32 v87, s46, v87
    v_cvt_pk_bf16_f32 v65, v86, v87
    v_lshlrev_b32 v88, 16, v126
    v_and_b32 v89, 0xffff0000, v126
    v_mfma_f32_32x32x16_bf16 v[32:47], a[216:219], v[72:75], v[32:47]
    v_mul_f32 v88, s46, v88
    v_mul_f32 v89, s46, v89
    v_cvt_pk_bf16_f32 v66, v88, v89
    v_lshlrev_b32 v90, 16, v127
    v_and_b32 v91, 0xffff0000, v127
    v_mul_f32 v90, s46, v90
    v_mfma_f32_32x32x16_bf16 v[48:63], a[248:251], v[72:75], v[48:63]
    v_mul_f32 v91, s46, v91
    v_cvt_pk_bf16_f32 v67, v90, v91
    v_accvgpr_write_b32 a188, v64
    v_accvgpr_write_b32 a189, v65
    v_accvgpr_write_b32 a190, v66
    v_accvgpr_write_b32 a191, v67
    v_mfma_f32_32x32x16_bf16 v[32:47], a[220:223], v[64:67], v[32:47]
    v_mfma_f32_32x32x16_bf16 v[48:63], a[252:255], v[64:67], v[48:63]
L_qJ:
    s_waitcnt vmcnt(0)
    s_barrier
    ds_read_b128 a[192:195], v160 offset:16384
    ds_read_b128 a[196:199], v161 offset:16384
    ds_read_b128 a[200:203], v162 offset:16384
    ds_read_b128 a[204:207], v163 offset:16384
    s_cmp_eq_u32 s80, 0
    s_cbranch_scc1 L_nopub_seg
    s_sub_u32 s80, s80, 1
    s_lshr_b32 s56, s80, 2
    s_mov_b32 s80, 0
    s_cmp_eq_u32 s28, 0
    s_cbranch_scc0 L_nopub_seg
    v_mov_b32 v192, s56
    v_mov_b32 v193, 1
    s_mov_b64 exec, 1
    buffer_store_byte v193, v192, s[24:27], 0 offen sc1
    s_mov_b64 exec, -1
L_nopub_seg:
    s_nop 7
    s_cmp_eq_u32 s53, 64
    s_cbranch_scc1 L_nomask
    v_subrev_u32 v188, s52, v186
    v_mov_b32 v189, 0xff800000
    v_add_u32 v190, 0, v188
    v_cmp_gt_u32 s[88:89], s53, v190
    v_add_u32 v191, 1, v188
    v_cmp_gt_u32 s[90:91], s53, v191
    v_add_u32 v192, 2, v188
    v_cmp_gt_u32 s[92:93], s53, v192
    v_add_u32 v193, 3, v188
    v_cmp_gt_u32 s[94:95], s53, v193
    s_nop 1
    v_cndmask_b32 v0, v189, v0, s[88:89]
    v_cndmask_b32 v32, v189, v32, s[88:89]
    v_cndmask_b32 v1, v189, v1, s[90:91]
    v_cndmask_b32 v33, v189, v33, s[90:91]
    v_cndmask_b32 v2, v189, v2, s[92:93]
    v_cndmask_b32 v34, v189, v34, s[92:93]
    v_cndmask_b32 v3, v189, v3, s[94:95]
    v_cndmask_b32 v35, v189, v35, s[94:95]
    v_add_u32 v190, 8, v188
    v_cmp_gt_u32 s[88:89], s53, v190
    v_add_u32 v191, 9, v188
    v_cmp_gt_u32 s[90:91], s53, v191
    v_add_u32 v192, 10, v188
    v_cmp_gt_u32 s[92:93], s53, v192
    v_add_u32 v193, 11, v188
    v_cmp_gt_u32 s[94:95], s53, v193
    s_nop 1
    v_cndmask_b32 v4, v189, v4, s[88:89]
    v_cndmask_b32 v36, v189, v36, s[88:89]
    v_cndmask_b32 v5, v189, v5, s[90:91]
    v_cndmask_b32 v37, v189, v37, s[90:91]
    v_cndmask_b32 v6, v189, v6, s[92:93]
    v_cndmask_b32 v38, v189, v38, s[92:93]
    v_cndmask_b32 v7, v189, v7, s[94:95]
    v_cndmask_b32 v39, v189, v39, s[94:95]
    v_add_u32 v190, 16, v188
    v_cmp_gt_u32 s[88:89], s53, v190
    v_add_u32 v191, 17, v188
    v_cmp_gt_u32 s[90:91], s53, v191
    v_add_u32 v192, 18, v188
    v_cmp_gt_u32 s[92:93], s53, v192
    v_add_u32 v193, 19, v188
    v_cmp_gt_u32 s[94:95], s53, v193
    s_nop 1
    v_cndmask_b32 v8, v189, v8, s[88:89]
    v_cndmask_b32 v40, v189, v40, s[88:89]
    v_cndmask_b32 v9, v189, v9, s[90:91]
    v_cndmask_b32 v41, v189, v41, s[90:91]
    v_cndmask_b32 v10, v189, v10, s[92:93]
    v_cndmask_b32 v42, v189, v42, s[92:93]
    v_cndmask_b32 v11, v189, v11, s[94:95]
    v_cndmask_b32 v43, v189, v43, s[94:95]
    v_add_u32 v190, 24, v188
    v_cmp_gt_u32 s[88:89], s53, v190
    v_add_u32 v191, 25, v188
    v_cmp_gt_u32 s[90:91], s53, v191
    v_add_u32 v192, 26, v188
    v_cmp_gt_u32 s[92:93], s53, v192
    v_add_u32 v193, 27, v188
    v_cmp_gt_u32 s[94:95], s53, v193
    s_nop 1
    v_cndmask_b32 v12, v189, v12, s[88:89]
    v_cndmask_b32 v44, v189, v44, s[88:89]
    v_cndmask_b32 v13, v189, v13, s[90:91]
    v_cndmask_b32 v45, v189, v45, s[90:91]
    v_cndmask_b32 v14, v189, v14, s[92:93]
    v_cndmask_b32 v46, v189, v46, s[92:93]
    v_cndmask_b32 v15, v189, v15, s[94:95]
    v_cndmask_b32 v47, v189, v47, s[94:95]
    v_add_u32 v190, 32, v188
    v_cmp_gt_u32 s[88:89], s53, v190
    v_add_u32 v191, 33, v188
    v_cmp_gt_u32 s[90:91], s53, v191
    v_add_u32 v192, 34, v188
    v_cmp_gt_u32 s[92:93], s53, v192
    v_add_u32 v193, 35, v188
    v_cmp_gt_u32 s[94:95], s53, v193
    s_nop 1
    v_cndmask_b32 v16, v189, v16, s[88:89]
    v_cndmask_b32 v48, v189, v48, s[88:89]
    v_cndmask_b32 v17, v189, v17, s[90:91]
    v_cndmask_b32 v49, v189, v49, s[90:91]
    v_cndmask_b32 v18, v189, v18, s[92:93]
    v_cndmask_b32 v50, v189, v50, s[92:93]
    v_cndmask_b32 v19, v189, v19, s[94:95]
    v_cndmask_b32 v51, v189, v51, s[94:95]
    v_add_u32 v190, 40, v188
    v_cmp_gt_u32 s[88:89], s53, v190
    v_add_u32 v191, 41, v188
    v_cmp_gt_u32 s[90:91], s53, v191
    v_add_u32 v192, 42, v188
    v_cmp_gt_u32 s[92:93], s53, v192
    v_add_u32 v193, 43, v188
    v_cmp_gt_u32 s[94:95], s53, v193
    s_nop 1
    v_cndmask_b32 v20, v189, v20, s[88:89]
    v_cndmask_b32 v52, v189, v52, s[88:89]
    v_cndmask_b32 v21, v189, v21, s[90:91]
    v_cndmask_b32 v53, v189, v53, s[90:91]
    v_cndmask_b32 v22, v189, v22, s[92:93]
    v_cndmask_b32 v54, v189, v54, s[92:93]
    v_cndmask_b32 v23, v189, v23, s[94:95]
    v_cndmask_b32 v55, v189, v55, s[94:95]
    v_add_u32 v190, 48, v188
    v_cmp_gt_u32 s[88:89], s53, v190
    v_add_u32 v191, 49, v188
    v_cmp_gt_u32 s[90:91], s53, v191
    v_add_u32 v192, 50, v188
    v_cmp_gt_u32 s[92:93], s53, v192
    v_add_u32 v193, 51, v188
    v_cmp_gt_u32 s[94:95], s53, v193
    s_nop 1
    v_cndmask_b32 v24, v189, v24, s[88:89]
    v_cndmask_b32 v56, v189, v56, s[88:89]
    v_cndmask_b32 v25, v189, v25, s[90:91]
    v_cndmask_b32 v57, v189, v57, s[90:91]
    v_cndmask_b32 v26, v189, v26, s[92:93]
    v_cndmask_b32 v58, v189, v58, s[92:93]
    v_cndmask_b32 v27, v189, v27, s[94:95]
    v_cndmask_b32 v59, v189, v59, s[94:95]
    v_add_u32 v190, 56, v188
    v_cmp_gt_u32 s[88:89], s53, v190
    v_add_u32 v191, 57, v188
    v_cmp_gt_u32 s[90:91], s53, v191
    v_add_u32 v192, 58, v188
    v_cmp_gt_u32 s[92:93], s53, v192
    v_add_u32 v193, 59, v188
    v_cmp_gt_u32 s[94:95], s53, v193
    s_nop 1
    v_cndmask_b32 v28, v189, v28, s[88:89]
    v_cndmask_b32 v60, v189, v60, s[88:89]
    v_cndmask_b32 v29, v189, v29, s[90:91]
    v_cndmask_b32 v61, v189, v61, s[90:91]
    v_cndmask_b32 v30, v189, v30, s[92:93]
    v_cndmask_b32 v62, v189, v62, s[92:93]
    v_cndmask_b32 v31, v189, v31, s[94:95]
    v_cndmask_b32 v63, v189, v63, s[94:95]
L_nomask:
    v_max3_f32 v128, v0, v1, v2
    v_max3_f32 v128, v128, v3, v4
    v_max3_f32 v128, v128, v5, v6
    v_max3_f32 v128, v128, v7, v8
    v_max3_f32 v128, v128, v9, v10
    v_max3_f32 v128, v128, v11, v12
    v_max3_f32 v128, v128, v13, v14
    v_max3_f32 v128, v128, v15, v16
    v_max3_f32 v128, v128, v17, v18
    v_max3_f32 v128, v128, v19, v20
    v_max3_f32 v128, v128, v21, v22
    v_max3_f32 v128, v128, v23, v24
    v_max3_f32 v128, v128, v25, v26
    v_max3_f32 v128, v128, v27, v28
    v_max3_f32 v128, v128, v29, v30
    v_max_f32 v128, v128, v31
    v_max3_f32 v144, v32, v33, v34
    v_max3_f32 v144, v144, v35, v36
    v_max3_f32 v144, v144, v37, v38
    v_max3_f32 v144, v144, v39, v40
    v_max3_f32 v144, v144, v41, v42
    v_max3_f32 v144, v144, v43, v44
    v_max3_f32 v144, v144, v45, v46
    v_max3_f32 v144, v144, v47, v48
    v_max3_f32 v144, v144, v49, v50
    v_max3_f32 v144, v144, v51, v52
    v_max3_f32 v144, v144, v53, v54
    v_max3_f32 v144, v144, v55, v56
    v_max3_f32 v144, v144, v57, v58
    v_max3_f32 v144, v144, v59, v60
    v_max3_f32 v144, v144, v61, v62
    v_max_f32 v144, v144, v63
    v_mov_b32 v190, v128
    v_mov_b32 v191, v144
    s_nop 1
    v_permlane32_swap_b32 v128, v190
    v_permlane32_swap_b32 v144, v191
    s_nop 1
    v_max_f32 v128, v128, v190
    v_max_f32 v144, v144, v191
    v_sub_f32 v128, 0, v128
    v_sub_f32 v144, 0, v144
    v_mov_b32 v129, v128
    v_mov_b32 v145, v144
    v_mov_b32 v130, v128
    v_mov_b32 v146, v144
    v_mov_b32 v131, v128
    v_mov_b32 v147, v144
    v_mov_b32 v132, v128
    v_mov_b32 v148, v144
    v_mov_b32 v133, v128
    v_mov_b32 v149, v144
    v_mov_b32 v134, v128
    v_mov_b32 v150, v144
    v_mov_b32 v135, v128
    v_mov_b32 v151, v144
    v_mov_b32 v136, v128
    v_mov_b32 v152, v144
    v_mov_b32 v137, v128
    v_mov_b32 v153, v144
    v_mov_b32 v138, v128
    v_mov_b32 v154, v144
    v_mov_b32 v139, v128
    v_mov_b32 v155, v144
    v_mov_b32 v140, v128
    v_mov_b32 v156, v144
    v_mov_b32 v141, v128
    v_mov_b32 v157, v144
    v_mov_b32 v142, v128
    v_mov_b32 v158, v144
    v_mov_b32 v143, v128
    v_mov_b32 v159, v144
    s_sub_u32 s42, s42, 1
    s_mov_b32 s87, 0
    s_mov_b32 s83, 4
    s_lshl_b32 s85, s28, 14
    s_add_u32 s85, s85, 65536
    s_and_b32 s56, s55, 3
    s_cmp_eq_u32 s56, 2
    s_cbranch_scc0 L_bg_nc
    s_lshr_b32 s56, s55, 4
    s_mul_i32 s84, s56, 17408
    s_mov_b32 s82, 1
    s_mov_b32 s81, 6
    s_branch L_bg_j
L_bg_nc:
    s_bitcmp1_b32 s39, 0
    s_cbranch_scc0 L_bg_j
    s_bfe_u32 s56, s68, 0x80008
    s_or_b32 s56, s56, s54
    s_cmp_eq_u32 s56, 0
    s_cbranch_scc0 L_bg_j
    s_and_b32 s56, s28, 1
    s_lshl_b32 s56, s56, 18
    s_add_u32 s84, s64, s56
    s_mov_b32 s6, s65
    s_mov_b32 s82, 4
    s_mov_b32 s81, 0xffff
    s_mov_b32 s87, 1
    s_call_b64 s[72:73], L_event
    s_call_b64 s[72:73], L_event
L_bg_j:
    s_cmp_eq_u32 s54, 0
    s_cbranch_scc0 L_p1B
    s_waitcnt lgkmcnt(2)
    v_mfma_f32_32x32x16_bf16 v[64:79], a[192:195], a[128:131], v[128:143]
    ds_read_b128 a[208:211], v164 offset:16384
    s_cmp_ge_u32 s42, 2
    s_cselect_b32 s48, s40, 1073741824
    s_add_u32 m0, s43, 0
    v_add_f32 v0, v0, v128
    v_add_f32 v1, v1, v128
    v_add_f32 v2, v2, v128
    v_add_f32 v3, v3, v128
    v_add_f32 v4, v4, v128
    v_mfma_f32_32x32x16_bf16 v[64:79], a[196:199], a[132:135], v[64:79]
    ds_read_b128 a[212:215], v165 offset:16384
    buffer_load_dwordx4 v172, s[8:11], s48 offen offset:0 lds
    v_add_f32 v5, v5, v128
    v_add_f32 v6, v6, v128
    v_mfma_f32_32x32x16_bf16 v[96:111], a[192:195], a[160:163], v[144:159]
    v_add_f32 v7, v7, v128
    v_add_f32 v8, v8, v128
    v_add_f32 v9, v9, v128
    v_add_f32 v10, v10, v128
    v_add_f32 v11, v11, v128
    v_add_f32 v12, v12, v128
    v_add_f32 v13, v13, v128
    v_add_f32 v14, v14, v128
    v_add_f32 v15, v15, v128
    v_add_f32 v32, v32, v144
    v_add_f32 v33, v33, v144
    v_add_f32 v34, v34, v144
    v_add_f32 v35, v35, v144
    v_mfma_f32_32x32x16_bf16 v[96:111], a[196:199], a[164:167], v[96:111]
    buffer_load_dwordx4 v173, s[8:11], s48 offen offset:1024 lds
    v_add_f32 v36, v36, v144
    v_add_f32 v37, v37, v144
    v_add_f32 v38, v38, v144
    v_add_f32 v39, v39, v144
    v_add_f32 v40, v40, v144
    s_waitcnt lgkmcnt(2)
    v_mfma_f32_32x32x16_bf16 v[64:79], a[200:203], a[136:139], v[64:79]
    ds_read_b128 a[216:219], v166 offset:16384
    v_add_f32 v41, v41, v144
    v_add_f32 v42, v42, v144
    v_add_f32 v43, v43, v144
    v_add_f32 v44, v44, v144
    v_add_f32 v45, v45, v144
    v_add_f32 v46, v46, v144
    v_add_f32 v47, v47, v144
    v_exp_f32 v0, v0
    v_exp_f32 v1, v1
    v_mfma_f32_32x32x16_bf16 v[64:79], a[204:207], a[140:143], v[64:79]
    ds_read_b128 a[220:223], v167 offset:16384
    buffer_load_dwordx4 v174, s[8:11], s48 offen offset:2048 lds
    v_exp_f32 v2, v2
    v_add_f32 v184, v0, v1
    v_mfma_f32_32x32x16_bf16 v[96:111], a[200:203], a[168:171], v[96:111]
    v_cvt_pk_bf16_f32 v0, v0, v1
    v_exp_f32 v3, v3
    v_add_f32 v184, v184, v2
    v_exp_f32 v4, v4
    v_add_f32 v184, v184, v3
    v_cvt_pk_bf16_f32 v1, v2, v3
    v_exp_f32 v5, v5
    v_add_f32 v184, v184, v4
    v_exp_f32 v6, v6
    v_mfma_f32_32x32x16_bf16 v[96:111], a[204:207], a[172:175], v[96:111]
    buffer_load_dwordx4 v175, s[8:11], s48 offen offset:3072 lds
    v_add_f32 v184, v184, v5
    v_cvt_pk_bf16_f32 v2, v4, v5
    v_exp_f32 v7, v7
    v_add_f32 v184, v184, v6
    s_waitcnt lgkmcnt(2)
    v_mfma_f32_32x32x16_bf16 v[64:79], a[208:211], a[144:147], v[64:79]
    ds_read_b128 a[224:227], v160 offset:24576
    s_add_u32 m0, s43, 49152
    v_exp_f32 v8, v8
    v_add_f32 v184, v184, v7
    v_cvt_pk_bf16_f32 v3, v6, v7
    v_exp_f32 v9, v9
    v_add_f32 v184, v184, v8
    v_exp_f32 v10, v10
    v_mfma_f32_32x32x16_bf16 v[64:79], a[212:215], a[148:151], v[64:79]
    ds_read_b128 a[228:231], v161 offset:24576
    buffer_load_dwordx4 v176, s[12:15], s41 offen offset:0 lds
    v_add_f32 v184, v184, v9
    v_cvt_pk_bf16_f32 v8, v8, v9
    v_mfma_f32_32x32x16_bf16 v[96:111], a[208:211], a[176:179], v[96:111]
    v_exp_f32 v11, v11
    v_add_f32 v184, v184, v10
    v_exp_f32 v12, v12
    v_add_f32 v184, v184, v11
    v_cvt_pk_bf16_f32 v9, v10, v11
    v_exp_f32 v13, v13
    v_add_f32 v184, v184, v12
    v_exp_f32 v14, v14
    v_add_f32 v184, v184, v13
    v_cvt_pk_bf16_f32 v10, v12, v13
    v_mfma_f32_32x32x16_bf16 v[96:111], a[212:215], a[180:183], v[96:111]
    buffer_load_dwordx4 v177, s[12:15], s41 offen offset:1024 lds
    v_exp_f32 v15, v15
    v_add_f32 v184, v184, v14
    v_exp_f32 v32, v32
    s_waitcnt lgkmcnt(2)
    v_mfma_f32_32x32x16_bf16 v[64:79], a[216:219], a[152:155], v[64:79]
    ds_read_b128 a[232:235], v162 offset:24576
    v_add_f32 v184, v184, v15
    v_cvt_pk_bf16_f32 v11, v14, v15
    v_exp_f32 v33, v33
    v_exp_f32 v34, v34
    v_add_f32 v185, v32, v33
    v_cvt_pk_bf16_f32 v32, v32, v33
    v_exp_f32 v35, v35
    v_add_f32 v185, v185, v34
    v_mfma_f32_32x32x16_bf16 v[64:79], a[220:223], a[156:159], v[64:79]
    ds_read_b128 a[236:239], v163 offset:24576
    buffer_load_dwordx4 v178, s[12:15], s41 offen offset:2048 lds
    v_exp_f32 v36, v36
    v_mfma_f32_32x32x16_bf16 v[96:111], a[216:219], a[184:187], v[96:111]
    v_add_f32 v185, v185, v35
    v_cvt_pk_bf16_f32 v33, v34, v35
    v_exp_f32 v37, v37
    v_add_f32 v185, v185, v36
    v_exp_f32 v38, v38
    v_add_f32 v185, v185, v37
    v_cvt_pk_bf16_f32 v34, v36, v37
    v_exp_f32 v39, v39
    v_add_f32 v185, v185, v38
    v_exp_f32 v40, v40
    v_mfma_f32_32x32x16_bf16 v[96:111], a[220:223], a[188:191], v[96:111]
    buffer_load_dwordx4 v179, s[12:15], s41 offen offset:3072 lds
    v_add_f32 v185, v185, v39
    v_cvt_pk_bf16_f32 v35, v38, v39
    v_exp_f32 v41, v41
    s_waitcnt lgkmcnt(2)
    v_mfma_f32_32x32x16_bf16 v[80:95], a[224:227], a[128:131], v[128:143]
    ds_read_b128 a[240:243], v164 offset:24576
    v_add_f32 v185, v185, v40
    v_exp_f32 v42, v42
    v_add_f32 v185, v185, v41
    v_cvt_pk_bf16_f32 v40, v40, v41
    v_exp_f32 v43, v43
    v_add_f32 v185, v185, v42
    v_exp_f32 v44, v44
    v_add_f32 v185, v185, v43
    v_mfma_f32_32x32x16_bf16 v[80:95], a[228:231], a[132:135], v[80:95]
    ds_read_b128 a[244:247], v165 offset:24576
    s_mov_b32 s41, s40
    s_add_u32 s40, s40, 262144
    v_cvt_pk_bf16_f32 v41, v42, v43
    v_exp_f32 v45, v45
    v_add_f32 v185, v185, v44
    v_exp_f32 v46, v46
    v_add_f32 v185, v185, v45
    v_mfma_f32_32x32x16_bf16 v[112:127], a[224:227], a[160:163], v[144:159]
    v_cvt_pk_bf16_f32 v42, v44, v45
    v_exp_f32 v47, v47
    v_add_f32 v185, v185, v46
    s_nop 0
    v_add_f32 v185, v185, v47
    v_cvt_pk_bf16_f32 v43, v46, v47
    v_add_f32 v16, v16, v128
    v_add_f32 v17, v17, v128
    v_add_f32 v18, v18, v128
    v_add_f32 v19, v19, v128
    v_add_f32 v20, v20, v128
    v_add_f32 v21, v21, v128
    v_add_f32 v22, v22, v128
    v_mfma_f32_32x32x16_bf16 v[112:127], a[228:231], a[164:167], v[112:127]
    v_add_f32 v23, v23, v128
    v_add_f32 v24, v24, v128
    v_add_f32 v25, v25, v128
    v_add_f32 v26, v26, v128
    v_add_f32 v27, v27, v128
    v_add_f32 v28, v28, v128
    v_add_f32 v29, v29, v128
    v_add_f32 v30, v30, v128
    v_add_f32 v31, v31, v128
    v_add_f32 v48, v48, v144
    v_add_f32 v49, v49, v144
    v_add_f32 v50, v50, v144
    v_add_f32 v51, v51, v144
    s_waitcnt lgkmcnt(2)
    v_mfma_f32_32x32x16_bf16 v[80:95], a[232:235], a[136:139], v[80:95]
    ds_read_b128 a[248:251], v166 offset:24576
    v_add_f32 v52, v52, v144
    v_add_f32 v53, v53, v144
    v_add_f32 v54, v54, v144
    v_add_f32 v55, v55, v144
    v_add_f32 v56, v56, v144
    v_add_f32 v57, v57, v144
    v_add_f32 v58, v58, v144
    v_add_f32 v59, v59, v144
    v_add_f32 v60, v60, v144
    v_add_f32 v61, v61, v144
    v_add_f32 v62, v62, v144
    v_add_f32 v63, v63, v144
    v_mfma_f32_32x32x16_bf16 v[80:95], a[236:239], a[140:143], v[80:95]
    ds_read_b128 a[252:255], v167 offset:24576
    v_exp_f32 v16, v16
    v_exp_f32 v17, v17
    v_add_f32 v184, v184, v16
    v_exp_f32 v18, v18
    v_add_f32 v184, v184, v17
    v_cvt_pk_bf16_f32 v16, v16, v17
    v_exp_f32 v19, v19
    v_mfma_f32_32x32x16_bf16 v[112:127], a[232:235], a[168:171], v[112:127]
    ds_read_b64_tr_b16 a[192:193], v168 offset:32768
    v_add_f32 v184, v184, v18
    v_exp_f32 v20, v20
    v_add_f32 v184, v184, v19
    v_cvt_pk_bf16_f32 v17, v18, v19
    v_exp_f32 v21, v21
    v_add_f32 v184, v184, v20
    v_exp_f32 v22, v22
    v_add_f32 v184, v184, v21
    v_mfma_f32_32x32x16_bf16 v[112:127], a[236:239], a[172:175], v[112:127]
    ds_read_b64_tr_b16 a[194:195], v168 offset:34816
    v_cvt_pk_bf16_f32 v18, v20, v21
    v_exp_f32 v23, v23
    v_add_f32 v184, v184, v22
    v_exp_f32 v24, v24
    v_add_f32 v184, v184, v23
    v_cvt_pk_bf16_f32 v19, v22, v23
    v_exp_f32 v25, v25
    v_add_f32 v184, v184, v24
    s_waitcnt lgkmcnt(4)
    v_mfma_f32_32x32x16_bf16 v[80:95], a[240:243], a[144:147], v[80:95]
    ds_read_b64_tr_b16 a[196:197], v168 offset:36864
    v_exp_f32 v26, v26
    v_add_f32 v184, v184, v25
    v_cvt_pk_bf16_f32 v24, v24, v25
    v_exp_f32 v27, v27
    v_add_f32 v184, v184, v26
    v_exp_f32 v28, v28
    v_add_f32 v184, v184, v27
    v_cvt_pk_bf16_f32 v25, v26, v27
    v_mfma_f32_32x32x16_bf16 v[80:95], a[244:247], a[148:151], v[80:95]
    ds_read_b64_tr_b16 a[198:199], v168 offset:38912
    v_exp_f32 v29, v29
    v_add_f32 v184, v184, v28
    v_exp_f32 v30, v30
    v_add_f32 v184, v184, v29
    v_cvt_pk_bf16_f32 v26, v28, v29
    v_exp_f32 v31, v31
    v_add_f32 v184, v184, v30
    v_exp_f32 v48, v48
    v_mfma_f32_32x32x16_bf16 v[112:127], a[240:243], a[176:179], v[112:127]
    ds_read_b64_tr_b16 a[200:201], v168 offset:40960
    v_add_f32 v184, v184, v31
    v_cvt_pk_bf16_f32 v27, v30, v31
    v_exp_f32 v49, v49
    v_add_f32 v185, v185, v48
    v_exp_f32 v50, v50
    v_add_f32 v185, v185, v49
    v_cvt_pk_bf16_f32 v48, v48, v49
    v_exp_f32 v51, v51
    v_add_f32 v185, v185, v50
    v_mfma_f32_32x32x16_bf16 v[112:127], a[244:247], a[180:183], v[112:127]
    ds_read_b64_tr_b16 a[202:203], v168 offset:43008
    v_exp_f32 v52, v52
    v_add_f32 v185, v185, v51
    v_cvt_pk_bf16_f32 v49, v50, v51
    v_exp_f32 v53, v53
    v_add_f32 v185, v185, v52
    v_exp_f32 v54, v54
    v_add_f32 v185, v185, v53
    v_cvt_pk_bf16_f32 v50, v52, v53
    s_waitcnt lgkmcnt(6)
    v_mfma_f32_32x32x16_bf16 v[80:95], a[248:251], a[152:155], v[80:95]
    ds_read_b64_tr_b16 a[204:205], v168 offset:45056
    v_exp_f32 v55, v55
    v_add_f32 v185, v185, v54
    v_exp_f32 v56, v56
    v_add_f32 v185, v185, v55
    v_cvt_pk_bf16_f32 v51, v54, v55
    v_exp_f32 v57, v57
    v_add_f32 v185, v185, v56
    v_exp_f32 v58, v58
    v_mfma_f32_32x32x16_bf16 v[80:95], a[252:255], a[156:159], v[80:95]
    ds_read_b64_tr_b16 a[206:207], v168 offset:47104
    v_add_f32 v185, v185, v57
    v_cvt_pk_bf16_f32 v56, v56, v57
    v_exp_f32 v59, v59
    v_add_f32 v185, v185, v58
    v_exp_f32 v60, v60
    v_add_f32 v185, v185, v59
    v_cvt_pk_bf16_f32 v57, v58, v59
    v_exp_f32 v61, v61
    v_mfma_f32_32x32x16_bf16 v[112:127], a[248:251], a[184:187], v[112:127]
    ds_read_b64_tr_b16 a[208:209], v169 offset:32768
    v_add_f32 v185, v185, v60
    v_exp_f32 v62, v62
    v_add_f32 v185, v185, v61
    v_cvt_pk_bf16_f32 v58, v60, v61
    v_exp_f32 v63, v63
    v_add_f32 v185, v185, v62
    s_nop 0
    v_add_f32 v185, v185, v63
    v_cvt_pk_bf16_f32 v59, v62, v63
    v_mfma_f32_32x32x16_bf16 v[112:127], a[252:255], a[188:191], v[112:127]
    ds_read_b64_tr_b16 a[210:211], v169 offset:34816
    s_nop 0
    s_branch L_back_A0
L_p1B:
    s_waitcnt lgkmcnt(2)
    v_mfma_f32_32x32x16_bf16 v[64:79], a[192:195], a[128:131], v[128:143]
    ds_read_b128 a[208:211], v164 offset:16384
    s_cmp_ge_u32 s42, 2
    s_cselect_b32 s48, s40, 1073741824
    s_add_u32 m0, s43, 0
    v_add_f32 v0, v0, v128
    v_add_f32 v1, v1, v128
    v_add_f32 v2, v2, v128
    v_add_f32 v3, v3, v128
    v_add_f32 v4, v4, v128
    v_add_f32 v5, v5, v128
    v_mfma_f32_32x32x16_bf16 v[64:79], a[196:199], a[132:135], v[64:79]
    ds_read_b128 a[212:215], v165 offset:16384
    buffer_load_dwordx4 v172, s[8:11], s48 offen offset:0 lds
    v_add_f32 v6, v6, v128
    v_add_f32 v7, v7, v128
    v_add_f32 v8, v8, v128
    v_mfma_f32_32x32x16_bf16 v[96:111], a[192:195], a[160:163], v[144:159]
    buffer_load_dwordx4 v173, s[8:11], s48 offen offset:1024 lds
    v_add_f32 v9, v9, v128
    v_add_f32 v10, v10, v128
    v_add_f32 v11, v11, v128
    v_add_f32 v12, v12, v128
    v_add_f32 v13, v13, v128
    v_add_f32 v14, v14, v128
    v_mfma_f32_32x32x16_bf16 v[96:111], a[196:199], a[164:167], v[96:111]
    buffer_load_dwordx4 v174, s[8:11], s48 offen offset:2048 lds
    v_add_f32 v15, v15, v128
    v_add_f32 v32, v32, v144
    v_add_f32 v33, v33, v144
    v_add_f32 v34, v34, v144
    v_add_f32 v35, v35, v144
    v_add_f32 v36, v36, v144
    v_add_f32 v37, v37, v144
    s_waitcnt lgkmcnt(2)
    v_mfma_f32_32x32x16_bf16 v[64:79], a[200:203], a[136:139], v[64:79]
    ds_read_b128 a[216:219], v166 offset:16384
    buffer_load_dwordx4 v175, s[8:11], s48 offen offset:3072 lds
    s_add_u32 s49, s48, 65536
    s_add_u32 m0, s43, 4096
    v_mfma_f32_32x32x16_bf16 v[64:79], a[204:207], a[140:143], v[64:79]
    ds_read_b128 a[220:223], v167 offset:16384
    buffer_load_dwordx4 v172, s[8:11], s49 offen offset:0 lds
    v_add_f32 v38, v38, v144
    v_add_f32 v39, v39, v144
    v_add_f32 v40, v40, v144
    v_mfma_f32_32x32x16_bf16 v[96:111], a[200:203], a[168:171], v[96:111]
    buffer_load_dwordx4 v173, s[8:11], s49 offen offset:1024 lds
    v_add_f32 v41, v41, v144
    v_add_f32 v42, v42, v144
    v_add_f32 v43, v43, v144
    v_add_f32 v44, v44, v144
    v_add_f32 v45, v45, v144
    v_add_f32 v46, v46, v144
    v_mfma_f32_32x32x16_bf16 v[96:111], a[204:207], a[172:175], v[96:111]
    buffer_load_dwordx4 v174, s[8:11], s49 offen offset:2048 lds
    v_add_f32 v47, v47, v144
    v_exp_f32 v0, v0
    v_exp_f32 v1, v1
    v_exp_f32 v2, v2
    s_waitcnt lgkmcnt(2)
    v_mfma_f32_32x32x16_bf16 v[64:79], a[208:211], a[144:147], v[64:79]
    ds_read_b128 a[224:227], v160 offset:24576
    buffer_load_dwordx4 v175, s[8:11], s49 offen offset:3072 lds
    s_add_u32 m0, s43, 49152
    v_mfma_f32_32x32x16_bf16 v[64:79], a[212:215], a[148:151], v[64:79]
    ds_read_b128 a[228:231], v161 offset:24576
    buffer_load_dwordx4 v176, s[12:15], s41 offen offset:0 lds
    v_add_f32 v184, v0, v1
    v_cvt_pk_bf16_f32 v0, v0, v1
    v_mfma_f32_32x32x16_bf16 v[96:111], a[208:211], a[176:179], v[96:111]
    buffer_load_dwordx4 v177, s[12:15], s41 offen offset:1024 lds
    v_exp_f32 v3, v3
    v_add_f32 v184, v184, v2
    v_exp_f32 v4, v4
    v_add_f32 v184, v184, v3
    v_mfma_f32_32x32x16_bf16 v[96:111], a[212:215], a[180:183], v[96:111]
    buffer_load_dwordx4 v178, s[12:15], s41 offen offset:2048 lds
    v_cvt_pk_bf16_f32 v1, v2, v3
    v_exp_f32 v5, v5
    v_add_f32 v184, v184, v4
    v_exp_f32 v6, v6
    v_add_f32 v184, v184, v5
    s_waitcnt lgkmcnt(2)
    v_mfma_f32_32x32x16_bf16 v[64:79], a[216:219], a[152:155], v[64:79]
    ds_read_b128 a[232:235], v162 offset:24576
    buffer_load_dwordx4 v179, s[12:15], s41 offen offset:3072 lds
    s_add_u32 s49, s41, 65536
    s_add_u32 m0, s43, 53248
    v_mfma_f32_32x32x16_bf16 v[64:79], a[220:223], a[156:159], v[64:79]
    ds_read_b128 a[236:239], v163 offset:24576
    buffer_load_dwordx4 v176, s[12:15], s49 offen offset:0 lds
    v_cvt_pk_bf16_f32 v2, v4, v5
    v_exp_f32 v7, v7
    v_mfma_f32_32x32x16_bf16 v[96:111], a[216:219], a[184:187], v[96:111]
    buffer_load_dwordx4 v177, s[12:15], s49 offen offset:1024 lds
    v_add_f32 v184, v184, v6
    v_exp_f32 v8, v8
    v_add_f32 v184, v184, v7
    v_cvt_pk_bf16_f32 v3, v6, v7
    v_mfma_f32_32x32x16_bf16 v[96:111], a[220:223], a[188:191], v[96:111]
    buffer_load_dwordx4 v178, s[12:15], s49 offen offset:2048 lds
    v_exp_f32 v9, v9
    v_add_f32 v184, v184, v8
    v_exp_f32 v10, v10
    v_add_f32 v184, v184, v9
    v_cvt_pk_bf16_f32 v8, v8, v9
    s_waitcnt lgkmcnt(2)
    v_mfma_f32_32x32x16_bf16 v[80:95], a[224:227], a[128:131], v[128:143]
    ds_read_b128 a[240:243], v164 offset:24576
    buffer_load_dwordx4 v179, s[12:15], s49 offen offset:3072 lds
    v_exp_f32 v11, v11
    v_add_f32 v184, v184, v10
    v_mfma_f32_32x32x16_bf16 v[80:95], a[228:231], a[132:135], v[80:95]
    ds_read_b128 a[244:247], v165 offset:24576
    s_mov_b32 s41, s40
    s_add_u32 s40, s40, 262144
    v_exp_f32 v12, v12
    v_add_f32 v184, v184, v11
    v_cvt_pk_bf16_f32 v9, v10, v11
    v_exp_f32 v13, v13
    v_add_f32 v184, v184, v12
    v_exp_f32 v14, v14
    v_add_f32 v184, v184, v13
    v_mfma_f32_32x32x16_bf16 v[112:127], a[224:227], a[160:163], v[144:159]
    v_cvt_pk_bf16_f32 v10, v12, v13
    v_exp_f32 v15, v15
    v_add_f32 v184, v184, v14
    v_exp_f32 v32, v32
    v_add_f32 v184, v184, v15
    v_cvt_pk_bf16_f32 v11, v14, v15
    v_exp_f32 v33, v33
    v_exp_f32 v34, v34
    v_add_f32 v185, v32, v33
    v_cvt_pk_bf16_f32 v32, v32, v33
    v_exp_f32 v35, v35
    v_add_f32 v185, v185, v34
    v_exp_f32 v36, v36
    v_mfma_f32_32x32x16_bf16 v[112:127], a[228:231], a[164:167], v[112:127]
    v_add_f32 v185, v185, v35
    v_cvt_pk_bf16_f32 v33, v34, v35
    v_exp_f32 v37, v37
    v_add_f32 v185, v185, v36
    v_exp_f32 v38, v38
    v_add_f32 v185, v185, v37
    v_cvt_pk_bf16_f32 v34, v36, v37
    v_exp_f32 v39, v39
    v_add_f32 v185, v185, v38
    v_exp_f32 v40, v40
    v_add_f32 v185, v185, v39
    v_cvt_pk_bf16_f32 v35, v38, v39
    v_exp_f32 v41, v41
    s_waitcnt lgkmcnt(2)
    v_mfma_f32_32x32x16_bf16 v[80:95], a[232:235], a[136:139], v[80:95]
    ds_read_b128 a[248:251], v166 offset:24576
    v_add_f32 v185, v185, v40
    v_exp_f32 v42, v42
    v_add_f32 v185, v185, v41
    v_cvt_pk_bf16_f32 v40, v40, v41
    v_exp_f32 v43, v43
    v_add_f32 v185, v185, v42
    v_exp_f32 v44, v44
    v_add_f32 v185, v185, v43
    v_cvt_pk_bf16_f32 v41, v42, v43
    v_exp_f32 v45, v45
    v_add_f32 v185, v185, v44
    v_mfma_f32_32x32x16_bf16 v[80:95], a[236:239], a[140:143], v[80:95]
    ds_read_b128 a[252:255], v167 offset:24576
    v_exp_f32 v46, v46
    v_add_f32 v185, v185, v45
    v_cvt_pk_bf16_f32 v42, v44, v45
    v_exp_f32 v47, v47
    v_add_f32 v185, v185, v46
    s_nop 0
    v_add_f32 v185, v185, v47
    v_cvt_pk_bf16_f32 v43, v46, v47
    v_add_f32 v16, v16, v128
    v_add_f32 v17, v17, v128
    v_add_f32 v18, v18, v128
    v_add_f32 v19, v19, v128
    v_add_f32 v20, v20, v128
    v_add_f32 v21, v21, v128
    v_mfma_f32_32x32x16_bf16 v[112:127], a[232:235], a[168:171], v[112:127]
    ds_read_b64_tr_b16 a[192:193], v168 offset:32768
    v_add_f32 v22, v22, v128
    v_add_f32 v23, v23, v128
    v_add_f32 v24, v24, v128
    v_add_f32 v25, v25, v128
    v_add_f32 v26, v26, v128
    v_add_f32 v27, v27, v128
    v_add_f32 v28, v28, v128
    v_add_f32 v29, v29, v128
    v_add_f32 v30, v30, v128
    v_add_f32 v31, v31, v128
    v_add_f32 v48, v48, v144
    v_add_f32 v49, v49, v144
    v_add_f32 v50, v50, v144
    v_add_f32 v51, v51, v144
    v_add_f32 v52, v52, v144
    v_mfma_f32_32x32x16_bf16 v[112:127], a[236:239], a[172:175], v[112:127]
    ds_read_b64_tr_b16 a[194:195], v168 offset:34816
    v_add_f32 v53, v53, v144
    v_add_f32 v54, v54, v144
    v_add_f32 v55, v55, v144
    v_add_f32 v56, v56, v144
    v_add_f32 v57, v57, v144
    v_add_f32 v58, v58, v144
    v_add_f32 v59, v59, v144
    v_add_f32 v60, v60, v144
    v_add_f32 v61, v61, v144
    v_add_f32 v62, v62, v144
    v_add_f32 v63, v63, v144
    v_exp_f32 v16, v16
    v_exp_f32 v17, v17
    v_add_f32 v184, v184, v16
    s_waitcnt lgkmcnt(4)
    v_mfma_f32_32x32x16_bf16 v[80:95], a[240:243], a[144:147], v[80:95]
    ds_read_b64_tr_b16 a[196:197], v168 offset:36864
    v_exp_f32 v18, v18
    v_add_f32 v184, v184, v17
    v_cvt_pk_bf16_f32 v16, v16, v17
    v_exp_f32 v19, v19
    v_add_f32 v184, v184, v18
    v_exp_f32 v20, v20
    v_add_f32 v184, v184, v19
    v_cvt_pk_bf16_f32 v17, v18, v19
    v_exp_f32 v21, v21
    v_add_f32 v184, v184, v20
    v_exp_f32 v22, v22
    v_mfma_f32_32x32x16_bf16 v[80:95], a[244:247], a[148:151], v[80:95]
    ds_read_b64_tr_b16 a[198:199], v168 offset:38912
    v_add_f32 v184, v184, v21
    v_cvt_pk_bf16_f32 v18, v20, v21
    v_exp_f32 v23, v23
    v_add_f32 v184, v184, v22
    v_exp_f32 v24, v24
    v_add_f32 v184, v184, v23
    v_cvt_pk_bf16_f32 v19, v22, v23
    v_exp_f32 v25, v25
    v_add_f32 v184, v184, v24
    v_exp_f32 v26, v26
    v_add_f32 v184, v184, v25
    v_mfma_f32_32x32x16_bf16 v[112:127], a[240:243], a[176:179], v[112:127]
    ds_read_b64_tr_b16 a[200:201], v168 offset:40960
    v_cvt_pk_bf16_f32 v24, v24, v25
    v_exp_f32 v27, v27
    v_add_f32 v184, v184, v26
    v_exp_f32 v28, v28
    v_add_f32 v184, v184, v27
    v_cvt_pk_bf16_f32 v25, v26, v27
    v_exp_f32 v29, v29
    v_add_f32 v184, v184, v28
    v_exp_f32 v30, v30
    v_add_f32 v184, v184, v29
    v_cvt_pk_bf16_f32 v26, v28, v29
    v_mfma_f32_32x32x16_bf16 v[112:127], a[244:247], a[180:183], v[112:127]
    ds_read_b64_tr_b16 a[202:203], v168 offset:43008
    v_exp_f32 v31, v31
    v_add_f32 v184, v184, v30
    v_exp_f32 v48, v48
    v_add_f32 v184, v184, v31
    v_cvt_pk_bf16_f32 v27, v30, v31
    v_exp_f32 v49, v49
    v_add_f32 v185, v185, v48
    v_exp_f32 v50, v50
    v_add_f32 v185, v185, v49
    v_cvt_pk_bf16_f32 v48, v48, v49
    v_exp_f32 v51, v51
    s_waitcnt lgkmcnt(6)
    v_mfma_f32_32x32x16_bf16 v[80:95], a[248:251], a[152:155], v[80:95]
    ds_read_b64_tr_b16 a[204:205], v168 offset:45056
    v_add_f32 v185, v185, v50
    v_exp_f32 v52, v52
    v_add_f32 v185, v185, v51
    v_cvt_pk_bf16_f32 v49, v50, v51
    v_exp_f32 v53, v53
    v_add_f32 v185, v185, v52
    v_exp_f32 v54, v54
    v_add_f32 v185, v185, v53
    v_cvt_pk_bf16_f32 v50, v52, v53
    v_exp_f32 v55, v55
    v_add_f32 v185, v185, v54
    v_mfma_f32_32x32x16_bf16 v[80:95], a[252:255], a[156:159], v[80:95]
    ds_read_b64_tr_b16 a[206:207], v168 offset:47104
    v_exp_f32 v56, v56
    v_add_f32 v185, v185, v55
    v_cvt_pk_bf16_f32 v51, v54, v55
    v_exp_f32 v57, v57
    v_add_f32 v185, v185, v56
    v_exp_f32 v58, v58
    v_add_f32 v185, v185, v57
    v_cvt_pk_bf16_f32 v56, v56, v57
    v_exp_f32 v59, v59
    v_add_f32 v185, v185, v58
    v_exp_f32 v60, v60
    v_mfma_f32_32x32x16_bf16 v[112:127], a[248:251], a[184:187], v[112:127]
    ds_read_b64_tr_b16 a[208:209], v169 offset:32768
    v_add_f32 v185, v185, v59
    v_cvt_pk_bf16_f32 v57, v58, v59
    v_exp_f32 v61, v61
    v_add_f32 v185, v185, v60
    v_exp_f32 v62, v62
    v_add_f32 v185, v185, v61
    v_cvt_pk_bf16_f32 v58, v60, v61
    v_exp_f32 v63, v63
    v_add_f32 v185, v185, v62
    s_nop 0
    v_add_f32 v185, v185, v63
    v_cvt_pk_bf16_f32 v59, v62, v63
    v_mfma_f32_32x32x16_bf16 v[112:127], a[252:255], a[188:191], v[112:127]
    ds_read_b64_tr_b16 a[210:211], v169 offset:34816
    s_nop 0
    s_branch L_back_B0
.p2align 6
L_loopA:
    s_waitcnt lgkmcnt(2)
    v_mfma_f32_32x32x16_bf16 v[64:79], a[192:195], a[128:131], v[128:143]
    ds_read_b128 a[208:211], v164 offset:16384
    s_cmp_ge_u32 s42, 2
    s_cselect_b32 s48, s40, 1073741824
    s_add_u32 m0, s43, 0
    v_exp_f32 v16, v16
    v_mfma_f32_32x32x16_bf16 v[64:79], a[196:199], a[132:135], v[64:79]
    ds_read_b128 a[212:215], v165 offset:16384
    buffer_load_dwordx4 v172, s[8:11], s48 offen offset:0 lds
    v_mfma_f32_32x32x16_bf16 v[96:111], a[192:195], a[160:163], v[144:159]
    v_exp_f32 v17, v17
    v_add_f32 v184, v184, v16
    v_exp_f32 v18, v18
    v_add_f32 v184, v184, v17
    v_mfma_f32_32x32x16_bf16 v[96:111], a[196:199], a[164:167], v[96:111]
    buffer_load_dwordx4 v173, s[8:11], s48 offen offset:1024 lds
    v_cvt_pk_bf16_f32 v16, v16, v17
    v_exp_f32 v19, v19
    s_waitcnt lgkmcnt(2)
    v_mfma_f32_32x32x16_bf16 v[64:79], a[200:203], a[136:139], v[64:79]
    ds_read_b128 a[216:219], v166 offset:16384
    v_add_f32 v184, v184, v18
    v_exp_f32 v20, v20
    v_add_f32 v184, v184, v19
    v_mfma_f32_32x32x16_bf16 v[64:79], a[204:207], a[140:143], v[64:79]
    ds_read_b128 a[220:223], v167 offset:16384
    buffer_load_dwordx4 v174, s[8:11], s48 offen offset:2048 lds
    v_cvt_pk_bf16_f32 v17, v18, v19
    v_mfma_f32_32x32x16_bf16 v[96:111], a[200:203], a[168:171], v[96:111]
    v_exp_f32 v21, v21
    v_add_f32 v184, v184, v20
    v_exp_f32 v22, v22
    v_mfma_f32_32x32x16_bf16 v[96:111], a[204:207], a[172:175], v[96:111]
    buffer_load_dwordx4 v175, s[8:11], s48 offen offset:3072 lds
    v_add_f32 v184, v184, v21
    v_cvt_pk_bf16_f32 v18, v20, v21
    s_waitcnt lgkmcnt(2)
    v_mfma_f32_32x32x16_bf16 v[64:79], a[208:211], a[144:147], v[64:79]
    ds_read_b128 a[224:227], v160 offset:24576
    s_add_u32 m0, s43, 49152
    v_exp_f32 v23, v23
    v_add_f32 v184, v184, v22
    v_mfma_f32_32x32x16_bf16 v[64:79], a[212:215], a[148:151], v[64:79]
    ds_read_b128 a[228:231], v161 offset:24576
    buffer_load_dwordx4 v176, s[12:15], s41 offen offset:0 lds
    v_exp_f32 v24, v24
    v_mfma_f32_32x32x16_bf16 v[96:111], a[208:211], a[176:179], v[96:111]
    v_add_f32 v184, v184, v23
    v_cvt_pk_bf16_f32 v19, v22, v23
    v_exp_f32 v25, v25
    v_add_f32 v184, v184, v24
    v_mfma_f32_32x32x16_bf16 v[96:111], a[212:215], a[180:183], v[96:111]
    buffer_load_dwordx4 v177, s[12:15], s41 offen offset:1024 lds
    v_exp_f32 v26, v26
    s_waitcnt lgkmcnt(2)
    v_mfma_f32_32x32x16_bf16 v[64:79], a[216:219], a[152:155], v[64:79]
    ds_read_b128 a[232:235], v162 offset:24576
    v_add_f32 v184, v184, v25
    v_cvt_pk_bf16_f32 v24, v24, v25
    v_exp_f32 v27, v27
    v_add_f32 v184, v184, v26
    v_mfma_f32_32x32x16_bf16 v[64:79], a[220:223], a[156:159], v[64:79]
    ds_read_b128 a[236:239], v163 offset:24576
    buffer_load_dwordx4 v178, s[12:15], s41 offen offset:2048 lds
    v_mfma_f32_32x32x16_bf16 v[96:111], a[216:219], a[184:187], v[96:111]
    v_exp_f32 v28, v28
    v_add_f32 v184, v184, v27
    v_cvt_pk_bf16_f32 v25, v26, v27
    v_exp_f32 v29, v29
    v_mfma_f32_32x32x16_bf16 v[96:111], a[220:223], a[188:191], v[96:111]
    buffer_load_dwordx4 v179, s[12:15], s41 offen offset:3072 lds
    v_add_f32 v184, v184, v28
    v_exp_f32 v30, v30
    s_waitcnt lgkmcnt(2)
    v_mfma_f32_32x32x16_bf16 v[80:95], a[224:227], a[128:131], v[128:143]
    ds_read_b128 a[240:243], v164 offset:24576
    v_add_f32 v184, v184, v29
    v_cvt_pk_bf16_f32 v26, v28, v29
    v_exp_f32 v31, v31
    v_mfma_f32_32x32x16_bf16 v[80:95], a[228:231], a[132:135], v[80:95]
    ds_read_b128 a[244:247], v165 offset:24576
    s_mov_b32 s41, s40
    s_add_u32 s40, s40, 262144
    v_add_f32 v184, v184, v30
    v_exp_f32 v48, v48
    v_mfma_f32_32x32x16_bf16 v[112:127], a[224:227], a[160:163], v[144:159]
    v_add_f32 v184, v184, v31
    v_cvt_pk_bf16_f32 v27, v30, v31
    v_exp_f32 v49, v49
    v_add_f32 v185, v185, v48
    v_mfma_f32_32x32x16_bf16 v[112:127], a[228:231], a[164:167], v[112:127]
    v_exp_f32 v50, v50
    v_add_f32 v185, v185, v49
    v_cvt_pk_bf16_f32 v48, v48, v49
    v_exp_f32 v51, v51
    s_waitcnt lgkmcnt(2)
    v_mfma_f32_32x32x16_bf16 v[80:95], a[232:235], a[136:139], v[80:95]
    ds_read_b128 a[248:251], v166 offset:24576
    v_add_f32 v185, v185, v50
    v_exp_f32 v52, v52
    v_add_f32 v185, v185, v51
    v_mfma_f32_32x32x16_bf16 v[80:95], a[236:239], a[140:143], v[80:95]
    ds_read_b128 a[252:255], v167 offset:24576
    v_cvt_pk_bf16_f32 v49, v50, v51
    v_exp_f32 v53, v53
    v_add_f32 v185, v185, v52
    v_mfma_f32_32x32x16_bf16 v[112:127], a[232:235], a[168:171], v[112:127]
    ds_read_b64_tr_b16 a[192:193], v168 offset:32768
    v_exp_f32 v54, v54
    v_add_f32 v185, v185, v53
    v_cvt_pk_bf16_f32 v50, v52, v53
    v_exp_f32 v55, v55
    v_mfma_f32_32x32x16_bf16 v[112:127], a[236:239], a[172:175], v[112:127]
    ds_read_b64_tr_b16 a[194:195], v168 offset:34816
    v_add_f32 v185, v185, v54
    v_exp_f32 v56, v56
    v_add_f32 v185, v185, v55
    s_waitcnt lgkmcnt(4)
    v_mfma_f32_32x32x16_bf16 v[80:95], a[240:243], a[144:147], v[80:95]
    ds_read_b64_tr_b16 a[196:197], v168 offset:36864
    v_cvt_pk_bf16_f32 v51, v54, v55
    v_exp_f32 v57, v57
    v_add_f32 v185, v185, v56
    v_mfma_f32_32x32x16_bf16 v[80:95], a[244:247], a[148:151], v[80:95]
    ds_read_b64_tr_b16 a[198:199], v168 offset:38912
    v_exp_f32 v58, v58
    v_add_f32 v185, v185, v57
    v_cvt_pk_bf16_f32 v56, v56, v57
    v_exp_f32 v59, v59
    v_mfma_f32_32x32x16_bf16 v[112:127], a[240:243], a[176:179], v[112:127]
    ds_read_b64_tr_b16 a[200:201], v168 offset:40960
    v_add_f32 v185, v185, v58
    v_exp_f32 v60, v60
    v_add_f32 v185, v185, v59
    v_mfma_f32_32x32x16_bf16 v[112:127], a[244:247], a[180:183], v[112:127]
    ds_read_b64_tr_b16 a[202:203], v168 offset:43008
    v_cvt_pk_bf16_f32 v57, v58, v59
    v_exp_f32 v61, v61
    v_add_f32 v185, v185, v60
    s_waitcnt lgkmcnt(6)
    v_mfma_f32_32x32x16_bf16 v[80:95], a[248:251], a[152:155], v[80:95]
    ds_read_b64_tr_b16 a[204:205], v168 offset:45056
    v_exp_f32 v62, v62
    v_add_f32 v185, v185, v61
    v_cvt_pk_bf16_f32 v58, v60, v61
    v_exp_f32 v63, v63
    v_mfma_f32_32x32x16_bf16 v[80:95], a[252:255], a[156:159], v[80:95]
    ds_read_b64_tr_b16 a[206:207], v168 offset:47104
    v_add_f32 v185, v185, v62
    s_nop 0
    v_add_f32 v185, v185, v63
    v_cvt_pk_bf16_f32 v59, v62, v63
    v_mfma_f32_32x32x16_bf16 v[112:127], a[248:251], a[184:187], v[112:127]
    ds_read_b64_tr_b16 a[208:209], v169 offset:32768
    v_max_f32 v188, v184, v185
    v_mfma_f32_32x32x16_bf16 v[112:127], a[252:255], a[188:191], v[112:127]
    ds_read_b64_tr_b16 a[210:211], v169 offset:34816
    v_cmp_nge_f32 vcc, s44, v188
    s_cbranch_vccnz L_stub_A0
L_back_A0:
    s_waitcnt lgkmcnt(6)
    v_mfma_f32_32x32x16_bf16 a[0:15], a[192:195], v[0:3], a[0:15]
    ds_read_b64_tr_b16 a[212:213], v169 offset:36864
    v_add_f32 v182, v182, v184
    v_add_f32 v183, v183, v185
    v_exp_f32 v64, v64
    v_mfma_f32_32x32x16_bf16 a[0:15], a[196:199], v[8:11], a[0:15]
    ds_read_b64_tr_b16 a[214:215], v169 offset:38912
    v_exp_f32 v65, v65
    v_exp_f32 v66, v66
    v_mfma_f32_32x32x16_bf16 a[64:79], a[192:195], v[32:35], a[64:79]
    ds_read_b64_tr_b16 a[216:217], v169 offset:40960
    v_add_f32 v184, v64, v65
    v_cvt_pk_bf16_f32 v64, v64, v65
    v_mfma_f32_32x32x16_bf16 a[64:79], a[196:199], v[40:43], a[64:79]
    ds_read_b64_tr_b16 a[218:219], v169 offset:43008
    v_exp_f32 v67, v67
    v_add_f32 v184, v184, v66
    v_exp_f32 v68, v68
    s_waitcnt lgkmcnt(6)
    v_mfma_f32_32x32x16_bf16 a[0:15], a[200:203], v[16:19], a[0:15]
    ds_read_b64_tr_b16 a[220:221], v169 offset:45056
    v_add_f32 v184, v184, v67
    v_cvt_pk_bf16_f32 v65, v66, v67
    v_exp_f32 v69, v69
    v_mfma_f32_32x32x16_bf16 a[0:15], a[204:207], v[24:27], a[0:15]
    ds_read_b64_tr_b16 a[222:223], v169 offset:47104
    v_add_f32 v184, v184, v68
    v_exp_f32 v70, v70
    v_mfma_f32_32x32x16_bf16 a[64:79], a[200:203], v[48:51], a[64:79]
    ds_read_b64_tr_b16 a[224:225], v170 offset:32768
    v_add_f32 v184, v184, v69
    v_cvt_pk_bf16_f32 v66, v68, v69
    v_exp_f32 v71, v71
    v_mfma_f32_32x32x16_bf16 a[64:79], a[204:207], v[56:59], a[64:79]
    ds_read_b64_tr_b16 a[226:227], v170 offset:34816
    v_add_f32 v184, v184, v70
    v_exp_f32 v72, v72
    s_waitcnt lgkmcnt(6)
    v_mfma_f32_32x32x16_bf16 a[16:31], a[208:211], v[0:3], a[16:31]
    ds_read_b64_tr_b16 a[228:229], v170 offset:36864
    v_add_f32 v184, v184, v71
    v_cvt_pk_bf16_f32 v67, v70, v71
    v_exp_f32 v73, v73
    v_mfma_f32_32x32x16_bf16 a[16:31], a[212:215], v[8:11], a[16:31]
    ds_read_b64_tr_b16 a[230:231], v170 offset:38912
    v_add_f32 v184, v184, v72
    v_exp_f32 v74, v74
    v_mfma_f32_32x32x16_bf16 a[80:95], a[208:211], v[32:35], a[80:95]
    ds_read_b64_tr_b16 a[232:233], v170 offset:40960
    v_add_f32 v184, v184, v73
    v_cvt_pk_bf16_f32 v72, v72, v73
    v_exp_f32 v75, v75
    v_mfma_f32_32x32x16_bf16 a[80:95], a[212:215], v[40:43], a[80:95]
    ds_read_b64_tr_b16 a[234:235], v170 offset:43008
    v_add_f32 v184, v184, v74
    v_exp_f32 v76, v76
    s_waitcnt lgkmcnt(6)
    v_mfma_f32_32x32x16_bf16 a[16:31], a[216:219], v[16:19], a[16:31]
    ds_read_b64_tr_b16 a[236:237], v170 offset:45056
    v_add_f32 v184, v184, v75
    v_cvt_pk_bf16_f32 v73, v74, v75
    v_exp_f32 v77, v77
    v_mfma_f32_32x32x16_bf16 a[16:31], a[220:223], v[24:27], a[16:31]
    ds_read_b64_tr_b16 a[238:239], v170 offset:47104
    v_add_f32 v184, v184, v76
    v_exp_f32 v78, v78
    v_add_f32 v184, v184, v77
    v_mfma_f32_32x32x16_bf16 a[80:95], a[216:219], v[48:51], a[80:95]
    ds_read_b64_tr_b16 a[240:241], v171 offset:32768
    v_cvt_pk_bf16_f32 v74, v76, v77
    v_exp_f32 v79, v79
    v_mfma_f32_32x32x16_bf16 a[80:95], a[220:223], v[56:59], a[80:95]
    ds_read_b64_tr_b16 a[242:243], v171 offset:34816
    v_add_f32 v184, v184, v78
    v_exp_f32 v96, v96
    v_add_f32 v184, v184, v79
    s_waitcnt lgkmcnt(6)
    v_mfma_f32_32x32x16_bf16 a[32:47], a[224:227], v[0:3], a[32:47]
    ds_read_b64_tr_b16 a[244:245], v171 offset:36864
    v_cvt_pk_bf16_f32 v75, v78, v79
    v_exp_f32 v97, v97
    v_mfma_f32_32x32x16_bf16 a[32:47], a[228:231], v[8:11], a[32:47]
    ds_read_b64_tr_b16 a[246:247], v171 offset:38912
    v_exp_f32 v98, v98
    v_add_f32 v185, v96, v97
    v_cvt_pk_bf16_f32 v96, v96, v97
    v_mfma_f32_32x32x16_bf16 a[96:111], a[224:227], v[32:35], a[96:111]
    ds_read_b64_tr_b16 a[248:249], v171 offset:40960
    v_exp_f32 v99, v99
    v_add_f32 v185, v185, v98
    v_mfma_f32_32x32x16_bf16 a[96:111], a[228:231], v[40:43], a[96:111]
    ds_read_b64_tr_b16 a[250:251], v171 offset:43008
    v_exp_f32 v100, v100
    v_add_f32 v185, v185, v99
    v_cvt_pk_bf16_f32 v97, v98, v99
    s_waitcnt lgkmcnt(6)
    v_mfma_f32_32x32x16_bf16 a[32:47], a[232:235], v[16:19], a[32:47]
    ds_read_b64_tr_b16 a[252:253], v171 offset:45056
    v_exp_f32 v101, v101
    v_add_f32 v185, v185, v100
    v_exp_f32 v102, v102
    v_mfma_f32_32x32x16_bf16 a[32:47], a[236:239], v[24:27], a[32:47]
    ds_read_b64_tr_b16 a[254:255], v171 offset:47104
    v_add_f32 v185, v185, v101
    v_cvt_pk_bf16_f32 v98, v100, v101
    v_mfma_f32_32x32x16_bf16 a[96:111], a[232:235], v[48:51], a[96:111]
    v_exp_f32 v103, v103
    v_add_f32 v185, v185, v102
    v_exp_f32 v104, v104
    v_mfma_f32_32x32x16_bf16 a[96:111], a[236:239], v[56:59], a[96:111]
    s_waitcnt vmcnt(0) lgkmcnt(0)
    s_barrier
    s_cmp_le_u32 s42, s81
    s_cbranch_scc1 L_evstub_0
    L_evback_0:
    v_add_f32 v185, v185, v103
    v_mfma_f32_32x32x16_bf16 a[48:63], a[240:243], v[0:3], a[48:63]
    ds_read_b128 a[192:195], v160 offset:0
    v_cvt_pk_bf16_f32 v99, v102, v103
    v_exp_f32 v105, v105
    v_add_f32 v185, v185, v104
    v_mfma_f32_32x32x16_bf16 a[48:63], a[244:247], v[8:11], a[48:63]
    ds_read_b128 a[196:199], v161 offset:0
    v_exp_f32 v106, v106
    v_add_f32 v185, v185, v105
    v_cvt_pk_bf16_f32 v104, v104, v105
    v_mfma_f32_32x32x16_bf16 a[112:127], a[240:243], v[32:35], a[112:127]
    v_exp_f32 v107, v107
    v_add_f32 v185, v185, v106
    v_exp_f32 v108, v108
    v_mfma_f32_32x32x16_bf16 a[112:127], a[244:247], v[40:43], a[112:127]
    v_add_f32 v185, v185, v107
    v_cvt_pk_bf16_f32 v105, v106, v107
    v_exp_f32 v109, v109
    v_mfma_f32_32x32x16_bf16 a[48:63], a[248:251], v[16:19], a[48:63]
    ds_read_b128 a[200:203], v162 offset:0
    v_add_f32 v185, v185, v108
    v_exp_f32 v110, v110
    v_mfma_f32_32x32x16_bf16 a[48:63], a[252:255], v[24:27], a[48:63]
    ds_read_b128 a[204:207], v163 offset:0
    v_add_f32 v185, v185, v109
    v_cvt_pk_bf16_f32 v106, v108, v109
    v_exp_f32 v111, v111
    v_mfma_f32_32x32x16_bf16 a[112:127], a[248:251], v[48:51], a[112:127]
    v_add_f32 v185, v185, v110
    s_nop 0
    v_add_f32 v185, v185, v111
    v_cvt_pk_bf16_f32 v107, v110, v111
    v_mfma_f32_32x32x16_bf16 a[112:127], a[252:255], v[56:59], a[112:127]
    s_add_u32 s45, s45, 262144
    s_sub_u32 s42, s42, 1
    s_cmp_eq_u32 s42, 0
    s_cbranch_scc1 L_tail1
    s_waitcnt lgkmcnt(2)
    v_mfma_f32_32x32x16_bf16 v[0:15], a[192:195], a[128:131], v[128:143]
    ds_read_b128 a[208:211], v164 offset:0
    s_cmp_ge_u32 s42, 2
    s_cselect_b32 s48, s40, 1073741824
    s_add_u32 m0, s43, 16384
    v_exp_f32 v80, v80
    v_mfma_f32_32x32x16_bf16 v[0:15], a[196:199], a[132:135], v[0:15]
    ds_read_b128 a[212:215], v165 offset:0
    buffer_load_dwordx4 v172, s[8:11], s48 offen offset:0 lds
    v_mfma_f32_32x32x16_bf16 v[32:47], a[192:195], a[160:163], v[144:159]
    v_exp_f32 v81, v81
    v_add_f32 v184, v184, v80
    v_exp_f32 v82, v82
    v_add_f32 v184, v184, v81
    v_mfma_f32_32x32x16_bf16 v[32:47], a[196:199], a[164:167], v[32:47]
    buffer_load_dwordx4 v173, s[8:11], s48 offen offset:1024 lds
    v_cvt_pk_bf16_f32 v80, v80, v81
    v_exp_f32 v83, v83
    s_waitcnt lgkmcnt(2)
    v_mfma_f32_32x32x16_bf16 v[0:15], a[200:203], a[136:139], v[0:15]
    ds_read_b128 a[216:219], v166 offset:0
    v_add_f32 v184, v184, v82
    v_exp_f32 v84, v84
    v_add_f32 v184, v184, v83
    v_mfma_f32_32x32x16_bf16 v[0:15], a[204:207], a[140:143], v[0:15]
    ds_read_b128 a[220:223], v167 offset:0
    buffer_load_dwordx4 v174, s[8:11], s48 offen offset:2048 lds
    v_cvt_pk_bf16_f32 v81, v82, v83
    v_mfma_f32_32x32x16_bf16 v[32:47], a[200:203], a[168:171], v[32:47]
    v_exp_f32 v85, v85
    v_add_f32 v184, v184, v84
    v_exp_f32 v86, v86
    v_mfma_f32_32x32x16_bf16 v[32:47], a[204:207], a[172:175], v[32:47]
    buffer_load_dwordx4 v175, s[8:11], s48 offen offset:3072 lds
    v_add_f32 v184, v184, v85
    v_cvt_pk_bf16_f32 v82, v84, v85
    s_waitcnt lgkmcnt(2)
    v_mfma_f32_32x32x16_bf16 v[0:15], a[208:211], a[144:147], v[0:15]
    ds_read_b128 a[224:227], v160 offset:8192
    s_add_u32 m0, s43, 32768
    v_exp_f32 v87, v87
    v_add_f32 v184, v184, v86
    v_mfma_f32_32x32x16_bf16 v[0:15], a[212:215], a[148:151], v[0:15]
    ds_read_b128 a[228:231], v161 offset:8192
    buffer_load_dwordx4 v176, s[12:15], s41 offen offset:0 lds
    v_exp_f32 v88, v88
    v_mfma_f32_32x32x16_bf16 v[32:47], a[208:211], a[176:179], v[32:47]
    v_add_f32 v184, v184, v87
    v_cvt_pk_bf16_f32 v83, v86, v87
    v_exp_f32 v89, v89
    v_add_f32 v184, v184, v88
    v_mfma_f32_32x32x16_bf16 v[32:47], a[212:215], a[180:183], v[32:47]
    buffer_load_dwordx4 v177, s[12:15], s41 offen offset:1024 lds
    v_exp_f32 v90, v90
    s_waitcnt lgkmcnt(2)
    v_mfma_f32_32x32x16_bf16 v[0:15], a[216:219], a[152:155], v[0:15]
    ds_read_b128 a[232:235], v162 offset:8192
    v_add_f32 v184, v184, v89
    v_cvt_pk_bf16_f32 v88, v88, v89
    v_exp_f32 v91, v91
    v_add_f32 v184, v184, v90
    v_mfma_f32_32x32x16_bf16 v[0:15], a[220:223], a[156:159], v[0:15]
    ds_read_b128 a[236:239], v163 offset:8192
    buffer_load_dwordx4 v178, s[12:15], s41 offen offset:2048 lds
    v_mfma_f32_32x32x16_bf16 v[32:47], a[216:219], a[184:187], v[32:47]
    v_exp_f32 v92, v92
    v_add_f32 v184, v184, v91
    v_cvt_pk_bf16_f32 v89, v90, v91
    v_exp_f32 v93, v93
    v_mfma_f32_32x32x16_bf16 v[32:47], a[220:223], a[188:191], v[32:47]
    buffer_load_dwordx4 v179, s[12:15], s41 offen offset:3072 lds
    v_add_f32 v184, v184, v92
    v_exp_f32 v94, v94
    s_waitcnt lgkmcnt(2)
    v_mfma_f32_32x32x16_bf16 v[16:31], a[224:227], a[128:131], v[128:143]
    ds_read_b128 a[240:243], v164 offset:8192
    v_add_f32 v184, v184, v93
    v_cvt_pk_bf16_f32 v90, v92, v93
    v_exp_f32 v95, v95
    v_mfma_f32_32x32x16_bf16 v[16:31], a[228:231], a[132:135], v[16:31]
    ds_read_b128 a[244:247], v165 offset:8192
    s_mov_b32 s41, s40
    s_add_u32 s40, s40, 262144
    v_add_f32 v184, v184, v94
    v_exp_f32 v112, v112
    v_mfma_f32_32x32x16_bf16 v[48:63], a[224:227], a[160:163], v[144:159]
    v_add_f32 v184, v184, v95
    v_cvt_pk_bf16_f32 v91, v94, v95
    v_exp_f32 v113, v113
    v_add_f32 v185, v185, v112
    v_mfma_f32_32x32x16_bf16 v[48:63], a[228:231], a[164:167], v[48:63]
    v_exp_f32 v114, v114
    v_add_f32 v185, v185, v113
    v_cvt_pk_bf16_f32 v112, v112, v113
    v_exp_f32 v115, v115
    s_waitcnt lgkmcnt(2)
    v_mfma_f32_32x32x16_bf16 v[16:31], a[232:235], a[136:139], v[16:31]
    ds_read_b128 a[248:251], v166 offset:8192
    v_add_f32 v185, v185, v114
    v_exp_f32 v116, v116
    v_add_f32 v185, v185, v115
    v_mfma_f32_32x32x16_bf16 v[16:31], a[236:239], a[140:143], v[16:31]
    ds_read_b128 a[252:255], v167 offset:8192
    v_cvt_pk_bf16_f32 v113, v114, v115
    v_exp_f32 v117, v117
    v_add_f32 v185, v185, v116
    v_mfma_f32_32x32x16_bf16 v[48:63], a[232:235], a[168:171], v[48:63]
    ds_read_b64_tr_b16 a[192:193], v168 offset:49152
    v_exp_f32 v118, v118
    v_add_f32 v185, v185, v117
    v_cvt_pk_bf16_f32 v114, v116, v117
    v_exp_f32 v119, v119
    v_mfma_f32_32x32x16_bf16 v[48:63], a[236:239], a[172:175], v[48:63]
    ds_read_b64_tr_b16 a[194:195], v168 offset:51200
    v_add_f32 v185, v185, v118
    v_exp_f32 v120, v120
    v_add_f32 v185, v185, v119
    s_waitcnt lgkmcnt(4)
    v_mfma_f32_32x32x16_bf16 v[16:31], a[240:243], a[144:147], v[16:31]
    ds_read_b64_tr_b16 a[196:197], v168 offset:53248
    v_cvt_pk_bf16_f32 v115, v118, v119
    v_exp_f32 v121, v121
    v_add_f32 v185, v185, v120
    v_mfma_f32_32x32x16_bf16 v[16:31], a[244:247], a[148:151], v[16:31]
    ds_read_b64_tr_b16 a[198:199], v168 offset:55296
    v_exp_f32 v122, v122
    v_add_f32 v185, v185, v121
    v_cvt_pk_bf16_f32 v120, v120, v121
    v_exp_f32 v123, v123
    v_mfma_f32_32x32x16_bf16 v[48:63], a[240:243], a[176:179], v[48:63]
    ds_read_b64_tr_b16 a[200:201], v168 offset:57344
    v_add_f32 v185, v185, v122
    v_exp_f32 v124, v124
    v_add_f32 v185, v185, v123
    v_mfma_f32_32x32x16_bf16 v[48:63], a[244:247], a[180:183], v[48:63]
    ds_read_b64_tr_b16 a[202:203], v168 offset:59392
    v_cvt_pk_bf16_f32 v121, v122, v123
    v_exp_f32 v125, v125
    v_add_f32 v185, v185, v124
    s_waitcnt lgkmcnt(6)
    v_mfma_f32_32x32x16_bf16 v[16:31], a[248:251], a[152:155], v[16:31]
    ds_read_b64_tr_b16 a[204:205], v168 offset:61440
    v_exp_f32 v126, v126
    v_add_f32 v185, v185, v125
    v_cvt_pk_bf16_f32 v122, v124, v125
    v_exp_f32 v127, v127
    v_mfma_f32_32x32x16_bf16 v[16:31], a[252:255], a[156:159], v[16:31]
    ds_read_b64_tr_b16 a[206:207], v168 offset:63488
    v_add_f32 v185, v185, v126
    s_nop 0
    v_add_f32 v185, v185, v127
    v_cvt_pk_bf16_f32 v123, v126, v127
    v_mfma_f32_32x32x16_bf16 v[48:63], a[248:251], a[184:187], v[48:63]
    ds_read_b64_tr_b16 a[208:209], v169 offset:49152
    v_max_f32 v188, v184, v185
    v_mfma_f32_32x32x16_bf16 v[48:63], a[252:255], a[188:191], v[48:63]
    ds_read_b64_tr_b16 a[210:211], v169 offset:51200
    v_cmp_nge_f32 vcc, s44, v188
    s_cbranch_vccnz L_stub_A1
L_back_A1:
    s_waitcnt lgkmcnt(6)
    v_mfma_f32_32x32x16_bf16 a[0:15], a[192:195], v[64:67], a[0:15]
    ds_read_b64_tr_b16 a[212:213], v169 offset:53248
    v_add_f32 v182, v182, v184
    v_add_f32 v183, v183, v185
    v_exp_f32 v0, v0
    v_mfma_f32_32x32x16_bf16 a[0:15], a[196:199], v[72:75], a[0:15]
    ds_read_b64_tr_b16 a[214:215], v169 offset:55296
    v_exp_f32 v1, v1
    v_exp_f32 v2, v2
    v_mfma_f32_32x32x16_bf16 a[64:79], a[192:195], v[96:99], a[64:79]
    ds_read_b64_tr_b16 a[216:217], v169 offset:57344
    v_add_f32 v184, v0, v1
    v_cvt_pk_bf16_f32 v0, v0, v1
    v_mfma_f32_32x32x16_bf16 a[64:79], a[196:199], v[104:107], a[64:79]
    ds_read_b64_tr_b16 a[218:219], v169 offset:59392
    v_exp_f32 v3, v3
    v_add_f32 v184, v184, v2
    v_exp_f32 v4, v4
    s_waitcnt lgkmcnt(6)
    v_mfma_f32_32x32x16_bf16 a[0:15], a[200:203], v[80:83], a[0:15]
    ds_read_b64_tr_b16 a[220:221], v169 offset:61440
    v_add_f32 v184, v184, v3
    v_cvt_pk_bf16_f32 v1, v2, v3
    v_exp_f32 v5, v5
    v_mfma_f32_32x32x16_bf16 a[0:15], a[204:207], v[88:91], a[0:15]
    ds_read_b64_tr_b16 a[222:223], v169 offset:63488
    v_add_f32 v184, v184, v4
    v_exp_f32 v6, v6
    v_mfma_f32_32x32x16_bf16 a[64:79], a[200:203], v[112:115], a[64:79]
    ds_read_b64_tr_b16 a[224:225], v170 offset:49152
    v_add_f32 v184, v184, v5
    v_cvt_pk_bf16_f32 v2, v4, v5
    v_exp_f32 v7, v7
    v_mfma_f32_32x32x16_bf16 a[64:79], a[204:207], v[120:123], a[64:79]
    ds_read_b64_tr_b16 a[226:227], v170 offset:51200
    v_add_f32 v184, v184, v6
    v_exp_f32 v8, v8
    s_waitcnt lgkmcnt(6)
    v_mfma_f32_32x32x16_bf16 a[16:31], a[208:211], v[64:67], a[16:31]
    ds_read_b64_tr_b16 a[228:229], v170 offset:53248
    v_add_f32 v184, v184, v7
    v_cvt_pk_bf16_f32 v3, v6, v7
    v_exp_f32 v9, v9
    v_mfma_f32_32x32x16_bf16 a[16:31], a[212:215], v[72:75], a[16:31]
    ds_read_b64_tr_b16 a[230:231], v170 offset:55296
    v_add_f32 v184, v184, v8
    v_exp_f32 v10, v10
    v_mfma_f32_32x32x16_bf16 a[80:95], a[208:211], v[96:99], a[80:95]
    ds_read_b64_tr_b16 a[232:233], v170 offset:57344
    v_add_f32 v184, v184, v9
    v_cvt_pk_bf16_f32 v8, v8, v9
    v_exp_f32 v11, v11
    v_mfma_f32_32x32x16_bf16 a[80:95], a[212:215], v[104:107], a[80:95]
    ds_read_b64_tr_b16 a[234:235], v170 offset:59392
    v_add_f32 v184, v184, v10
    v_exp_f32 v12, v12
    s_waitcnt lgkmcnt(6)
    v_mfma_f32_32x32x16_bf16 a[16:31], a[216:219], v[80:83], a[16:31]
    ds_read_b64_tr_b16 a[236:237], v170 offset:61440
    v_add_f32 v184, v184, v11
    v_cvt_pk_bf16_f32 v9, v10, v11
    v_exp_f32 v13, v13
    v_mfma_f32_32x32x16_bf16 a[16:31], a[220:223], v[88:91], a[16:31]
    ds_read_b64_tr_b16 a[238:239], v170 offset:63488
    v_add_f32 v184, v184, v12
    v_exp_f32 v14, v14
    v_add_f32 v184, v184, v13
    v_mfma_f32_32x32x16_bf16 a[80:95], a[216:219], v[112:115], a[80:95]
    ds_read_b64_tr_b16 a[240:241], v171 offset:49152
    v_cvt_pk_bf16_f32 v10, v12, v13
    v_exp_f32 v15, v15
    v_mfma_f32_32x32x16_bf16 a[80:95], a[220:223], v[120:123], a[80:95]
    ds_read_b64_tr_b16 a[242:243], v171 offset:51200
    v_add_f32 v184, v184, v14
    v_exp_f32 v32, v32
    v_add_f32 v184, v184, v15
    s_waitcnt lgkmcnt(6)
    v_mfma_f32_32x32x16_bf16 a[32:47], a[224:227], v[64:67], a[32:47]
    ds_read_b64_tr_b16 a[244:245], v171 offset:53248
    v_cvt_pk_bf16_f32 v11, v14, v15
    v_exp_f32 v33, v33
    v_mfma_f32_32x32x16_bf16 a[32:47], a[228:231], v[72:75], a[32:47]
    ds_read_b64_tr_b16 a[246:247], v171 offset:55296
    v_exp_f32 v34, v34
    v_add_f32 v185, v32, v33
    v_cvt_pk_bf16_f32 v32, v32, v33
    v_mfma_f32_32x32x16_bf16 a[96:111], a[224:227], v[96:99], a[96:111]
    ds_read_b64_tr_b16 a[248:249], v171 offset:57344
    v_exp_f32 v35, v35
    v_add_f32 v185, v185, v34
    v_mfma_f32_32x32x16_bf16 a[96:111], a[228:231], v[104:107], a[96:111]
    ds_read_b64_tr_b16 a[250:251], v171 offset:59392
    v_exp_f32 v36, v36
    v_add_f32 v185, v185, v35
    v_cvt_pk_bf16_f32 v33, v34, v35
    s_waitcnt lgkmcnt(6)
    v_mfma_f32_32x32x16_bf16 a[32:47], a[232:235], v[80:83], a[32:47]
    ds_read_b64_tr_b16 a[252:253], v171 offset:61440
    v_exp_f32 v37, v37
    v_add_f32 v185, v185, v36
    v_exp_f32 v38, v38
    v_mfma_f32_32x32x16_bf16 a[32:47], a[236:239], v[88:91], a[32:47]
    ds_read_b64_tr_b16 a[254:255], v171 offset:63488
    v_add_f32 v185, v185, v37
    v_cvt_pk_bf16_f32 v34, v36, v37
    v_mfma_f32_32x32x16_bf16 a[96:111], a[232:235], v[112:115], a[96:111]
    v_exp_f32 v39, v39
    v_add_f32 v185, v185, v38
    v_exp_f32 v40, v40
    v_mfma_f32_32x32x16_bf16 a[96:111], a[236:239], v[120:123], a[96:111]
    s_waitcnt vmcnt(0) lgkmcnt(0)
    s_barrier
    s_cmp_le_u32 s42, s81
    s_cbranch_scc1 L_evstub_1
    L_evback_1:
    v_add_f32 v185, v185, v39
    v_mfma_f32_32x32x16_bf16 a[48:63], a[240:243], v[64:67], a[48:63]
    ds_read_b128 a[192:195], v160 offset:16384
    v_cvt_pk_bf16_f32 v35, v38, v39
    v_exp_f32 v41, v41
    v_add_f32 v185, v185, v40
    v_mfma_f32_32x32x16_bf16 a[48:63], a[244:247], v[72:75], a[48:63]
    ds_read_b128 a[196:199], v161 offset:16384
    v_exp_f32 v42, v42
    v_add_f32 v185, v185, v41
    v_cvt_pk_bf16_f32 v40, v40, v41
    v_mfma_f32_32x32x16_bf16 a[112:127], a[240:243], v[96:99], a[112:127]
    v_exp_f32 v43, v43
    v_add_f32 v185, v185, v42
    v_exp_f32 v44, v44
    v_mfma_f32_32x32x16_bf16 a[112:127], a[244:247], v[104:107], a[112:127]
    v_add_f32 v185, v185, v43
    v_cvt_pk_bf16_f32 v41, v42, v43
    v_exp_f32 v45, v45
    v_mfma_f32_32x32x16_bf16 a[48:63], a[248:251], v[80:83], a[48:63]
    ds_read_b128 a[200:203], v162 offset:16384
    v_add_f32 v185, v185, v44
    v_exp_f32 v46, v46
    v_mfma_f32_32x32x16_bf16 a[48:63], a[252:255], v[88:91], a[48:63]
    ds_read_b128 a[204:207], v163 offset:16384
    v_add_f32 v185, v185, v45
    v_cvt_pk_bf16_f32 v42, v44, v45
    v_exp_f32 v47, v47
    v_mfma_f32_32x32x16_bf16 a[112:127], a[248:251], v[112:115], a[112:127]
    v_add_f32 v185, v185, v46
    s_nop 0
    v_add_f32 v185, v185, v47
    v_cvt_pk_bf16_f32 v43, v46, v47
    v_mfma_f32_32x32x16_bf16 a[112:127], a[252:255], v[120:123], a[112:127]
    s_add_u32 s45, s45, 262144
    s_sub_u32 s42, s42, 1
    s_cmp_eq_u32 s42, 0
    s_cbranch_scc0 L_loopA
    s_branch L_tail0
.p2align 6
L_loopB:
    s_waitcnt lgkmcnt(2)
    v_mfma_f32_32x32x16_bf16 v[64:79], a[192:195], a[128:131], v[128:143]
    ds_read_b128 a[208:211], v164 offset:16384
    s_cmp_ge_u32 s42, 2
    s_cselect_b32 s48, s40, 1073741824
    s_add_u32 m0, s43, 0
    v_exp_f32 v16, v16
    v_mfma_f32_32x32x16_bf16 v[64:79], a[196:199], a[132:135], v[64:79]
    ds_read_b128 a[212:215], v165 offset:16384
    buffer_load_dwordx4 v172, s[8:11], s48 offen offset:0 lds
    v_exp_f32 v17, v17
    v_mfma_f32_32x32x16_bf16 v[96:111], a[192:195], a[160:163], v[144:159]
    buffer_load_dwordx4 v173, s[8:11], s48 offen offset:1024 lds
    v_add_f32 v184, v184, v16
    v_exp_f32 v18, v18
    v_mfma_f32_32x32x16_bf16 v[96:111], a[196:199], a[164:167], v[96:111]
    buffer_load_dwordx4 v174, s[8:11], s48 offen offset:2048 lds
    v_add_f32 v184, v184, v17
    v_cvt_pk_bf16_f32 v16, v16, v17
    s_waitcnt lgkmcnt(2)
    v_mfma_f32_32x32x16_bf16 v[64:79], a[200:203], a[136:139], v[64:79]
    ds_read_b128 a[216:219], v166 offset:16384
    buffer_load_dwordx4 v175, s[8:11], s48 offen offset:3072 lds
    s_add_u32 s49, s48, 65536
    s_add_u32 m0, s43, 4096
    v_mfma_f32_32x32x16_bf16 v[64:79], a[204:207], a[140:143], v[64:79]
    ds_read_b128 a[220:223], v167 offset:16384
    buffer_load_dwordx4 v172, s[8:11], s49 offen offset:0 lds
    v_exp_f32 v19, v19
    v_mfma_f32_32x32x16_bf16 v[96:111], a[200:203], a[168:171], v[96:111]
    buffer_load_dwordx4 v173, s[8:11], s49 offen offset:1024 lds
    v_add_f32 v184, v184, v18
    v_mfma_f32_32x32x16_bf16 v[96:111], a[204:207], a[172:175], v[96:111]
    buffer_load_dwordx4 v174, s[8:11], s49 offen offset:2048 lds
    v_exp_f32 v20, v20
    v_add_f32 v184, v184, v19
    s_waitcnt lgkmcnt(2)
    v_mfma_f32_32x32x16_bf16 v[64:79], a[208:211], a[144:147], v[64:79]
    ds_read_b128 a[224:227], v160 offset:24576
    buffer_load_dwordx4 v175, s[8:11], s49 offen offset:3072 lds
    s_add_u32 m0, s43, 49152
    v_mfma_f32_32x32x16_bf16 v[64:79], a[212:215], a[148:151], v[64:79]
    ds_read_b128 a[228:231], v161 offset:24576
    buffer_load_dwordx4 v176, s[12:15], s41 offen offset:0 lds
    v_cvt_pk_bf16_f32 v17, v18, v19
    v_mfma_f32_32x32x16_bf16 v[96:111], a[208:211], a[176:179], v[96:111]
    buffer_load_dwordx4 v177, s[12:15], s41 offen offset:1024 lds
    v_exp_f32 v21, v21
    v_add_f32 v184, v184, v20
    v_mfma_f32_32x32x16_bf16 v[96:111], a[212:215], a[180:183], v[96:111]
    buffer_load_dwordx4 v178, s[12:15], s41 offen offset:2048 lds
    v_exp_f32 v22, v22
    v_add_f32 v184, v184, v21
    s_waitcnt lgkmcnt(2)
    v_mfma_f32_32x32x16_bf16 v[64:79], a[216:219], a[152:155], v[64:79]
    ds_read_b128 a[232:235], v162 offset:24576
    buffer_load_dwordx4 v179, s[12:15], s41 offen offset:3072 lds
    s_add_u32 s49, s41, 65536
    s_add_u32 m0, s43, 53248
    v_mfma_f32_32x32x16_bf16 v[64:79], a[220:223], a[156:159], v[64:79]
    ds_read_b128 a[236:239], v163 offset:24576
    buffer_load_dwordx4 v176, s[12:15], s49 offen offset:0 lds
    v_cvt_pk_bf16_f32 v18, v20, v21
    v_mfma_f32_32x32x16_bf16 v[96:111], a[216:219], a[184:187], v[96:111]
    buffer_load_dwordx4 v177, s[12:15], s49 offen offset:1024 lds
    v_exp_f32 v23, v23
    v_add_f32 v184, v184, v22
    v_mfma_f32_32x32x16_bf16 v[96:111], a[220:223], a[188:191], v[96:111]
    buffer_load_dwordx4 v178, s[12:15], s49 offen offset:2048 lds
    v_exp_f32 v24, v24
    s_waitcnt lgkmcnt(2)
    v_mfma_f32_32x32x16_bf16 v[80:95], a[224:227], a[128:131], v[128:143]
    ds_read_b128 a[240:243], v164 offset:24576
    buffer_load_dwordx4 v179, s[12:15], s49 offen offset:3072 lds
    v_add_f32 v184, v184, v23
    v_cvt_pk_bf16_f32 v19, v22, v23
    v_mfma_f32_32x32x16_bf16 v[80:95], a[228:231], a[132:135], v[80:95]
    ds_read_b128 a[244:247], v165 offset:24576
    s_mov_b32 s41, s40
    s_add_u32 s40, s40, 262144
    v_exp_f32 v25, v25
    v_add_f32 v184, v184, v24
    v_mfma_f32_32x32x16_bf16 v[112:127], a[224:227], a[160:163], v[144:159]
    v_exp_f32 v26, v26
    v_add_f32 v184, v184, v25
    v_cvt_pk_bf16_f32 v24, v24, v25
    v_exp_f32 v27, v27
    v_add_f32 v184, v184, v26
    v_exp_f32 v28, v28
    v_mfma_f32_32x32x16_bf16 v[112:127], a[228:231], a[164:167], v[112:127]
    v_add_f32 v184, v184, v27
    v_cvt_pk_bf16_f32 v25, v26, v27
    v_exp_f32 v29, v29
    v_add_f32 v184, v184, v28
    v_exp_f32 v30, v30
    s_waitcnt lgkmcnt(2)
    v_mfma_f32_32x32x16_bf16 v[80:95], a[232:235], a[136:139], v[80:95]
    ds_read_b128 a[248:251], v166 offset:24576
    v_add_f32 v184, v184, v29
    v_cvt_pk_bf16_f32 v26, v28, v29
    v_exp_f32 v31, v31
    v_add_f32 v184, v184, v30
    v_exp_f32 v48, v48
    v_mfma_f32_32x32x16_bf16 v[80:95], a[236:239], a[140:143], v[80:95]
    ds_read_b128 a[252:255], v167 offset:24576
    v_add_f32 v184, v184, v31
    v_cvt_pk_bf16_f32 v27, v30, v31
    v_exp_f32 v49, v49
    v_add_f32 v185, v185, v48
    v_mfma_f32_32x32x16_bf16 v[112:127], a[232:235], a[168:171], v[112:127]
    ds_read_b64_tr_b16 a[192:193], v168 offset:32768
    v_exp_f32 v50, v50
    v_add_f32 v185, v185, v49
    v_cvt_pk_bf16_f32 v48, v48, v49
    v_exp_f32 v51, v51
    v_add_f32 v185, v185, v50
    v_mfma_f32_32x32x16_bf16 v[112:127], a[236:239], a[172:175], v[112:127]
    ds_read_b64_tr_b16 a[194:195], v168 offset:34816
    v_exp_f32 v52, v52
    v_add_f32 v185, v185, v51
    v_cvt_pk_bf16_f32 v49, v50, v51
    v_exp_f32 v53, v53
    s_waitcnt lgkmcnt(4)
    v_mfma_f32_32x32x16_bf16 v[80:95], a[240:243], a[144:147], v[80:95]
    ds_read_b64_tr_b16 a[196:197], v168 offset:36864
    v_add_f32 v185, v185, v52
    v_exp_f32 v54, v54
    v_add_f32 v185, v185, v53
    v_cvt_pk_bf16_f32 v50, v52, v53
    v_exp_f32 v55, v55
    v_mfma_f32_32x32x16_bf16 v[80:95], a[244:247], a[148:151], v[80:95]
    ds_read_b64_tr_b16 a[198:199], v168 offset:38912
    v_add_f32 v185, v185, v54
    v_exp_f32 v56, v56
    v_add_f32 v185, v185, v55
    v_cvt_pk_bf16_f32 v51, v54, v55
    v_exp_f32 v57, v57
    v_mfma_f32_32x32x16_bf16 v[112:127], a[240:243], a[176:179], v[112:127]
    ds_read_b64_tr_b16 a[200:201], v168 offset:40960
    v_add_f32 v185, v185, v56
    v_exp_f32 v58, v58
    v_add_f32 v185, v185, v57
    v_cvt_pk_bf16_f32 v56, v56, v57
    v_mfma_f32_32x32x16_bf16 v[112:127], a[244:247], a[180:183], v[112:127]
    ds_read_b64_tr_b16 a[202:203], v168 offset:43008
    v_exp_f32 v59, v59
    v_add_f32 v185, v185, v58
    v_exp_f32 v60, v60
    v_add_f32 v185, v185, v59
    v_cvt_pk_bf16_f32 v57, v58, v59
    s_waitcnt lgkmcnt(6)
    v_mfma_f32_32x32x16_bf16 v[80:95], a[248:251], a[152:155], v[80:95]
    ds_read_b64_tr_b16 a[204:205], v168 offset:45056
    v_exp_f32 v61, v61
    v_add_f32 v185, v185, v60
    v_exp_f32 v62, v62
    v_add_f32 v185, v185, v61
    v_cvt_pk_bf16_f32 v58, v60, v61
    v_mfma_f32_32x32x16_bf16 v[80:95], a[252:255], a[156:159], v[80:95]
    ds_read_b64_tr_b16 a[206:207], v168 offset:47104
    v_exp_f32 v63, v63
    v_add_f32 v185, v185, v62
    s_nop 0
    v_add_f32 v185, v185, v63
    v_cvt_pk_bf16_f32 v59, v62, v63
    v_mfma_f32_32x32x16_bf16 v[112:127], a[248:251], a[184:187], v[112:127]
    ds_read_b64_tr_b16 a[208:209], v169 offset:32768
    v_max_f32 v188, v184, v185
    v_mfma_f32_32x32x16_bf16 v[112:127], a[252:255], a[188:191], v[112:127]
    ds_read_b64_tr_b16 a[210:211], v169 offset:34816
    v_cmp_nge_f32 vcc, s44, v188
    s_cbranch_vccnz L_stub_B0
L_back_B0:
    s_waitcnt lgkmcnt(6)
    v_mfma_f32_32x32x16_bf16 a[0:15], a[192:195], v[0:3], a[0:15]
    ds_read_b64_tr_b16 a[212:213], v169 offset:36864
    v_add_f32 v182, v182, v184
    v_add_f32 v183, v183, v185
    v_exp_f32 v64, v64
    v_mfma_f32_32x32x16_bf16 a[0:15], a[196:199], v[8:11], a[0:15]
    ds_read_b64_tr_b16 a[214:215], v169 offset:38912
    v_exp_f32 v65, v65
    v_exp_f32 v66, v66
    v_mfma_f32_32x32x16_bf16 a[64:79], a[192:195], v[32:35], a[64:79]
    ds_read_b64_tr_b16 a[216:217], v169 offset:40960
    v_add_f32 v184, v64, v65
    v_cvt_pk_bf16_f32 v64, v64, v65
    v_mfma_f32_32x32x16_bf16 a[64:79], a[196:199], v[40:43], a[64:79]
    ds_read_b64_tr_b16 a[218:219], v169 offset:43008
    v_exp_f32 v67, v67
    v_add_f32 v184, v184, v66
    v_exp_f32 v68, v68
    s_waitcnt lgkmcnt(6)
    v_mfma_f32_32x32x16_bf16 a[0:15], a[200:203], v[16:19], a[0:15]
    ds_read_b64_tr_b16 a[220:221], v169 offset:45056
    v_add_f32 v184, v184, v67
    v_cvt_pk_bf16_f32 v65, v66, v67
    v_exp_f32 v69, v69
    v_mfma_f32_32x32x16_bf16 a[0:15], a[204:207], v[24:27], a[0:15]
    ds_read_b64_tr_b16 a[222:223], v169 offset:47104
    v_add_f32 v184, v184, v68
    v_exp_f32 v70, v70
    v_mfma_f32_32x32x16_bf16 a[64:79], a[200:203], v[48:51], a[64:79]
    ds_read_b64_tr_b16 a[224:225], v170 offset:32768
    v_add_f32 v184, v184, v69
    v_cvt_pk_bf16_f32 v66, v68, v69
    v_exp_f32 v71, v71
    v_mfma_f32_32x32x16_bf16 a[64:79], a[204:207], v[56:59], a[64:79]
    ds_read_b64_tr_b16 a[226:227], v170 offset:34816
    v_add_f32 v184, v184, v70
    v_exp_f32 v72, v72
    s_waitcnt lgkmcnt(6)
    v_mfma_f32_32x32x16_bf16 a[16:31], a[208:211], v[0:3], a[16:31]
    ds_read_b64_tr_b16 a[228:229], v170 offset:36864
    v_add_f32 v184, v184, v71
    v_cvt_pk_bf16_f32 v67, v70, v71
    v_exp_f32 v73, v73
    v_mfma_f32_32x32x16_bf16 a[16:31], a[212:215], v[8:11], a[16:31]
    ds_read_b64_tr_b16 a[230:231], v170 offset:38912
    v_add_f32 v184, v184, v72
    v_exp_f32 v74, v74
    v_mfma_f32_32x32x16_bf16 a[80:95], a[208:211], v[32:35], a[80:95]
    ds_read_b64_tr_b16 a[232:233], v170 offset:40960
    v_add_f32 v184, v184, v73
    v_cvt_pk_bf16_f32 v72, v72, v73
    v_exp_f32 v75, v75
    v_mfma_f32_32x32x16_bf16 a[80:95], a[212:215], v[40:43], a[80:95]
    ds_read_b64_tr_b16 a[234:235], v170 offset:43008
    v_add_f32 v184, v184, v74
    v_exp_f32 v76, v76
    s_waitcnt lgkmcnt(6)
    v_mfma_f32_32x32x16_bf16 a[16:31], a[216:219], v[16:19], a[16:31]
    ds_read_b64_tr_b16 a[236:237], v170 offset:45056
    v_add_f32 v184, v184, v75
    v_cvt_pk_bf16_f32 v73, v74, v75
    v_exp_f32 v77, v77
    v_mfma_f32_32x32x16_bf16 a[16:31], a[220:223], v[24:27], a[16:31]
    ds_read_b64_tr_b16 a[238:239], v170 offset:47104
    v_add_f32 v184, v184, v76
    v_exp_f32 v78, v78
    v_add_f32 v184, v184, v77
    v_mfma_f32_32x32x16_bf16 a[80:95], a[216:219], v[48:51], a[80:95]
    ds_read_b64_tr_b16 a[240:241], v171 offset:32768
    v_cvt_pk_bf16_f32 v74, v76, v77
    v_exp_f32 v79, v79
    v_mfma_f32_32x32x16_bf16 a[80:95], a[220:223], v[56:59], a[80:95]
    ds_read_b64_tr_b16 a[242:243], v171 offset:34816
    v_add_f32 v184, v184, v78
    v_exp_f32 v96, v96
    v_add_f32 v184, v184, v79
    s_waitcnt lgkmcnt(6)
    v_mfma_f32_32x32x16_bf16 a[32:47], a[224:227], v[0:3], a[32:47]
    ds_read_b64_tr_b16 a[244:245], v171 offset:36864
    v_cvt_pk_bf16_f32 v75, v78, v79
    v_exp_f32 v97, v97
    v_mfma_f32_32x32x16_bf16 a[32:47], a[228:231], v[8:11], a[32:47]
    ds_read_b64_tr_b16 a[246:247], v171 offset:38912
    v_exp_f32 v98, v98
    v_add_f32 v185, v96, v97
    v_cvt_pk_bf16_f32 v96, v96, v97
    v_mfma_f32_32x32x16_bf16 a[96:111], a[224:227], v[32:35], a[96:111]
    ds_read_b64_tr_b16 a[248:249], v171 offset:40960
    v_exp_f32 v99, v99
    v_add_f32 v185, v185, v98
    v_mfma_f32_32x32x16_bf16 a[96:111], a[228:231], v[40:43], a[96:111]
    ds_read_b64_tr_b16 a[250:251], v171 offset:43008
    v_exp_f32 v100, v100
    v_add_f32 v185, v185, v99
    v_cvt_pk_bf16_f32 v97, v98, v99
    s_waitcnt lgkmcnt(6)
    v_mfma_f32_32x32x16_bf16 a[32:47], a[232:235], v[16:19], a[32:47]
    ds_read_b64_tr_b16 a[252:253], v171 offset:45056
    v_exp_f32 v101, v101
    v_add_f32 v185, v185, v100
    v_exp_f32 v102, v102
    v_mfma_f32_32x32x16_bf16 a[32:47], a[236:239], v[24:27], a[32:47]
    ds_read_b64_tr_b16 a[254:255], v171 offset:47104
    v_add_f32 v185, v185, v101
    v_cvt_pk_bf16_f32 v98, v100, v101
    v_mfma_f32_32x32x16_bf16 a[96:111], a[232:235], v[48:51], a[96:111]
    v_exp_f32 v103, v103
    v_add_f32 v185, v185, v102
    v_exp_f32 v104, v104
    v_mfma_f32_32x32x16_bf16 a[96:111], a[236:239], v[56:59], a[96:111]
    s_waitcnt vmcnt(0) lgkmcnt(0)
    s_barrier
    s_cmp_le_u32 s42, s81
    s_cbranch_scc1 L_evstub_2
    L_evback_2:
    v_add_f32 v185, v185, v103
    v_mfma_f32_32x32x16_bf16 a[48:63], a[240:243], v[0:3], a[48:63]
    ds_read_b128 a[192:195], v160 offset:0
    v_cvt_pk_bf16_f32 v99, v102, v103
    v_exp_f32 v105, v105
    v_add_f32 v185, v185, v104
    v_mfma_f32_32x32x16_bf16 a[48:63], a[244:247], v[8:11], a[48:63]
    ds_read_b128 a[196:199], v161 offset:0
    v_exp_f32 v106, v106
    v_add_f32 v185, v185, v105
    v_cvt_pk_bf16_f32 v104, v104, v105
    v_mfma_f32_32x32x16_bf16 a[112:127], a[240:243], v[32:35], a[112:127]
    v_exp_f32 v107, v107
    v_add_f32 v185, v185, v106
    v_exp_f32 v108, v108
    v_mfma_f32_32x32x16_bf16 a[112:127], a[244:247], v[40:43], a[112:127]
    v_add_f32 v185, v185, v107
    v_cvt_pk_bf16_f32 v105, v106, v107
    v_exp_f32 v109, v109
    v_mfma_f32_32x32x16_bf16 a[48:63], a[248:251], v[16:19], a[48:63]
    ds_read_b128 a[200:203], v162 offset:0
    v_add_f32 v185, v185, v108
    v_exp_f32 v110, v110
    v_mfma_f32_32x32x16_bf16 a[48:63], a[252:255], v[24:27], a[48:63]
    ds_read_b128 a[204:207], v163 offset:0
    v_add_f32 v185, v185, v109
    v_cvt_pk_bf16_f32 v106, v108, v109
    v_exp_f32 v111, v111
    v_mfma_f32_32x32x16_bf16 a[112:127], a[248:251], v[48:51], a[112:127]
    v_add_f32 v185, v185, v110
    s_nop 0
    v_add_f32 v185, v185, v111
    v_cvt_pk_bf16_f32 v107, v110, v111
    v_mfma_f32_32x32x16_bf16 a[112:127], a[252:255], v[56:59], a[112:127]
    s_add_u32 s45, s45, 262144
    s_sub_u32 s42, s42, 1
    s_cmp_eq_u32 s42, 0
    s_cbranch_scc1 L_tail1
    s_waitcnt lgkmcnt(2)
    v_mfma_f32_32x32x16_bf16 v[0:15], a[192:195], a[128:131], v[128:143]
    ds_read_b128 a[208:211], v164 offset:0
    s_cmp_ge_u32 s42, 2
    s_cselect_b32 s48, s40, 1073741824
    s_add_u32 m0, s43, 16384
    v_exp_f32 v80, v80
    v_mfma_f32_32x32x16_bf16 v[0:15], a[196:199], a[132:135], v[0:15]
    ds_read_b128 a[212:215], v165 offset:0
    buffer_load_dwordx4 v172, s[8:11], s48 offen offset:0 lds
    v_exp_f32 v81, v81
    v_mfma_f32_32x32x16_bf16 v[32:47], a[192:195], a[160:163], v[144:159]
    buffer_load_dwordx4 v173, s[8:11], s48 offen offset:1024 lds
    v_add_f32 v184, v184, v80
    v_exp_f32 v82, v82
    v_mfma_f32_32x32x16_bf16 v[32:47], a[196:199], a[164:167], v[32:47]
    buffer_load_dwordx4 v174, s[8:11], s48 offen offset:2048 lds
    v_add_f32 v184, v184, v81
    v_cvt_pk_bf16_f32 v80, v80, v81
    s_waitcnt lgkmcnt(2)
    v_mfma_f32_32x32x16_bf16 v[0:15], a[200:203], a[136:139], v[0:15]
    ds_read_b128 a[216:219], v166 offset:0
    buffer_load_dwordx4 v175, s[8:11], s48 offen offset:3072 lds
    s_add_u32 s49, s48, 65536
    s_add_u32 m0, s43, 20480
    v_mfma_f32_32x32x16_bf16 v[0:15], a[204:207], a[140:143], v[0:15]
    ds_read_b128 a[220:223], v167 offset:0
    buffer_load_dwordx4 v172, s[8:11], s49 offen offset:0 lds
    v_exp_f32 v83, v83
    v_mfma_f32_32x32x16_bf16 v[32:47], a[200:203], a[168:171], v[32:47]
    buffer_load_dwordx4 v173, s[8:11], s49 offen offset:1024 lds
    v_add_f32 v184, v184, v82
    v_mfma_f32_32x32x16_bf16 v[32:47], a[204:207], a[172:175], v[32:47]
    buffer_load_dwordx4 v174, s[8:11], s49 offen offset:2048 lds
    v_exp_f32 v84, v84
    v_add_f32 v184, v184, v83
    s_waitcnt lgkmcnt(2)
    v_mfma_f32_32x32x16_bf16 v[0:15], a[208:211], a[144:147], v[0:15]
    ds_read_b128 a[224:227], v160 offset:8192
    buffer_load_dwordx4 v175, s[8:11], s49 offen offset:3072 lds
    s_add_u32 m0, s43, 32768
    v_mfma_f32_32x32x16_bf16 v[0:15], a[212:215], a[148:151], v[0:15]
    ds_read_b128 a[228:231], v161 offset:8192
    buffer_load_dwordx4 v176, s[12:15], s41 offen offset:0 lds
    v_cvt_pk_bf16_f32 v81, v82, v83
    v_mfma_f32_32x32x16_bf16 v[32:47], a[208:211], a[176:179], v[32:47]
    buffer_load_dwordx4 v177, s[12:15], s41 offen offset:1024 lds
    v_exp_f32 v85, v85
    v_add_f32 v184, v184, v84
    v_mfma_f32_32x32x16_bf16 v[32:47], a[212:215], a[180:183], v[32:47]
    buffer_load_dwordx4 v178, s[12:15], s41 offen offset:2048 lds
    v_exp_f32 v86, v86
    v_add_f32 v184, v184, v85
    s_waitcnt lgkmcnt(2)
    v_mfma_f32_32x32x16_bf16 v[0:15], a[216:219], a[152:155], v[0:15]
    ds_read_b128 a[232:235], v162 offset:8192
    buffer_load_dwordx4 v179, s[12:15], s41 offen offset:3072 lds
    s_add_u32 s49, s41, 65536
    s_add_u32 m0, s43, 36864
    v_mfma_f32_32x32x16_bf16 v[0:15], a[220:223], a[156:159], v[0:15]
    ds_read_b128 a[236:239], v163 offset:8192
    buffer_load_dwordx4 v176, s[12:15], s49 offen offset:0 lds
    v_cvt_pk_bf16_f32 v82, v84, v85
    v_mfma_f32_32x32x16_bf16 v[32:47], a[216:219], a[184:187], v[32:47]
    buffer_load_dwordx4 v177, s[12:15], s49 offen offset:1024 lds
    v_exp_f32 v87, v87
    v_add_f32 v184, v184, v86
    v_mfma_f32_32x32x16_bf16 v[32:47], a[220:223], a[188:191], v[32:47]
    buffer_load_dwordx4 v178, s[12:15], s49 offen offset:2048 lds
    v_exp_f32 v88, v88
    s_waitcnt lgkmcnt(2)
    v_mfma_f32_32x32x16_bf16 v[16:31], a[224:227], a[128:131], v[128:143]
    ds_read_b128 a[240:243], v164 offset:8192
    buffer_load_dwordx4 v179, s[12:15], s49 offen offset:3072 lds
    v_add_f32 v184, v184, v87
    v_cvt_pk_bf16_f32 v83, v86, v87
    v_mfma_f32_32x32x16_bf16 v[16:31], a[228:231], a[132:135], v[16:31]
    ds_read_b128 a[244:247], v165 offset:8192
    s_mov_b32 s41, s40
    s_add_u32 s40, s40, 262144
    v_exp_f32 v89, v89
    v_add_f32 v184, v184, v88
    v_mfma_f32_32x32x16_bf16 v[48:63], a[224:227], a[160:163], v[144:159]
    v_exp_f32 v90, v90
    v_add_f32 v184, v184, v89
    v_cvt_pk_bf16_f32 v88, v88, v89
    v_exp_f32 v91, v91
    v_add_f32 v184, v184, v90
    v_exp_f32 v92, v92
    v_mfma_f32_32x32x16_bf16 v[48:63], a[228:231], a[164:167], v[48:63]
    v_add_f32 v184, v184, v91
    v_cvt_pk_bf16_f32 v89, v90, v91
    v_exp_f32 v93, v93
    v_add_f32 v184, v184, v92
    v_exp_f32 v94, v94
    s_waitcnt lgkmcnt(2)
    v_mfma_f32_32x32x16_bf16 v[16:31], a[232:235], a[136:139], v[16:31]
    ds_read_b128 a[248:251], v166 offset:8192
    v_add_f32 v184, v184, v93
    v_cvt_pk_bf16_f32 v90, v92, v93
    v_exp_f32 v95, v95
    v_add_f32 v184, v184, v94
    v_exp_f32 v112, v112
    v_mfma_f32_32x32x16_bf16 v[16:31], a[236:239], a[140:143], v[16:31]
    ds_read_b128 a[252:255], v167 offset:8192
    v_add_f32 v184, v184, v95
    v_cvt_pk_bf16_f32 v91, v94, v95
    v_exp_f32 v113, v113
    v_add_f32 v185, v185, v112
    v_mfma_f32_32x32x16_bf16 v[48:63], a[232:235], a[168:171], v[48:63]
    ds_read_b64_tr_b16 a[192:193], v168 offset:49152
    v_exp_f32 v114, v114
    v_add_f32 v185, v185, v113
    v_cvt_pk_bf16_f32 v112, v112, v113
    v_exp_f32 v115, v115
    v_add_f32 v185, v185, v114
    v_mfma_f32_32x32x16_bf16 v[48:63], a[236:239], a[172:175], v[48:63]
    ds_read_b64_tr_b16 a[194:195], v168 offset:51200
    v_exp_f32 v116, v116
    v_add_f32 v185, v185, v115
    v_cvt_pk_bf16_f32 v113, v114, v115
    v_exp_f32 v117, v117
    s_waitcnt lgkmcnt(4)
    v_mfma_f32_32x32x16_bf16 v[16:31], a[240:243], a[144:147], v[16:31]
    ds_read_b64_tr_b16 a[196:197], v168 offset:53248
    v_add_f32 v185, v185, v116
    v_exp_f32 v118, v118
    v_add_f32 v185, v185, v117
    v_cvt_pk_bf16_f32 v114, v116, v117
    v_exp_f32 v119, v119
    v_mfma_f32_32x32x16_bf16 v[16:31], a[244:247], a[148:151], v[16:31]
    ds_read_b64_tr_b16 a[198:199], v168 offset:55296
    v_add_f32 v185, v185, v118
    v_exp_f32 v120, v120
    v_add_f32 v185, v185, v119
    v_cvt_pk_bf16_f32 v115, v118, v119
    v_exp_f32 v121, v121
    v_mfma_f32_32x32x16_bf16 v[48:63], a[240:243], a[176:179], v[48:63]
    ds_read_b64_tr_b16 a[200:201], v168 offset:57344
    v_add_f32 v185, v185, v120
    v_exp_f32 v122, v122
    v_add_f32 v185, v185, v121
    v_cvt_pk_bf16_f32 v120, v120, v121
    v_mfma_f32_32x32x16_bf16 v[48:63], a[244:247], a[180:183], v[48:63]
    ds_read_b64_tr_b16 a[202:203], v168 offset:59392
    v_exp_f32 v123, v123
    v_add_f32 v185, v185, v122
    v_exp_f32 v124, v124
    v_add_f32 v185, v185, v123
    v_cvt_pk_bf16_f32 v121, v122, v123
    s_waitcnt lgkmcnt(6)
    v_mfma_f32_32x32x16_bf16 v[16:31], a[248:251], a[152:155], v[16:31]
    ds_read_b64_tr_b16 a[204:205], v168 offset:61440
    v_exp_f32 v125, v125
    v_add_f32 v185, v185, v124
    v_exp_f32 v126, v126
    v_add_f32 v185, v185, v125
    v_cvt_pk_bf16_f32 v122, v124, v125
    v_mfma_f32_32x32x16_bf16 v[16:31], a[252:255], a[156:159], v[16:31]
    ds_read_b64_tr_b16 a[206:207], v168 offset:63488
    v_exp_f32 v127, v127
    v_add_f32 v185, v185, v126
    s_nop 0
    v_add_f32 v185, v185, v127
    v_cvt_pk_bf16_f32 v123, v126, v127
    v_mfma_f32_32x32x16_bf16 v[48:63], a[248:251], a[184:187], v[48:63]
    ds_read_b64_tr_b16 a[208:209], v169 offset:49152
    v_max_f32 v188, v184, v185
    v_mfma_f32_32x32x16_bf16 v[48:63], a[252:255], a[188:191], v[48:63]
    ds_read_b64_tr_b16 a[210:211], v169 offset:51200
    v_cmp_nge_f32 vcc, s44, v188
    s_cbranch_vccnz L_stub_B1
L_back_B1:
    s_waitcnt lgkmcnt(6)
    v_mfma_f32_32x32x16_bf16 a[0:15], a[192:195], v[64:67], a[0:15]
    ds_read_b64_tr_b16 a[212:213], v169 offset:53248
    v_add_f32 v182, v182, v184
    v_add_f32 v183, v183, v185
    v_exp_f32 v0, v0
    v_mfma_f32_32x32x16_bf16 a[0:15], a[196:199], v[72:75], a[0:15]
    ds_read_b64_tr_b16 a[214:215], v169 offset:55296
    v_exp_f32 v1, v1
    v_exp_f32 v2, v2
    v_mfma_f32_32x32x16_bf16 a[64:79], a[192:195], v[96:99], a[64:79]
    ds_read_b64_tr_b16 a[216:217], v169 offset:57344
    v_add_f32 v184, v0, v1
    v_cvt_pk_bf16_f32 v0, v0, v1
    v_mfma_f32_32x32x16_bf16 a[64:79], a[196:199], v[104:107], a[64:79]
    ds_read_b64_tr_b16 a[218:219], v169 offset:59392
    v_exp_f32 v3, v3
    v_add_f32 v184, v184, v2
    v_exp_f32 v4, v4
    s_waitcnt lgkmcnt(6)
    v_mfma_f32_32x32x16_bf16 a[0:15], a[200:203], v[80:83], a[0:15]
    ds_read_b64_tr_b16 a[220:221], v169 offset:61440
    v_add_f32 v184, v184, v3
    v_cvt_pk_bf16_f32 v1, v2, v3
    v_exp_f32 v5, v5
    v_mfma_f32_32x32x16_bf16 a[0:15], a[204:207], v[88:91], a[0:15]
    ds_read_b64_tr_b16 a[222:223], v169 offset:63488
    v_add_f32 v184, v184, v4
    v_exp_f32 v6, v6
    v_mfma_f32_32x32x16_bf16 a[64:79], a[200:203], v[112:115], a[64:79]
    ds_read_b64_tr_b16 a[224:225], v170 offset:49152
    v_add_f32 v184, v184, v5
    v_cvt_pk_bf16_f32 v2, v4, v5
    v_exp_f32 v7, v7
    v_mfma_f32_32x32x16_bf16 a[64:79], a[204:207], v[120:123], a[64:79]
    ds_read_b64_tr_b16 a[226:227], v170 offset:51200
    v_add_f32 v184, v184, v6
    v_exp_f32 v8, v8
    s_waitcnt lgkmcnt(6)
    v_mfma_f32_32x32x16_bf16 a[16:31], a[208:211], v[64:67], a[16:31]
    ds_read_b64_tr_b16 a[228:229], v170 offset:53248
    v_add_f32 v184, v184, v7
    v_cvt_pk_bf16_f32 v3, v6, v7
    v_exp_f32 v9, v9
    v_mfma_f32_32x32x16_bf16 a[16:31], a[212:215], v[72:75], a[16:31]
    ds_read_b64_tr_b16 a[230:231], v170 offset:55296
    v_add_f32 v184, v184, v8
    v_exp_f32 v10, v10
    v_mfma_f32_32x32x16_bf16 a[80:95], a[208:211], v[96:99], a[80:95]
    ds_read_b64_tr_b16 a[232:233], v170 offset:57344
    v_add_f32 v184, v184, v9
    v_cvt_pk_bf16_f32 v8, v8, v9
    v_exp_f32 v11, v11
    v_mfma_f32_32x32x16_bf16 a[80:95], a[212:215], v[104:107], a[80:95]
    ds_read_b64_tr_b16 a[234:235], v170 offset:59392
    v_add_f32 v184, v184, v10
    v_exp_f32 v12, v12
    s_waitcnt lgkmcnt(6)
    v_mfma_f32_32x32x16_bf16 a[16:31], a[216:219], v[80:83], a[16:31]
    ds_read_b64_tr_b16 a[236:237], v170 offset:61440
    v_add_f32 v184, v184, v11
    v_cvt_pk_bf16_f32 v9, v10, v11
    v_exp_f32 v13, v13
    v_mfma_f32_32x32x16_bf16 a[16:31], a[220:223], v[88:91], a[16:31]
    ds_read_b64_tr_b16 a[238:239], v170 offset:63488
    v_add_f32 v184, v184, v12
    v_exp_f32 v14, v14
    v_add_f32 v184, v184, v13
    v_mfma_f32_32x32x16_bf16 a[80:95], a[216:219], v[112:115], a[80:95]
    ds_read_b64_tr_b16 a[240:241], v171 offset:49152
    v_cvt_pk_bf16_f32 v10, v12, v13
    v_exp_f32 v15, v15
    v_mfma_f32_32x32x16_bf16 a[80:95], a[220:223], v[120:123], a[80:95]
    ds_read_b64_tr_b16 a[242:243], v171 offset:51200
    v_add_f32 v184, v184, v14
    v_exp_f32 v32, v32
    v_add_f32 v184, v184, v15
    s_waitcnt lgkmcnt(6)
    v_mfma_f32_32x32x16_bf16 a[32:47], a[224:227], v[64:67], a[32:47]
    ds_read_b64_tr_b16 a[244:245], v171 offset:53248
    v_cvt_pk_bf16_f32 v11, v14, v15
    v_exp_f32 v33, v33
    v_mfma_f32_32x32x16_bf16 a[32:47], a[228:231], v[72:75], a[32:47]
    ds_read_b64_tr_b16 a[246:247], v171 offset:55296
    v_exp_f32 v34, v34
    v_add_f32 v185, v32, v33
    v_cvt_pk_bf16_f32 v32, v32, v33
    v_mfma_f32_32x32x16_bf16 a[96:111], a[224:227], v[96:99], a[96:111]
    ds_read_b64_tr_b16 a[248:249], v171 offset:57344
    v_exp_f32 v35, v35
    v_add_f32 v185, v185, v34
    v_mfma_f32_32x32x16_bf16 a[96:111], a[228:231], v[104:107], a[96:111]
    ds_read_b64_tr_b16 a[250:251], v171 offset:59392
    v_exp_f32 v36, v36
    v_add_f32 v185, v185, v35
    v_cvt_pk_bf16_f32 v33, v34, v35
    s_waitcnt lgkmcnt(6)
    v_mfma_f32_32x32x16_bf16 a[32:47], a[232:235], v[80:83], a[32:47]
    ds_read_b64_tr_b16 a[252:253], v171 offset:61440
    v_exp_f32 v37, v37
    v_add_f32 v185, v185, v36
    v_exp_f32 v38, v38
    v_mfma_f32_32x32x16_bf16 a[32:47], a[236:239], v[88:91], a[32:47]
    ds_read_b64_tr_b16 a[254:255], v171 offset:63488
    v_add_f32 v185, v185, v37
    v_cvt_pk_bf16_f32 v34, v36, v37
    v_mfma_f32_32x32x16_bf16 a[96:111], a[232:235], v[112:115], a[96:111]
    v_exp_f32 v39, v39
    v_add_f32 v185, v185, v38
    v_exp_f32 v40, v40
    v_mfma_f32_32x32x16_bf16 a[96:111], a[236:239], v[120:123], a[96:111]
    s_waitcnt vmcnt(0) lgkmcnt(0)
    s_barrier
    s_cmp_le_u32 s42, s81
    s_cbranch_scc1 L_evstub_3
    L_evback_3:
    v_add_f32 v185, v185, v39
    v_mfma_f32_32x32x16_bf16 a[48:63], a[240:243], v[64:67], a[48:63]
    ds_read_b128 a[192:195], v160 offset:16384
    v_cvt_pk_bf16_f32 v35, v38, v39
    v_exp_f32 v41, v41
    v_add_f32 v185, v185, v40
    v_mfma_f32_32x32x16_bf16 a[48:63], a[244:247], v[72:75], a[48:63]
    ds_read_b128 a[196:199], v161 offset:16384
    v_exp_f32 v42, v42
    v_add_f32 v185, v185, v41
    v_cvt_pk_bf16_f32 v40, v40, v41
    v_mfma_f32_32x32x16_bf16 a[112:127], a[240:243], v[96:99], a[112:127]
    v_exp_f32 v43, v43
    v_add_f32 v185, v185, v42
    v_exp_f32 v44, v44
    v_mfma_f32_32x32x16_bf16 a[112:127], a[244:247], v[104:107], a[112:127]
    v_add_f32 v185, v185, v43
    v_cvt_pk_bf16_f32 v41, v42, v43
    v_exp_f32 v45, v45
    v_mfma_f32_32x32x16_bf16 a[48:63], a[248:251], v[80:83], a[48:63]
    ds_read_b128 a[200:203], v162 offset:16384
    v_add_f32 v185, v185, v44
    v_exp_f32 v46, v46
    v_mfma_f32_32x32x16_bf16 a[48:63], a[252:255], v[88:91], a[48:63]
    ds_read_b128 a[204:207], v163 offset:16384
    v_add_f32 v185, v185, v45
    v_cvt_pk_bf16_f32 v42, v44, v45
    v_exp_f32 v47, v47
    v_mfma_f32_32x32x16_bf16 a[112:127], a[248:251], v[112:115], a[112:127]
    v_add_f32 v185, v185, v46
    s_nop 0
    v_add_f32 v185, v185, v47
    v_cvt_pk_bf16_f32 v43, v46, v47
    v_mfma_f32_32x32x16_bf16 a[112:127], a[252:255], v[120:123], a[112:127]
    s_add_u32 s45, s45, 262144
    s_sub_u32 s42, s42, 1
    s_cmp_eq_u32 s42, 0
    s_cbranch_scc0 L_loopB
    s_branch L_tail0
L_tail1:
    s_waitcnt lgkmcnt(0)
    ds_read_b64_tr_b16 a[192:193], v168 offset:49152
    ds_read_b64_tr_b16 a[194:195], v168 offset:51200
    ds_read_b64_tr_b16 a[196:197], v168 offset:53248
    ds_read_b64_tr_b16 a[198:199], v168 offset:55296
    ds_read_b64_tr_b16 a[200:201], v168 offset:57344
    ds_read_b64_tr_b16 a[202:203], v168 offset:59392
    ds_read_b64_tr_b16 a[204:205], v168 offset:61440
    ds_read_b64_tr_b16 a[206:207], v168 offset:63488
    ds_read_b64_tr_b16 a[208:209], v169 offset:49152
    ds_read_b64_tr_b16 a[210:211], v169 offset:51200
    v_exp_f32 v80, v80
    v_exp_f32 v81, v81
    v_add_f32 v184, v184, v80
    v_exp_f32 v82, v82
    v_add_f32 v184, v184, v81
    v_cvt_pk_bf16_f32 v80, v80, v81
    v_exp_f32 v83, v83
    v_add_f32 v184, v184, v82
    v_exp_f32 v84, v84
    v_add_f32 v184, v184, v83
    v_cvt_pk_bf16_f32 v81, v82, v83
    v_exp_f32 v85, v85
    v_add_f32 v184, v184, v84
    v_exp_f32 v86, v86
    v_add_f32 v184, v184, v85
    v_cvt_pk_bf16_f32 v82, v84, v85
    v_exp_f32 v87, v87
    v_add_f32 v184, v184, v86
    v_exp_f32 v88, v88
    v_add_f32 v184, v184, v87
    v_cvt_pk_bf16_f32 v83, v86, v87
    v_exp_f32 v89, v89
    v_add_f32 v184, v184, v88
    v_exp_f32 v90, v90
    v_add_f32 v184, v184, v89
    v_cvt_pk_bf16_f32 v88, v88, v89
    v_exp_f32 v91, v91
    v_add_f32 v184, v184, v90
    v_exp_f32 v92, v92
    v_add_f32 v184, v184, v91
    v_cvt_pk_bf16_f32 v89, v90, v91
    v_exp_f32 v93, v93
    v_add_f32 v184, v184, v92
    v_exp_f32 v94, v94
    v_add_f32 v184, v184, v93
    v_cvt_pk_bf16_f32 v90, v92, v93
    v_exp_f32 v95, v95
    v_add_f32 v184, v184, v94
    v_exp_f32 v112, v112
    v_add_f32 v184, v184, v95
    v_cvt_pk_bf16_f32 v91, v94, v95
    v_exp_f32 v113, v113
    v_add_f32 v185, v185, v112
    v_exp_f32 v114, v114
    v_add_f32 v185, v185, v113
    v_cvt_pk_bf16_f32 v112, v112, v113
    v_exp_f32 v115, v115
    v_add_f32 v185, v185, v114
    v_exp_f32 v116, v116
    v_add_f32 v185, v185, v115
    v_cvt_pk_bf16_f32 v113, v114, v115
    v_exp_f32 v117, v117
    v_add_f32 v185, v185, v116
    v_exp_f32 v118, v118
    v_add_f32 v185, v185, v117
    v_cvt_pk_bf16_f32 v114, v116, v117
    v_exp_f32 v119, v119
    v_add_f32 v185, v185, v118
    v_exp_f32 v120, v120
    v_add_f32 v185, v185, v119
    v_cvt_pk_bf16_f32 v115, v118, v119
    v_exp_f32 v121, v121
    v_add_f32 v185, v185, v120
    v_exp_f32 v122, v122
    v_add_f32 v185, v185, v121
    v_cvt_pk_bf16_f32 v120, v120, v121
    v_exp_f32 v123, v123
    v_add_f32 v185, v185, v122
    v_exp_f32 v124, v124
    v_add_f32 v185, v185, v123
    v_cvt_pk_bf16_f32 v121, v122, v123
    v_exp_f32 v125, v125
    v_add_f32 v185, v185, v124
    v_exp_f32 v126, v126
    v_add_f32 v185, v185, v125
    v_cvt_pk_bf16_f32 v122, v124, v125
    v_exp_f32 v127, v127
    v_add_f32 v185, v185, v126
    s_nop 0
    v_add_f32 v185, v185, v127
    v_cvt_pk_bf16_f32 v123, v126, v127
    v_max_f32 v188, v184, v185
    s_nop 0
    v_cmp_nge_f32 vcc, s44, v188
    s_cbranch_vccnz L_stub_T1
L_back_T1:
    v_add_f32 v182, v182, v184
    v_add_f32 v183, v183, v185
    s_mov_b32 s58, s32
    s_mov_b32 s59, s55
    s_mov_b32 s30, s39
    s_bitcmp1_b32 s39, 0
    s_cbranch_scc0 L_nopf_T1
    s_mov_b64 s[32:33], s[64:65]
    s_mov_b64 s[34:35], s[66:67]
    s_mov_b64 s[36:37], s[68:69]
    s_mov_b64 s[38:39], s[70:71]
    s_call_b64 s[60:61], L_setup
L_nopf_T1:
    s_and_b32 s48, s59, 3
    s_lshr_b32 s49, s59, 4
    s_mul_i32 s56, s49, 17408
    s_cmp_eq_u32 s48, 1
    s_cbranch_scc1 L_prod_T1
    s_call_b64 s[60:61], L_epiaddr
    s_cmp_eq_u32 s48, 2
    s_cbranch_scc1 L_cons_T1
    v_mov_b32 v188, v182
    v_mov_b32 v189, v183
    s_nop 1
    v_permlane32_swap_b32 v182, v188
    v_permlane32_swap_b32 v183, v189
    s_nop 1
    v_add_f32 v182, v182, v188
    v_add_f32 v183, v183, v189
    v_rcp_f32 v192, v182
    v_rcp_f32 v194, v183
    s_nop 1
    v_mov_b32 v193, v192
    v_mov_b32 v195, v194
    s_waitcnt lgkmcnt(8)
    v_mfma_f32_32x32x16_bf16 a[0:15], a[192:195], v[64:67], a[0:15]
    ds_read_b64_tr_b16 a[212:213], v169 offset:53248
    s_waitcnt lgkmcnt(7)
    v_mfma_f32_32x32x16_bf16 a[0:15], a[196:199], v[72:75], a[0:15]
    ds_read_b64_tr_b16 a[214:215], v169 offset:55296
    v_mfma_f32_32x32x16_bf16 a[64:79], a[192:195], v[96:99], a[64:79]
    ds_read_b64_tr_b16 a[216:217], v169 offset:57344
    v_mfma_f32_32x32x16_bf16 a[64:79], a[196:199], v[104:107], a[64:79]
    ds_read_b64_tr_b16 a[218:219], v169 offset:59392
    s_waitcnt lgkmcnt(8)
    v_mfma_f32_32x32x16_bf16 a[0:15], a[200:203], v[80:83], a[0:15]
    ds_read_b64_tr_b16 a[220:221], v169 offset:61440
    s_waitcnt lgkmcnt(7)
    v_mfma_f32_32x32x16_bf16 a[0:15], a[204:207], v[88:91], a[0:15]
    ds_read_b64_tr_b16 a[222:223], v169 offset:63488
    v_mfma_f32_32x32x16_bf16 a[64:79], a[200:203], v[112:115], a[64:79]
    ds_read_b64_tr_b16 a[224:225], v170 offset:49152
    v_mfma_f32_32x32x16_bf16 a[64:79], a[204:207], v[120:123], a[64:79]
    ds_read_b64_tr_b16 a[226:227], v170 offset:51200
    s_waitcnt lgkmcnt(8)
    v_mfma_f32_32x32x16_bf16 a[16:31], a[208:211], v[64:67], a[16:31]
    ds_read_b64_tr_b16 a[228:229], v170 offset:53248
    s_waitcnt lgkmcnt(7)
    v_mfma_f32_32x32x16_bf16 a[16:31], a[212:215], v[72:75], a[16:31]
    ds_read_b64_tr_b16 a[230:231], v170 offset:55296
    s_nop 5
    v_accvgpr_read_b32 v208, a0
    v_accvgpr_read_b32 v209, a1
    v_accvgpr_read_b32 v210, a2
    v_accvgpr_read_b32 v211, a3
    v_accvgpr_read_b32 v212, a4
    v_mfma_f32_32x32x16_bf16 a[80:95], a[208:211], v[96:99], a[80:95]
    ds_read_b64_tr_b16 a[232:233], v170 offset:57344
    v_accvgpr_read_b32 v213, a5
    v_accvgpr_read_b32 v214, a6
    v_accvgpr_read_b32 v215, a7
    v_xor_b32 v200, 0, v248
    v_xor_b32 v201, 16, v248
    v_mfma_f32_32x32x16_bf16 a[80:95], a[212:215], v[104:107], a[80:95]
    ds_read_b64_tr_b16 a[234:235], v170 offset:59392
    v_mul_f32 v208, v208, v192
    v_mul_f32 v209, v209, v192
    v_mul_f32 v210, v210, v192
    v_mul_f32 v211, v211, v192
    v_mul_f32 v212, v212, v192
    s_waitcnt lgkmcnt(8)
    v_mfma_f32_32x32x16_bf16 a[16:31], a[216:219], v[80:83], a[16:31]
    ds_read_b64_tr_b16 a[236:237], v170 offset:61440
    v_mul_f32 v213, v213, v192
    v_mul_f32 v214, v214, v192
    v_mul_f32 v215, v215, v192
    v_cvt_pk_bf16_f32 v224, v208, v209
    v_cvt_pk_bf16_f32 v225, v210, v211
    s_waitcnt lgkmcnt(7)
    v_mfma_f32_32x32x16_bf16 a[16:31], a[220:223], v[88:91], a[16:31]
    ds_read_b64_tr_b16 a[238:239], v170 offset:63488
    v_cvt_pk_bf16_f32 v226, v212, v213
    v_cvt_pk_bf16_f32 v227, v214, v215
    ds_write_b64 v200, v[224:225] offset:0
    ds_write_b64 v201, v[226:227] offset:0
    v_accvgpr_read_b32 v216, a8
    v_mfma_f32_32x32x16_bf16 a[80:95], a[216:219], v[112:115], a[80:95]
    ds_read_b64_tr_b16 a[240:241], v171 offset:49152
    v_accvgpr_read_b32 v217, a9
    v_accvgpr_read_b32 v218, a10
    v_accvgpr_read_b32 v219, a11
    v_accvgpr_read_b32 v220, a12
    v_accvgpr_read_b32 v221, a13
    v_mfma_f32_32x32x16_bf16 a[80:95], a[220:223], v[120:123], a[80:95]
    ds_read_b64_tr_b16 a[242:243], v171 offset:51200
    v_accvgpr_read_b32 v222, a14
    v_accvgpr_read_b32 v223, a15
    v_xor_b32 v202, 32, v248
    v_xor_b32 v203, 48, v248
    v_mul_f32 v216, v216, v192
    s_waitcnt lgkmcnt(10)
    v_mfma_f32_32x32x16_bf16 a[32:47], a[224:227], v[64:67], a[32:47]
    ds_read_b64_tr_b16 a[244:245], v171 offset:53248
    v_mul_f32 v217, v217, v192
    v_mul_f32 v218, v218, v192
    v_mul_f32 v219, v219, v192
    v_mul_f32 v220, v220, v192
    v_mul_f32 v221, v221, v192
    s_waitcnt lgkmcnt(9)
    v_mfma_f32_32x32x16_bf16 a[32:47], a[228:231], v[72:75], a[32:47]
    ds_read_b64_tr_b16 a[246:247], v171 offset:55296
    v_mul_f32 v222, v222, v192
    v_mul_f32 v223, v223, v192
    v_cvt_pk_bf16_f32 v228, v216, v217
    v_cvt_pk_bf16_f32 v229, v218, v219
    v_cvt_pk_bf16_f32 v230, v220, v221
    v_mfma_f32_32x32x16_bf16 a[96:111], a[224:227], v[96:99], a[96:111]
    ds_read_b64_tr_b16 a[248:249], v171 offset:57344
    v_cvt_pk_bf16_f32 v231, v222, v223
    ds_write_b64 v202, v[228:229] offset:0
    ds_write_b64 v203, v[230:231] offset:0
    v_accvgpr_read_b32 v208, a16
    v_accvgpr_read_b32 v209, a17
    v_mfma_f32_32x32x16_bf16 a[96:111], a[228:231], v[104:107], a[96:111]
    ds_read_b64_tr_b16 a[250:251], v171 offset:59392
    v_accvgpr_read_b32 v210, a18
    v_accvgpr_read_b32 v211, a19
    v_accvgpr_read_b32 v212, a20
    v_accvgpr_read_b32 v213, a21
    v_accvgpr_read_b32 v214, a22
    s_waitcnt lgkmcnt(12)
    v_mfma_f32_32x32x16_bf16 a[32:47], a[232:235], v[80:83], a[32:47]
    ds_read_b64_tr_b16 a[252:253], v171 offset:61440
    v_accvgpr_read_b32 v215, a23
    v_xor_b32 v200, 64, v248
    v_xor_b32 v201, 80, v248
    v_mul_f32 v208, v208, v192
    v_mul_f32 v209, v209, v192
    s_waitcnt lgkmcnt(11)
    v_mfma_f32_32x32x16_bf16 a[32:47], a[236:239], v[88:91], a[32:47]
    ds_read_b64_tr_b16 a[254:255], v171 offset:63488
    v_mul_f32 v210, v210, v192
    v_mul_f32 v211, v211, v192
    v_mul_f32 v212, v212, v192
    v_mul_f32 v213, v213, v192
    v_mul_f32 v214, v214, v192
    v_mfma_f32_32x32x16_bf16 a[96:111], a[232:235], v[112:115], a[96:111]
    v_mul_f32 v215, v215, v192
    v_cvt_pk_bf16_f32 v224, v208, v209
    v_cvt_pk_bf16_f32 v225, v210, v211
    v_cvt_pk_bf16_f32 v226, v212, v213
    v_cvt_pk_bf16_f32 v227, v214, v215
    v_mfma_f32_32x32x16_bf16 a[96:111], a[236:239], v[120:123], a[96:111]
    ds_write_b64 v200, v[224:225] offset:0
    ds_write_b64 v201, v[226:227] offset:0
    v_accvgpr_read_b32 v216, a24
    v_accvgpr_read_b32 v217, a25
    v_accvgpr_read_b32 v218, a26
    s_waitcnt lgkmcnt(10)
    v_mfma_f32_32x32x16_bf16 a[48:63], a[240:243], v[64:67], a[48:63]
    v_accvgpr_read_b32 v219, a27
    v_accvgpr_read_b32 v220, a28
    v_accvgpr_read_b32 v221, a29
    v_accvgpr_read_b32 v222, a30
    v_accvgpr_read_b32 v223, a31
    s_waitcnt lgkmcnt(8)
    v_mfma_f32_32x32x16_bf16 a[48:63], a[244:247], v[72:75], a[48:63]
    v_xor_b32 v202, 96, v248
    v_xor_b32 v203, 112, v248
    v_mul_f32 v216, v216, v192
    v_mul_f32 v217, v217, v192
    v_mul_f32 v218, v218, v192
    v_mfma_f32_32x32x16_bf16 a[112:127], a[240:243], v[96:99], a[112:127]
    v_mul_f32 v219, v219, v192
    v_mul_f32 v220, v220, v192
    v_mul_f32 v221, v221, v192
    v_mul_f32 v222, v222, v192
    v_mul_f32 v223, v223, v192
    v_mfma_f32_32x32x16_bf16 a[112:127], a[244:247], v[104:107], a[112:127]
    v_cvt_pk_bf16_f32 v228, v216, v217
    v_cvt_pk_bf16_f32 v229, v218, v219
    v_cvt_pk_bf16_f32 v230, v220, v221
    v_cvt_pk_bf16_f32 v231, v222, v223
    ds_write_b64 v202, v[228:229] offset:0
    s_waitcnt lgkmcnt(5)
    v_mfma_f32_32x32x16_bf16 a[48:63], a[248:251], v[80:83], a[48:63]
    ds_write_b64 v203, v[230:231] offset:0
    ds_read_b128 v[0:3], v249 offset:0
    ds_read_b128 v[4:7], v249 offset:1024
    ds_read_b128 v[8:11], v249 offset:2048
    ds_read_b128 v[12:15], v249 offset:3072
    s_waitcnt lgkmcnt(8)
    v_mfma_f32_32x32x16_bf16 a[48:63], a[252:255], v[88:91], a[48:63]
    v_accvgpr_read_b32 v208, a64
    v_accvgpr_read_b32 v209, a65
    v_accvgpr_read_b32 v210, a66
    v_accvgpr_read_b32 v211, a67
    v_accvgpr_read_b32 v212, a68
    v_mfma_f32_32x32x16_bf16 a[112:127], a[248:251], v[112:115], a[112:127]
    v_accvgpr_read_b32 v213, a69
    v_accvgpr_read_b32 v214, a70
    v_accvgpr_read_b32 v215, a71
    v_xor_b32 v200, 0, v248
    v_xor_b32 v201, 16, v248
    v_mfma_f32_32x32x16_bf16 a[112:127], a[252:255], v[120:123], a[112:127]
    s_add_u32 s57, s58, 0
    s_waitcnt lgkmcnt(3)
    buffer_store_dwordx4 v[0:3], v251, s[16:19], s57 offen sc1
    s_add_u32 s57, s58, 32768
    s_waitcnt lgkmcnt(2)
    buffer_store_dwordx4 v[4:7], v251, s[16:19], s57 offen sc1
    s_add_u32 s57, s58, 65536
    s_waitcnt lgkmcnt(1)
    buffer_store_dwordx4 v[8:11], v251, s[16:19], s57 offen sc1
    s_add_u32 s57, s58, 98304
    s_waitcnt lgkmcnt(0)
    buffer_store_dwordx4 v[12:15], v251, s[16:19], s57 offen sc1
    v_mul_f32 v208, v208, v194
    v_mul_f32 v209, v209, v194
    v_mul_f32 v210, v210, v194
    v_mul_f32 v211, v211, v194
    v_mul_f32 v212, v212, v194
    v_mul_f32 v213, v213, v194
    v_mul_f32 v214, v214, v194
    v_mul_f32 v215, v215, v194
    v_cvt_pk_bf16_f32 v224, v208, v209
    v_cvt_pk_bf16_f32 v225, v210, v211
    v_cvt_pk_bf16_f32 v226, v212, v213
    v_cvt_pk_bf16_f32 v227, v214, v215
    ds_write_b64 v200, v[224:225] offset:4096
    ds_write_b64 v201, v[226:227] offset:4096
    v_accvgpr_read_b32 v216, a72
    v_accvgpr_read_b32 v217, a73
    v_accvgpr_read_b32 v218, a74
    v_accvgpr_read_b32 v219, a75
    v_accvgpr_read_b32 v220, a76
    v_accvgpr_read_b32 v221, a77
    v_accvgpr_read_b32 v222, a78
    v_accvgpr_read_b32 v223, a79
    v_xor_b32 v202, 32, v248
    v_xor_b32 v203, 48, v248
    v_mul_f32 v216, v216, v194
    v_mul_f32 v217, v217, v194
    v_mul_f32 v218, v218, v194
    v_mul_f32 v219, v219, v194
    v_mul_f32 v220, v220, v194
    v_mul_f32 v221, v221, v194
    v_mul_f32 v222, v222, v194
    v_mul_f32 v223, v223, v194
    v_cvt_pk_bf16_f32 v228, v216, v217
    v_cvt_pk_bf16_f32 v229, v218, v219
    v_cvt_pk_bf16_f32 v230, v220, v221
    v_cvt_pk_bf16_f32 v231, v222, v223
    ds_write_b64 v202, v[228:229] offset:4096
    ds_write_b64 v203, v[230:231] offset:4096
    v_accvgpr_read_b32 v208, a80
    v_accvgpr_read_b32 v209, a81
    v_accvgpr_read_b32 v210, a82
    v_accvgpr_read_b32 v211, a83
    v_accvgpr_read_b32 v212, a84
    v_accvgpr_read_b32 v213, a85
    v_accvgpr_read_b32 v214, a86
    v_accvgpr_read_b32 v215, a87
    v_xor_b32 v200, 64, v248
    v_xor_b32 v201, 80, v248
    v_mul_f32 v208, v208, v194
    v_mul_f32 v209, v209, v194
    v_mul_f32 v210, v210, v194
    v_mul_f32 v211, v211, v194
    v_mul_f32 v212, v212, v194
    v_mul_f32 v213, v213, v194
    v_mul_f32 v214, v214, v194
    v_mul_f32 v215, v215, v194
    v_cvt_pk_bf16_f32 v224, v208, v209
    v_cvt_pk_bf16_f32 v225, v210, v211
    v_cvt_pk_bf16_f32 v226, v212, v213
    v_cvt_pk_bf16_f32 v227, v214, v215
    ds_write_b64 v200, v[224:225] offset:4096
    ds_write_b64 v201, v[226:227] offset:4096
    v_accvgpr_read_b32 v216, a88
    v_accvgpr_read_b32 v217, a89
    v_accvgpr_read_b32 v218, a90
    v_accvgpr_read_b32 v219, a91
    v_accvgpr_read_b32 v220, a92
    v_accvgpr_read_b32 v221, a93
    v_accvgpr_read_b32 v222, a94
    v_accvgpr_read_b32 v223, a95
    v_xor_b32 v202, 96, v248
    v_xor_b32 v203, 112, v248
    v_mul_f32 v216, v216, v194
    v_mul_f32 v217, v217, v194
    v_mul_f32 v218, v218, v194
    v_mul_f32 v219, v219, v194
    v_mul_f32 v220, v220, v194
    v_mul_f32 v221, v221, v194
    v_mul_f32 v222, v222, v194
    v_mul_f32 v223, v223, v194
    v_cvt_pk_bf16_f32 v228, v216, v217
    v_cvt_pk_bf16_f32 v229, v218, v219
    v_cvt_pk_bf16_f32 v230, v220, v221
    v_cvt_pk_bf16_f32 v231, v222, v223
    ds_write_b64 v202, v[228:229] offset:4096
    ds_write_b64 v203, v[230:231] offset:4096
    ds_read_b128 v[16:19], v249 offset:4096
    ds_read_b128 v[20:23], v249 offset:5120
    ds_read_b128 v[24:27], v249 offset:6144
    ds_read_b128 v[28:31], v249 offset:7168
    v_accvgpr_read_b32 v208, a32
    v_accvgpr_read_b32 v209, a33
    v_accvgpr_read_b32 v210, a34
    v_accvgpr_read_b32 v211, a35
    v_accvgpr_read_b32 v212, a36
    v_accvgpr_read_b32 v213, a37
    v_accvgpr_read_b32 v214, a38
    v_accvgpr_read_b32 v215, a39
    v_xor_b32 v200, 0, v248
    v_xor_b32 v201, 16, v248
    s_add_u32 s57, s58, 131072
    s_waitcnt lgkmcnt(3)
    buffer_store_dwordx4 v[16:19], v251, s[16:19], s57 offen sc1
    s_add_u32 s57, s58, 163840
    s_waitcnt lgkmcnt(2)
    buffer_store_dwordx4 v[20:23], v251, s[16:19], s57 offen sc1
    s_add_u32 s57, s58, 196608
    s_waitcnt lgkmcnt(1)
    buffer_store_dwordx4 v[24:27], v251, s[16:19], s57 offen sc1
    s_add_u32 s57, s58, 229376
    s_waitcnt lgkmcnt(0)
    buffer_store_dwordx4 v[28:31], v251, s[16:19], s57 offen sc1
    v_mul_f32 v208, v208, v192
    v_mul_f32 v209, v209, v192
    v_mul_f32 v210, v210, v192
    v_mul_f32 v211, v211, v192
    v_mul_f32 v212, v212, v192
    v_mul_f32 v213, v213, v192
    v_mul_f32 v214, v214, v192
    v_mul_f32 v215, v215, v192
    v_cvt_pk_bf16_f32 v224, v208, v209
    v_cvt_pk_bf16_f32 v225, v210, v211
    v_cvt_pk_bf16_f32 v226, v212, v213
    v_cvt_pk_bf16_f32 v227, v214, v215
    ds_write_b64 v200, v[224:225] offset:0
    ds_write_b64 v201, v[226:227] offset:0
    v_accvgpr_read_b32 v216, a40
    v_accvgpr_read_b32 v217, a41
    v_accvgpr_read_b32 v218, a42
    v_accvgpr_read_b32 v219, a43
    v_accvgpr_read_b32 v220, a44
    v_accvgpr_read_b32 v221, a45
    v_accvgpr_read_b32 v222, a46
    v_accvgpr_read_b32 v223, a47
    v_xor_b32 v202, 32, v248
    v_xor_b32 v203, 48, v248
    v_mul_f32 v216, v216, v192
    v_mul_f32 v217, v217, v192
    v_mul_f32 v218, v218, v192
    v_mul_f32 v219, v219, v192
    v_mul_f32 v220, v220, v192
    v_mul_f32 v221, v221, v192
    v_mul_f32 v222, v222, v192
    v_mul_f32 v223, v223, v192
    v_cvt_pk_bf16_f32 v228, v216, v217
    v_cvt_pk_bf16_f32 v229, v218, v219
    v_cvt_pk_bf16_f32 v230, v220, v221
    v_cvt_pk_bf16_f32 v231, v222, v223
    ds_write_b64 v202, v[228:229] offset:0
    ds_write_b64 v203, v[230:231] offset:0
    v_accvgpr_read_b32 v208, a48
    v_accvgpr_read_b32 v209, a49
    v_accvgpr_read_b32 v210, a50
    v_accvgpr_read_b32 v211, a51
    v_accvgpr_read_b32 v212, a52
    v_accvgpr_read_b32 v213, a53
    v_accvgpr_read_b32 v214, a54
    v_accvgpr_read_b32 v215, a55
    v_xor_b32 v200, 64, v248
    v_xor_b32 v201, 80, v248
    v_mul_f32 v208, v208, v192
    v_mul_f32 v209, v209, v192
    v_mul_f32 v210, v210, v192
    v_mul_f32 v211, v211, v192
    v_mul_f32 v212, v212, v192
    v_mul_f32 v213, v213, v192
    v_mul_f32 v214, v214, v192
    v_mul_f32 v215, v215, v192
    v_cvt_pk_bf16_f32 v224, v208, v209
    v_cvt_pk_bf16_f32 v225, v210, v211
    v_cvt_pk_bf16_f32 v226, v212, v213
    v_cvt_pk_bf16_f32 v227, v214, v215
    ds_write_b64 v200, v[224:225] offset:0
    ds_write_b64 v201, v[226:227] offset:0
    v_accvgpr_read_b32 v216, a56
    v_accvgpr_read_b32 v217, a57
    v_accvgpr_read_b32 v218, a58
    v_accvgpr_read_b32 v219, a59
    v_accvgpr_read_b32 v220, a60
    v_accvgpr_read_b32 v221, a61
    v_accvgpr_read_b32 v222, a62
    v_accvgpr_read_b32 v223, a63
    v_xor_b32 v202, 96, v248
    v_xor_b32 v203, 112, v248
    v_mul_f32 v216, v216, v192
    v_mul_f32 v217, v217, v192
    v_mul_f32 v218, v218, v192
    v_mul_f32 v219, v219, v192
    v_mul_f32 v220, v220, v192
    v_mul_f32 v221, v221, v192
    v_mul_f32 v222, v222, v192
    v_mul_f32 v223, v223, v192
    v_cvt_pk_bf16_f32 v228, v216, v217
    v_cvt_pk_bf16_f32 v229, v218, v219
    v_cvt_pk_bf16_f32 v230, v220, v221
    v_cvt_pk_bf16_f32 v231, v222, v223
    ds_write_b64 v202, v[228:229] offset:0
    ds_write_b64 v203, v[230:231] offset:0
    ds_read_b128 v[32:35], v249 offset:0
    ds_read_b128 v[36:39], v249 offset:1024
    ds_read_b128 v[40:43], v249 offset:2048
    ds_read_b128 v[44:47], v249 offset:3072
    v_accvgpr_read_b32 v208, a96
    v_accvgpr_read_b32 v209, a97
    v_accvgpr_read_b32 v210, a98
    v_accvgpr_read_b32 v211, a99
    v_accvgpr_read_b32 v212, a100
    v_accvgpr_read_b32 v213, a101
    v_accvgpr_read_b32 v214, a102
    v_accvgpr_read_b32 v215, a103
    v_xor_b32 v200, 0, v248
    v_xor_b32 v201, 16, v248
    s_add_u32 s57, s58, 128
    s_waitcnt lgkmcnt(3)
    buffer_store_dwordx4 v[32:35], v251, s[16:19], s57 offen sc1
    s_add_u32 s57, s58, 32896
    s_waitcnt lgkmcnt(2)
    buffer_store_dwordx4 v[36:39], v251, s[16:19], s57 offen sc1
    s_add_u32 s57, s58, 65664
    s_waitcnt lgkmcnt(1)
    buffer_store_dwordx4 v[40:43], v251, s[16:19], s57 offen sc1
    s_add_u32 s57, s58, 98432
    s_waitcnt lgkmcnt(0)
    buffer_store_dwordx4 v[44:47], v251, s[16:19], s57 offen sc1
    v_mul_f32 v208, v208, v194
    v_mul_f32 v209, v209, v194
    v_mul_f32 v210, v210, v194
    v_mul_f32 v211, v211, v194
    v_mul_f32 v212, v212, v194
    v_mul_f32 v213, v213, v194
    v_mul_f32 v214, v214, v194
    v_mul_f32 v215, v215, v194
    v_cvt_pk_bf16_f32 v224, v208, v209
    v_cvt_pk_bf16_f32 v225, v210, v211
    v_cvt_pk_bf16_f32 v226, v212, v213
    v_cvt_pk_bf16_f32 v227, v214, v215
    ds_write_b64 v200, v[224:225] offset:4096
    ds_write_b64 v201, v[226:227] offset:4096
    v_accvgpr_read_b32 v216, a104
    v_accvgpr_read_b32 v217, a105
    v_accvgpr_read_b32 v218, a106
    v_accvgpr_read_b32 v219, a107
    v_accvgpr_read_b32 v220, a108
    v_accvgpr_read_b32 v221, a109
    v_accvgpr_read_b32 v222, a110
    v_accvgpr_read_b32 v223, a111
    v_xor_b32 v202, 32, v248
    v_xor_b32 v203, 48, v248
    v_mul_f32 v216, v216, v194
    v_mul_f32 v217, v217, v194
    v_mul_f32 v218, v218, v194
    v_mul_f32 v219, v219, v194
    v_mul_f32 v220, v220, v194
    v_mul_f32 v221, v221, v194
    v_mul_f32 v222, v222, v194
    v_mul_f32 v223, v223, v194
    v_cvt_pk_bf16_f32 v228, v216, v217
    v_cvt_pk_bf16_f32 v229, v218, v219
    v_cvt_pk_bf16_f32 v230, v220, v221
    v_cvt_pk_bf16_f32 v231, v222, v223
    ds_write_b64 v202, v[228:229] offset:4096
    ds_write_b64 v203, v[230:231] offset:4096
    v_accvgpr_read_b32 v208, a112
    v_accvgpr_read_b32 v209, a113
    v_accvgpr_read_b32 v210, a114
    v_accvgpr_read_b32 v211, a115
    v_accvgpr_read_b32 v212, a116
    v_accvgpr_read_b32 v213, a117
    v_accvgpr_read_b32 v214, a118
    v_accvgpr_read_b32 v215, a119
    v_xor_b32 v200, 64, v248
    v_xor_b32 v201, 80, v248
    v_mul_f32 v208, v208, v194
    v_mul_f32 v209, v209, v194
    v_mul_f32 v210, v210, v194
    v_mul_f32 v211, v211, v194
    v_mul_f32 v212, v212, v194
    v_mul_f32 v213, v213, v194
    v_mul_f32 v214, v214, v194
    v_mul_f32 v215, v215, v194
    v_cvt_pk_bf16_f32 v224, v208, v209
    v_cvt_pk_bf16_f32 v225, v210, v211
    v_cvt_pk_bf16_f32 v226, v212, v213
    v_cvt_pk_bf16_f32 v227, v214, v215
    ds_write_b64 v200, v[224:225] offset:4096
    ds_write_b64 v201, v[226:227] offset:4096
    v_accvgpr_read_b32 v216, a120
    v_accvgpr_read_b32 v217, a121
    v_accvgpr_read_b32 v218, a122
    v_accvgpr_read_b32 v219, a123
    v_accvgpr_read_b32 v220, a124
    v_accvgpr_read_b32 v221, a125
    v_accvgpr_read_b32 v222, a126
    v_accvgpr_read_b32 v223, a127
    v_xor_b32 v202, 96, v248
    v_xor_b32 v203, 112, v248
    v_mul_f32 v216, v216, v194
    v_mul_f32 v217, v217, v194
    v_mul_f32 v218, v218, v194
    v_mul_f32 v219, v219, v194
    v_mul_f32 v220, v220, v194
    v_mul_f32 v221, v221, v194
    v_mul_f32 v222, v222, v194
    v_mul_f32 v223, v223, v194
    v_cvt_pk_bf16_f32 v228, v216, v217
    v_cvt_pk_bf16_f32 v229, v218, v219
    v_cvt_pk_bf16_f32 v230, v220, v221
    v_cvt_pk_bf16_f32 v231, v222, v223
    ds_write_b64 v202, v[228:229] offset:4096
    ds_write_b64 v203, v[230:231] offset:4096
    ds_read_b128 v[48:51], v249 offset:4096
    ds_read_b128 v[52:55], v249 offset:5120
    ds_read_b128 v[56:59], v249 offset:6144
    ds_read_b128 v[60:63], v249 offset:7168
    s_add_u32 s57, s58, 131200
    s_waitcnt lgkmcnt(3)
    buffer_store_dwordx4 v[48:51], v251, s[16:19], s57 offen sc1
    s_add_u32 s57, s58, 163968
    s_waitcnt lgkmcnt(2)
    buffer_store_dwordx4 v[52:55], v251, s[16:19], s57 offen sc1
    s_add_u32 s57, s58, 196736
    s_waitcnt lgkmcnt(1)
    buffer_store_dwordx4 v[56:59], v251, s[16:19], s57 offen sc1
    s_add_u32 s57, s58, 229504
    s_waitcnt lgkmcnt(0)
    buffer_store_dwordx4 v[60:63], v251, s[16:19], s57 offen sc1
    s_branch L_epi_done
L_prod_T1:
    v_mov_b32 v188, v128
    v_mov_b32 v189, v144
    v_mov_b32 v190, v182
    v_mov_b32 v191, v183
    s_add_u32 s57, s56, 16384
    buffer_store_dwordx4 v[188:191], v181, s[20:23], s57 offen sc1
    s_waitcnt lgkmcnt(8)
    v_mfma_f32_32x32x16_bf16 a[0:15], a[192:195], v[64:67], a[0:15]
    ds_read_b64_tr_b16 a[212:213], v169 offset:53248
    s_waitcnt lgkmcnt(7)
    v_mfma_f32_32x32x16_bf16 a[0:15], a[196:199], v[72:75], a[0:15]
    ds_read_b64_tr_b16 a[214:215], v169 offset:55296
    v_mfma_f32_32x32x16_bf16 a[64:79], a[192:195], v[96:99], a[64:79]
    ds_read_b64_tr_b16 a[216:217], v169 offset:57344
    v_mfma_f32_32x32x16_bf16 a[64:79], a[196:199], v[104:107], a[64:79]
    ds_read_b64_tr_b16 a[218:219], v169 offset:59392
    s_waitcnt lgkmcnt(8)
    v_mfma_f32_32x32x16_bf16 a[0:15], a[200:203], v[80:83], a[0:15]
    ds_read_b64_tr_b16 a[220:221], v169 offset:61440
    s_waitcnt lgkmcnt(7)
    v_mfma_f32_32x32x16_bf16 a[0:15], a[204:207], v[88:91], a[0:15]
    ds_read_b64_tr_b16 a[222:223], v169 offset:63488
    v_mfma_f32_32x32x16_bf16 a[64:79], a[200:203], v[112:115], a[64:79]
    ds_read_b64_tr_b16 a[224:225], v170 offset:49152
    v_mfma_f32_32x32x16_bf16 a[64:79], a[204:207], v[120:123], a[64:79]
    ds_read_b64_tr_b16 a[226:227], v170 offset:51200
    s_waitcnt lgkmcnt(8)
    v_mfma_f32_32x32x16_bf16 a[16:31], a[208:211], v[64:67], a[16:31]
    ds_read_b64_tr_b16 a[228:229], v170 offset:53248
    s_waitcnt lgkmcnt(7)
    v_mfma_f32_32x32x16_bf16 a[16:31], a[212:215], v[72:75], a[16:31]
    ds_read_b64_tr_b16 a[230:231], v170 offset:55296
    s_nop 5
    v_accvgpr_read_b32 v208, a0
    v_accvgpr_read_b32 v209, a1
    v_accvgpr_read_b32 v210, a2
    v_accvgpr_read_b32 v211, a3
    v_accvgpr_read_b32 v212, a4
    v_mfma_f32_32x32x16_bf16 a[80:95], a[208:211], v[96:99], a[80:95]
    ds_read_b64_tr_b16 a[232:233], v170 offset:57344
    v_accvgpr_read_b32 v213, a5
    v_accvgpr_read_b32 v214, a6
    v_accvgpr_read_b32 v215, a7
    v_cvt_pk_bf16_f32 v224, v208, v209
    v_cvt_pk_bf16_f32 v225, v210, v211
    v_mfma_f32_32x32x16_bf16 a[80:95], a[212:215], v[104:107], a[80:95]
    ds_read_b64_tr_b16 a[234:235], v170 offset:59392
    v_cvt_pk_bf16_f32 v226, v212, v213
    v_cvt_pk_bf16_f32 v227, v214, v215
    s_add_u32 s57, s56, 0
    buffer_store_dwordx4 v[224:227], v181, s[20:23], s57 offen offset:0 sc1
    v_accvgpr_read_b32 v216, a8
    s_waitcnt lgkmcnt(8)
    v_mfma_f32_32x32x16_bf16 a[16:31], a[216:219], v[80:83], a[16:31]
    ds_read_b64_tr_b16 a[236:237], v170 offset:61440
    v_accvgpr_read_b32 v217, a9
    v_accvgpr_read_b32 v218, a10
    v_accvgpr_read_b32 v219, a11
    v_accvgpr_read_b32 v220, a12
    v_accvgpr_read_b32 v221, a13
    s_waitcnt lgkmcnt(7)
    v_mfma_f32_32x32x16_bf16 a[16:31], a[220:223], v[88:91], a[16:31]
    ds_read_b64_tr_b16 a[238:239], v170 offset:63488
    v_accvgpr_read_b32 v222, a14
    v_accvgpr_read_b32 v223, a15
    v_cvt_pk_bf16_f32 v228, v216, v217
    v_cvt_pk_bf16_f32 v229, v218, v219
    v_cvt_pk_bf16_f32 v230, v220, v221
    v_mfma_f32_32x32x16_bf16 a[80:95], a[216:219], v[112:115], a[80:95]
    ds_read_b64_tr_b16 a[240:241], v171 offset:49152
    v_cvt_pk_bf16_f32 v231, v222, v223
    s_add_u32 s57, s56, 0
    buffer_store_dwordx4 v[228:231], v181, s[20:23], s57 offen offset:1024 sc1
    v_mfma_f32_32x32x16_bf16 a[80:95], a[220:223], v[120:123], a[80:95]
    ds_read_b64_tr_b16 a[242:243], v171 offset:51200
    s_waitcnt lgkmcnt(8)
    v_mfma_f32_32x32x16_bf16 a[32:47], a[224:227], v[64:67], a[32:47]
    ds_read_b64_tr_b16 a[244:245], v171 offset:53248
    s_waitcnt lgkmcnt(7)
    v_mfma_f32_32x32x16_bf16 a[32:47], a[228:231], v[72:75], a[32:47]
    ds_read_b64_tr_b16 a[246:247], v171 offset:55296
    s_nop 5
    v_accvgpr_read_b32 v208, a16
    v_accvgpr_read_b32 v209, a17
    v_accvgpr_read_b32 v210, a18
    v_accvgpr_read_b32 v211, a19
    v_accvgpr_read_b32 v212, a20
    v_mfma_f32_32x32x16_bf16 a[96:111], a[224:227], v[96:99], a[96:111]
    ds_read_b64_tr_b16 a[248:249], v171 offset:57344
    v_accvgpr_read_b32 v213, a21
    v_accvgpr_read_b32 v214, a22
    v_accvgpr_read_b32 v215, a23
    v_cvt_pk_bf16_f32 v232, v208, v209
    v_cvt_pk_bf16_f32 v233, v210, v211
    v_mfma_f32_32x32x16_bf16 a[96:111], a[228:231], v[104:107], a[96:111]
    ds_read_b64_tr_b16 a[250:251], v171 offset:59392
    v_cvt_pk_bf16_f32 v234, v212, v213
    v_cvt_pk_bf16_f32 v235, v214, v215
    s_add_u32 s57, s56, 0
    buffer_store_dwordx4 v[232:235], v181, s[20:23], s57 offen offset:2048 sc1
    v_accvgpr_read_b32 v216, a24
    s_waitcnt lgkmcnt(8)
    v_mfma_f32_32x32x16_bf16 a[32:47], a[232:235], v[80:83], a[32:47]
    ds_read_b64_tr_b16 a[252:253], v171 offset:61440
    v_accvgpr_read_b32 v217, a25
    v_accvgpr_read_b32 v218, a26
    v_accvgpr_read_b32 v219, a27
    v_accvgpr_read_b32 v220, a28
    v_accvgpr_read_b32 v221, a29
    s_waitcnt lgkmcnt(7)
    v_mfma_f32_32x32x16_bf16 a[32:47], a[236:239], v[88:91], a[32:47]
    ds_read_b64_tr_b16 a[254:255], v171 offset:63488
    v_accvgpr_read_b32 v222, a30
    v_accvgpr_read_b32 v223, a31
    v_cvt_pk_bf16_f32 v236, v216, v217
    v_cvt_pk_bf16_f32 v237, v218, v219
    v_cvt_pk_bf16_f32 v238, v220, v221
    v_mfma_f32_32x32x16_bf16 a[96:111], a[232:235], v[112:115], a[96:111]
    v_cvt_pk_bf16_f32 v239, v222, v223
    s_add_u32 s57, s56, 0
    buffer_store_dwordx4 v[236:239], v181, s[20:23], s57 offen offset:3072 sc1
    v_accvgpr_read_b32 v208, a64
    v_accvgpr_read_b32 v209, a65
    v_mfma_f32_32x32x16_bf16 a[96:111], a[236:239], v[120:123], a[96:111]
    v_accvgpr_read_b32 v210, a66
    v_accvgpr_read_b32 v211, a67
    v_accvgpr_read_b32 v212, a68
    v_accvgpr_read_b32 v213, a69
    v_accvgpr_read_b32 v214, a70
    s_waitcnt lgkmcnt(6)
    v_mfma_f32_32x32x16_bf16 a[48:63], a[240:243], v[64:67], a[48:63]
    v_accvgpr_read_b32 v215, a71
    v_cvt_pk_bf16_f32 v224, v208, v209
    v_cvt_pk_bf16_f32 v225, v210, v211
    v_cvt_pk_bf16_f32 v226, v212, v213
    v_cvt_pk_bf16_f32 v227, v214, v215
    s_waitcnt lgkmcnt(4)
    v_mfma_f32_32x32x16_bf16 a[48:63], a[244:247], v[72:75], a[48:63]
    s_add_u32 s57, s56, 4096
    buffer_store_dwordx4 v[224:227], v181, s[20:23], s57 offen offset:0 sc1
    v_accvgpr_read_b32 v216, a72
    v_accvgpr_read_b32 v217, a73
    v_accvgpr_read_b32 v218, a74
    v_mfma_f32_32x32x16_bf16 a[112:127], a[240:243], v[96:99], a[112:127]
    v_accvgpr_read_b32 v219, a75
    v_accvgpr_read_b32 v220, a76
    v_accvgpr_read_b32 v221, a77
    v_accvgpr_read_b32 v222, a78
    v_accvgpr_read_b32 v223, a79
    v_mfma_f32_32x32x16_bf16 a[112:127], a[244:247], v[104:107], a[112:127]
    v_cvt_pk_bf16_f32 v228, v216, v217
    v_cvt_pk_bf16_f32 v229, v218, v219
    v_cvt_pk_bf16_f32 v230, v220, v221
    v_cvt_pk_bf16_f32 v231, v222, v223
    s_add_u32 s57, s56, 4096
    s_waitcnt lgkmcnt(2)
    v_mfma_f32_32x32x16_bf16 a[48:63], a[248:251], v[80:83], a[48:63]
    buffer_store_dwordx4 v[228:231], v181, s[20:23], s57 offen offset:1024 sc1
    v_accvgpr_read_b32 v208, a80
    v_accvgpr_read_b32 v209, a81
    v_accvgpr_read_b32 v210, a82
    v_accvgpr_read_b32 v211, a83
    s_waitcnt lgkmcnt(0)
    v_mfma_f32_32x32x16_bf16 a[48:63], a[252:255], v[88:91], a[48:63]
    v_accvgpr_read_b32 v212, a84
    v_accvgpr_read_b32 v213, a85
    v_accvgpr_read_b32 v214, a86
    v_accvgpr_read_b32 v215, a87
    v_cvt_pk_bf16_f32 v232, v208, v209
    v_mfma_f32_32x32x16_bf16 a[112:127], a[248:251], v[112:115], a[112:127]
    v_cvt_pk_bf16_f32 v233, v210, v211
    v_cvt_pk_bf16_f32 v234, v212, v213
    v_cvt_pk_bf16_f32 v235, v214, v215
    s_add_u32 s57, s56, 4096
    buffer_store_dwordx4 v[232:235], v181, s[20:23], s57 offen offset:2048 sc1
    v_mfma_f32_32x32x16_bf16 a[112:127], a[252:255], v[120:123], a[112:127]
    v_accvgpr_read_b32 v216, a88
    v_accvgpr_read_b32 v217, a89
    v_accvgpr_read_b32 v218, a90
    v_accvgpr_read_b32 v219, a91
    v_accvgpr_read_b32 v220, a92
    v_accvgpr_read_b32 v221, a93
    v_accvgpr_read_b32 v222, a94
    v_accvgpr_read_b32 v223, a95
    v_cvt_pk_bf16_f32 v236, v216, v217
    v_cvt_pk_bf16_f32 v237, v218, v219
    v_cvt_pk_bf16_f32 v238, v220, v221
    v_cvt_pk_bf16_f32 v239, v222, v223
    s_add_u32 s57, s56, 4096
    buffer_store_dwordx4 v[236:239], v181, s[20:23], s57 offen offset:3072 sc1
    v_accvgpr_read_b32 v208, a32
    v_accvgpr_read_b32 v209, a33
    v_accvgpr_read_b32 v210, a34
    v_accvgpr_read_b32 v211, a35
    v_accvgpr_read_b32 v212, a36
    v_accvgpr_read_b32 v213, a37
    v_accvgpr_read_b32 v214, a38
    v_accvgpr_read_b32 v215, a39
    v_cvt_pk_bf16_f32 v224, v208, v209
    v_cvt_pk_bf16_f32 v225, v210, v211
    v_cvt_pk_bf16_f32 v226, v212, v213
    v_cvt_pk_bf16_f32 v227, v214, v215
    s_add_u32 s57, s56, 8192
    buffer_store_dwordx4 v[224:227], v181, s[20:23], s57 offen offset:0 sc1
    v_accvgpr_read_b32 v216, a40
    v_accvgpr_read_b32 v217, a41
    v_accvgpr_read_b32 v218, a42
    v_accvgpr_read_b32 v219, a43
    v_accvgpr_read_b32 v220, a44
    v_accvgpr_read_b32 v221, a45
    v_accvgpr_read_b32 v222, a46
    v_accvgpr_read_b32 v223, a47
    v_cvt_pk_bf16_f32 v228, v216, v217
    v_cvt_pk_bf16_f32 v229, v218, v219
    v_cvt_pk_bf16_f32 v230, v220, v221
    v_cvt_pk_bf16_f32 v231, v222, v223
    s_add_u32 s57, s56, 8192
    buffer_store_dwordx4 v[228:231], v181, s[20:23], s57 offen offset:1024 sc1
    v_accvgpr_read_b32 v208, a48
    v_accvgpr_read_b32 v209, a49
    v_accvgpr_read_b32 v210, a50
    v_accvgpr_read_b32 v211, a51
    v_accvgpr_read_b32 v212, a52
    v_accvgpr_read_b32 v213, a53
    v_accvgpr_read_b32 v214, a54
    v_accvgpr_read_b32 v215, a55
    v_cvt_pk_bf16_f32 v232, v208, v209
    v_cvt_pk_bf16_f32 v233, v210, v211
    v_cvt_pk_bf16_f32 v234, v212, v213
    v_cvt_pk_bf16_f32 v235, v214, v215
    s_add_u32 s57, s56, 8192
    buffer_store_dwordx4 v[232:235], v181, s[20:23], s57 offen offset:2048 sc1
    v_accvgpr_read_b32 v216, a56
    v_accvgpr_read_b32 v217, a57
    v_accvgpr_read_b32 v218, a58
    v_accvgpr_read_b32 v219, a59
    v_accvgpr_read_b32 v220, a60
    v_accvgpr_read_b32 v221, a61
    v_accvgpr_read_b32 v222, a62
    v_accvgpr_read_b32 v223, a63
    v_cvt_pk_bf16_f32 v236, v216, v217
    v_cvt_pk_bf16_f32 v237, v218, v219
    v_cvt_pk_bf16_f32 v238, v220, v221
    v_cvt_pk_bf16_f32 v239, v222, v223
    s_add_u32 s57, s56, 8192
    buffer_store_dwordx4 v[236:239], v181, s[20:23], s57 offen offset:3072 sc1
    v_accvgpr_read_b32 v208, a96
    v_accvgpr_read_b32 v209, a97
    v_accvgpr_read_b32 v210, a98
    v_accvgpr_read_b32 v211, a99
    v_accvgpr_read_b32 v212, a100
    v_accvgpr_read_b32 v213, a101
    v_accvgpr_read_b32 v214, a102
    v_accvgpr_read_b32 v215, a103
    v_cvt_pk_bf16_f32 v224, v208, v209
    v_cvt_pk_bf16_f32 v225, v210, v211
    v_cvt_pk_bf16_f32 v226, v212, v213
    v_cvt_pk_bf16_f32 v227, v214, v215
    s_add_u32 s57, s56, 12288
    buffer_store_dwordx4 v[224:227], v181, s[20:23], s57 offen offset:0 sc1
    v_accvgpr_read_b32 v216, a104
    v_accvgpr_read_b32 v217, a105
    v_accvgpr_read_b32 v218, a106
    v_accvgpr_read_b32 v219, a107
    v_accvgpr_read_b32 v220, a108
    v_accvgpr_read_b32 v221, a109
    v_accvgpr_read_b32 v222, a110
    v_accvgpr_read_b32 v223, a111
    v_cvt_pk_bf16_f32 v228, v216, v217
    v_cvt_pk_bf16_f32 v229, v218, v219
    v_cvt_pk_bf16_f32 v230, v220, v221
    v_cvt_pk_bf16_f32 v231, v222, v223
    s_add_u32 s57, s56, 12288
    buffer_store_dwordx4 v[228:231], v181, s[20:23], s57 offen offset:1024 sc1
    v_accvgpr_read_b32 v208, a112
    v_accvgpr_read_b32 v209, a113
    v_accvgpr_read_b32 v210, a114
    v_accvgpr_read_b32 v211, a115
    v_accvgpr_read_b32 v212, a116
    v_accvgpr_read_b32 v213, a117
    v_accvgpr_read_b32 v214, a118
    v_accvgpr_read_b32 v215, a119
    v_cvt_pk_bf16_f32 v232, v208, v209
    v_cvt_pk_bf16_f32 v233, v210, v211
    v_cvt_pk_bf16_f32 v234, v212, v213
    v_cvt_pk_bf16_f32 v235, v214, v215
    s_add_u32 s57, s56, 12288
    buffer_store_dwordx4 v[232:235], v181, s[20:23], s57 offen offset:2048 sc1
    v_accvgpr_read_b32 v216, a120
    v_accvgpr_read_b32 v217, a121
    v_accvgpr_read_b32 v218, a122
    v_accvgpr_read_b32 v219, a123
    v_accvgpr_read_b32 v220, a124
    v_accvgpr_read_b32 v221, a125
    v_accvgpr_read_b32 v222, a126
    v_accvgpr_read_b32 v223, a127
    v_cvt_pk_bf16_f32 v236, v216, v217
    v_cvt_pk_bf16_f32 v237, v218, v219
    v_cvt_pk_bf16_f32 v238, v220, v221
    v_cvt_pk_bf16_f32 v239, v222, v223
    s_add_u32 s57, s56, 12288
    buffer_store_dwordx4 v[236:239], v181, s[20:23], s57 offen offset:3072 sc1
    s_add_u32 s80, s49, 1
    s_branch L_epi_done
L_cons_T1:
    s_cmp_eq_u32 s83, 0
    s_cbranch_scc0 L_consd_T1
    s_lshl_b32 s57, s28, 14
    s_add_u32 s57, s57, 65536
    v_add_u32 v188, s57, v181
    s_waitcnt vmcnt(0)
    ds_read_b128 v[0:3], v188 offset:0
    ds_read_b128 v[4:7], v188 offset:1024
    ds_read_b128 v[8:11], v188 offset:2048
    ds_read_b128 v[12:15], v188 offset:3072
    ds_read_b128 v[16:19], v188 offset:4096
    ds_read_b128 v[20:23], v188 offset:5120
    ds_read_b128 v[24:27], v188 offset:6144
    ds_read_b128 v[28:31], v188 offset:7168
    ds_read_b128 v[32:35], v188 offset:8192
    ds_read_b128 v[36:39], v188 offset:9216
    ds_read_b128 v[40:43], v188 offset:10240
    ds_read_b128 v[44:47], v188 offset:11264
    ds_read_b128 v[48:51], v188 offset:12288
    ds_read_b128 v[52:55], v188 offset:13312
    ds_read_b128 v[56:59], v188 offset:14336
    ds_read_b128 v[60:63], v188 offset:15360
    s_waitcnt lgkmcnt(0)
    s_branch L_consj_T1
L_consd_T1:
    s_and_b32 s49, s49, 31
L_poll_T1:
    v_readfirstlane_b32 s57, v187
    s_bitcmp1_b32 s57, 0
    s_cbranch_scc1 L_polled_T1
    s_sleep 16
    buffer_load_ubyte v187, v253, s[24:27], 0 offen sc1
    s_waitcnt vmcnt(0)
    s_branch L_poll_T1
L_polled_T1:
    s_add_u32 s57, s56, 16384
    buffer_load_dwordx4 v[232:235], v181, s[20:23], s57 offen sc1
    s_add_u32 s57, s56, 0
    buffer_load_dwordx4 v[0:3], v181, s[20:23], s57 offen offset:0 sc1
    buffer_load_dwordx4 v[4:7], v181, s[20:23], s57 offen offset:1024 sc1
    buffer_load_dwordx4 v[8:11], v181, s[20:23], s57 offen offset:2048 sc1
    buffer_load_dwordx4 v[12:15], v181, s[20:23], s57 offen offset:3072 sc1
    s_add_u32 s57, s56, 4096
    buffer_load_dwordx4 v[16:19], v181, s[20:23], s57 offen offset:0 sc1
    buffer_load_dwordx4 v[20:23], v181, s[20:23], s57 offen offset:1024 sc1
    buffer_load_dwordx4 v[24:27], v181, s[20:23], s57 offen offset:2048 sc1
    buffer_load_dwordx4 v[28:31], v181, s[20:23], s57 offen offset:3072 sc1
    s_add_u32 s57, s56, 8192
    buffer_load_dwordx4 v[32:35], v181, s[20:23], s57 offen offset:0 sc1
    buffer_load_dwordx4 v[36:39], v181, s[20:23], s57 offen offset:1024 sc1
    buffer_load_dwordx4 v[40:43], v181, s[20:23], s57 offen offset:2048 sc1
    buffer_load_dwordx4 v[44:47], v181, s[20:23], s57 offen offset:3072 sc1
    s_add_u32 s57, s56, 12288
    buffer_load_dwordx4 v[48:51], v181, s[20:23], s57 offen offset:0 sc1
    buffer_load_dwordx4 v[52:55], v181, s[20:23], s57 offen offset:1024 sc1
    buffer_load_dwordx4 v[56:59], v181, s[20:23], s57 offen offset:2048 sc1
    buffer_load_dwordx4 v[60:63], v181, s[20:23], s57 offen offset:3072 sc1
    s_waitcnt vmcnt(16)
L_consj_T1:
    s_mov_b32 s82, 0
    s_mov_b32 s81, 0
    v_min_f32 v188, v128, v232
    v_sub_f32 v236, v188, v128
    v_sub_f32 v238, v188, v232
    v_exp_f32 v236, v236
    v_exp_f32 v238, v238
    s_nop 0
    v_mul_f32 v182, v182, v236
    v_fmac_f32 v182, v234, v238
    v_min_f32 v188, v144, v233
    v_sub_f32 v237, v188, v144
    v_sub_f32 v239, v188, v233
    v_exp_f32 v237, v237
    v_exp_f32 v239, v239
    s_nop 0
    v_mul_f32 v183, v183, v237
    v_fmac_f32 v183, v235, v239
    v_mov_b32 v188, v182
    v_mov_b32 v189, v183
    s_nop 1
    v_permlane32_swap_b32 v182, v188
    v_permlane32_swap_b32 v183, v189
    s_nop 1
    v_add_f32 v182, v182, v188
    v_add_f32 v183, v183, v189
    v_rcp_f32 v182, v182
    v_rcp_f32 v183, v183
    s_nop 1
    v_mul_f32 v192, v236, v182
    v_mul_f32 v193, v236, v182
    v_mul_f32 v196, v238, v182
    v_mul_f32 v197, v238, v182
    v_mul_f32 v194, v237, v183
    v_mul_f32 v195, v237, v183
    v_mul_f32 v198, v239, v183
    v_mul_f32 v199, v239, v183
    s_waitcnt lgkmcnt(8)
    v_mfma_f32_32x32x16_bf16 a[0:15], a[192:195], v[64:67], a[0:15]
    ds_read_b64_tr_b16 a[212:213], v169 offset:53248
    s_waitcnt lgkmcnt(7)
    v_mfma_f32_32x32x16_bf16 a[0:15], a[196:199], v[72:75], a[0:15]
    ds_read_b64_tr_b16 a[214:215], v169 offset:55296
    v_mfma_f32_32x32x16_bf16 a[64:79], a[192:195], v[96:99], a[64:79]
    ds_read_b64_tr_b16 a[216:217], v169 offset:57344
    v_mfma_f32_32x32x16_bf16 a[64:79], a[196:199], v[104:107], a[64:79]
    ds_read_b64_tr_b16 a[218:219], v169 offset:59392
    s_waitcnt lgkmcnt(8)
    v_mfma_f32_32x32x16_bf16 a[0:15], a[200:203], v[80:83], a[0:15]
    ds_read_b64_tr_b16 a[220:221], v169 offset:61440
    s_waitcnt lgkmcnt(7)
    v_mfma_f32_32x32x16_bf16 a[0:15], a[204:207], v[88:91], a[0:15]
    ds_read_b64_tr_b16 a[222:223], v169 offset:63488
    v_mfma_f32_32x32x16_bf16 a[64:79], a[200:203], v[112:115], a[64:79]
    ds_read_b64_tr_b16 a[224:225], v170 offset:49152
    v_mfma_f32_32x32x16_bf16 a[64:79], a[204:207], v[120:123], a[64:79]
    ds_read_b64_tr_b16 a[226:227], v170 offset:51200
    s_waitcnt lgkmcnt(8)
    v_mfma_f32_32x32x16_bf16 a[16:31], a[208:211], v[64:67], a[16:31]
    ds_read_b64_tr_b16 a[228:229], v170 offset:53248
    s_waitcnt lgkmcnt(7)
    v_mfma_f32_32x32x16_bf16 a[16:31], a[212:215], v[72:75], a[16:31]
    ds_read_b64_tr_b16 a[230:231], v170 offset:55296
    s_nop 5
    v_accvgpr_read_b32 v208, a0
    v_accvgpr_read_b32 v209, a1
    v_accvgpr_read_b32 v210, a2
    v_accvgpr_read_b32 v211, a3
    v_accvgpr_read_b32 v212, a4
    v_mfma_f32_32x32x16_bf16 a[80:95], a[208:211], v[96:99], a[80:95]
    ds_read_b64_tr_b16 a[232:233], v170 offset:57344
    v_accvgpr_read_b32 v213, a5
    v_accvgpr_read_b32 v214, a6
    v_accvgpr_read_b32 v215, a7
    v_xor_b32 v200, 0, v248
    v_xor_b32 v201, 16, v248
    v_mfma_f32_32x32x16_bf16 a[80:95], a[212:215], v[104:107], a[80:95]
    ds_read_b64_tr_b16 a[234:235], v170 offset:59392
    v_mul_f32 v208, v208, v192
    v_mul_f32 v209, v209, v192
    v_mul_f32 v210, v210, v192
    v_mul_f32 v211, v211, v192
    v_mul_f32 v212, v212, v192
    s_waitcnt lgkmcnt(8)
    v_mfma_f32_32x32x16_bf16 a[16:31], a[216:219], v[80:83], a[16:31]
    ds_read_b64_tr_b16 a[236:237], v170 offset:61440
    v_mul_f32 v213, v213, v192
    v_mul_f32 v214, v214, v192
    v_mul_f32 v215, v215, v192
    s_waitcnt vmcnt(15)
    v_lshlrev_b32 v240, 16, v0
    s_waitcnt lgkmcnt(7)
    v_mfma_f32_32x32x16_bf16 a[16:31], a[220:223], v[88:91], a[16:31]
    ds_read_b64_tr_b16 a[238:239], v170 offset:63488
    v_and_b32 v241, 0xffff0000, v0
    v_fmac_f32 v208, v240, v196
    v_fmac_f32 v209, v241, v196
    v_lshlrev_b32 v240, 16, v1
    v_and_b32 v241, 0xffff0000, v1
    v_mfma_f32_32x32x16_bf16 a[80:95], a[216:219], v[112:115], a[80:95]
    ds_read_b64_tr_b16 a[240:241], v171 offset:49152
    v_fmac_f32 v210, v240, v196
    v_fmac_f32 v211, v241, v196
    v_lshlrev_b32 v240, 16, v2
    v_and_b32 v241, 0xffff0000, v2
    v_fmac_f32 v212, v240, v196
    v_mfma_f32_32x32x16_bf16 a[80:95], a[220:223], v[120:123], a[80:95]
    ds_read_b64_tr_b16 a[242:243], v171 offset:51200
    v_fmac_f32 v213, v241, v196
    v_lshlrev_b32 v240, 16, v3
    v_and_b32 v241, 0xffff0000, v3
    v_fmac_f32 v214, v240, v196
    v_fmac_f32 v215, v241, v196
    s_waitcnt lgkmcnt(8)
    v_mfma_f32_32x32x16_bf16 a[32:47], a[224:227], v[64:67], a[32:47]
    ds_read_b64_tr_b16 a[244:245], v171 offset:53248
    v_cvt_pk_bf16_f32 v224, v208, v209
    v_cvt_pk_bf16_f32 v225, v210, v211
    v_cvt_pk_bf16_f32 v226, v212, v213
    v_cvt_pk_bf16_f32 v227, v214, v215
    ds_write_b64 v200, v[224:225] offset:0
    s_waitcnt lgkmcnt(8)
    v_mfma_f32_32x32x16_bf16 a[32:47], a[228:231], v[72:75], a[32:47]
    ds_read_b64_tr_b16 a[246:247], v171 offset:55296
    ds_write_b64 v201, v[226:227] offset:0
    v_accvgpr_read_b32 v216, a8
    v_accvgpr_read_b32 v217, a9
    v_accvgpr_read_b32 v218, a10
    v_accvgpr_read_b32 v219, a11
    v_mfma_f32_32x32x16_bf16 a[96:111], a[224:227], v[96:99], a[96:111]
    ds_read_b64_tr_b16 a[248:249], v171 offset:57344
    v_accvgpr_read_b32 v220, a12
    v_accvgpr_read_b32 v221, a13
    v_accvgpr_read_b32 v222, a14
    v_accvgpr_read_b32 v223, a15
    v_xor_b32 v202, 32, v248
    v_mfma_f32_32x32x16_bf16 a[96:111], a[228:231], v[104:107], a[96:111]
    ds_read_b64_tr_b16 a[250:251], v171 offset:59392
    v_xor_b32 v203, 48, v248
    v_mul_f32 v216, v216, v192
    v_mul_f32 v217, v217, v192
    v_mul_f32 v218, v218, v192
    v_mul_f32 v219, v219, v192
    s_waitcnt lgkmcnt(10)
    v_mfma_f32_32x32x16_bf16 a[32:47], a[232:235], v[80:83], a[32:47]
    ds_read_b64_tr_b16 a[252:253], v171 offset:61440
    v_mul_f32 v220, v220, v192
    v_mul_f32 v221, v221, v192
    v_mul_f32 v222, v222, v192
    v_mul_f32 v223, v223, v192
    s_waitcnt vmcnt(14)
    s_waitcnt lgkmcnt(9)
    v_mfma_f32_32x32x16_bf16 a[32:47], a[236:239], v[88:91], a[32:47]
    ds_read_b64_tr_b16 a[254:255], v171 offset:63488
    v_lshlrev_b32 v242, 16, v4
    v_and_b32 v243, 0xffff0000, v4
    v_fmac_f32 v216, v242, v196
    v_fmac_f32 v217, v243, v196
    v_lshlrev_b32 v242, 16, v5
    v_mfma_f32_32x32x16_bf16 a[96:111], a[232:235], v[112:115], a[96:111]
    v_and_b32 v243, 0xffff0000, v5
    v_fmac_f32 v218, v242, v196
    v_fmac_f32 v219, v243, v196
    v_lshlrev_b32 v242, 16, v6
    v_and_b32 v243, 0xffff0000, v6
    v_mfma_f32_32x32x16_bf16 a[96:111], a[236:239], v[120:123], a[96:111]
    v_fmac_f32 v220, v242, v196
    v_fmac_f32 v221, v243, v196
    v_lshlrev_b32 v242, 16, v7
    v_and_b32 v243, 0xffff0000, v7
    v_fmac_f32 v222, v242, v196
    s_waitcnt lgkmcnt(8)
    v_mfma_f32_32x32x16_bf16 a[48:63], a[240:243], v[64:67], a[48:63]
    v_fmac_f32 v223, v243, v196
    v_cvt_pk_bf16_f32 v228, v216, v217
    v_cvt_pk_bf16_f32 v229, v218, v219
    v_cvt_pk_bf16_f32 v230, v220, v221
    v_cvt_pk_bf16_f32 v231, v222, v223
    s_waitcnt lgkmcnt(5)
    v_mfma_f32_32x32x16_bf16 a[48:63], a[244:247], v[72:75], a[48:63]
    ds_write_b64 v202, v[228:229] offset:0
    ds_write_b64 v203, v[230:231] offset:0
    v_accvgpr_read_b32 v208, a16
    v_accvgpr_read_b32 v209, a17
    v_accvgpr_read_b32 v210, a18
    v_mfma_f32_32x32x16_bf16 a[112:127], a[240:243], v[96:99], a[112:127]
    v_accvgpr_read_b32 v211, a19
    v_accvgpr_read_b32 v212, a20
    v_accvgpr_read_b32 v213, a21
    v_accvgpr_read_b32 v214, a22
    v_accvgpr_read_b32 v215, a23
    v_mfma_f32_32x32x16_bf16 a[112:127], a[244:247], v[104:107], a[112:127]
    v_xor_b32 v200, 64, v248
    v_xor_b32 v201, 80, v248
    v_mul_f32 v208, v208, v192
    v_mul_f32 v209, v209, v192
    v_mul_f32 v210, v210, v192
    s_waitcnt lgkmcnt(4)
    v_mfma_f32_32x32x16_bf16 a[48:63], a[248:251], v[80:83], a[48:63]
    v_mul_f32 v211, v211, v192
    v_mul_f32 v212, v212, v192
    v_mul_f32 v213, v213, v192
    v_mul_f32 v214, v214, v192
    v_mul_f32 v215, v215, v192
    s_waitcnt lgkmcnt(2)
    v_mfma_f32_32x32x16_bf16 a[48:63], a[252:255], v[88:91], a[48:63]
    s_waitcnt vmcnt(13)
    v_lshlrev_b32 v240, 16, v8
    v_and_b32 v241, 0xffff0000, v8
    v_fmac_f32 v208, v240, v196
    v_fmac_f32 v209, v241, v196
    v_mfma_f32_32x32x16_bf16 a[112:127], a[248:251], v[112:115], a[112:127]
    v_lshlrev_b32 v240, 16, v9
    v_and_b32 v241, 0xffff0000, v9
    v_fmac_f32 v210, v240, v196
    v_fmac_f32 v211, v241, v196
    v_lshlrev_b32 v240, 16, v10
    v_mfma_f32_32x32x16_bf16 a[112:127], a[252:255], v[120:123], a[112:127]
    v_and_b32 v241, 0xffff0000, v10
    v_fmac_f32 v212, v240, v196
    v_fmac_f32 v213, v241, v196
    v_lshlrev_b32 v240, 16, v11
    v_and_b32 v241, 0xffff0000, v11
    v_fmac_f32 v214, v240, v196
    v_fmac_f32 v215, v241, v196
    v_cvt_pk_bf16_f32 v224, v208, v209
    v_cvt_pk_bf16_f32 v225, v210, v211
    v_cvt_pk_bf16_f32 v226, v212, v213
    v_cvt_pk_bf16_f32 v227, v214, v215
    ds_write_b64 v200, v[224:225] offset:0
    ds_write_b64 v201, v[226:227] offset:0
    v_accvgpr_read_b32 v216, a24
    v_accvgpr_read_b32 v217, a25
    v_accvgpr_read_b32 v218, a26
    v_accvgpr_read_b32 v219, a27
    v_accvgpr_read_b32 v220, a28
    v_accvgpr_read_b32 v221, a29
    v_accvgpr_read_b32 v222, a30
    v_accvgpr_read_b32 v223, a31
    v_xor_b32 v202, 96, v248
    v_xor_b32 v203, 112, v248
    v_mul_f32 v216, v216, v192
    v_mul_f32 v217, v217, v192
    v_mul_f32 v218, v218, v192
    v_mul_f32 v219, v219, v192
    v_mul_f32 v220, v220, v192
    v_mul_f32 v221, v221, v192
    v_mul_f32 v222, v222, v192
    v_mul_f32 v223, v223, v192
    s_waitcnt vmcnt(12)
    v_lshlrev_b32 v242, 16, v12
    v_and_b32 v243, 0xffff0000, v12
    v_fmac_f32 v216, v242, v196
    v_fmac_f32 v217, v243, v196
    v_lshlrev_b32 v242, 16, v13
    v_and_b32 v243, 0xffff0000, v13
    v_fmac_f32 v218, v242, v196
    v_fmac_f32 v219, v243, v196
    v_lshlrev_b32 v242, 16, v14
    v_and_b32 v243, 0xffff0000, v14
    v_fmac_f32 v220, v242, v196
    v_fmac_f32 v221, v243, v196
    v_lshlrev_b32 v242, 16, v15
    v_and_b32 v243, 0xffff0000, v15
    v_fmac_f32 v222, v242, v196
    v_fmac_f32 v223, v243, v196
    v_cvt_pk_bf16_f32 v228, v216, v217
    v_cvt_pk_bf16_f32 v229, v218, v219
    v_cvt_pk_bf16_f32 v230, v220, v221
    v_cvt_pk_bf16_f32 v231, v222, v223
    ds_write_b64 v202, v[228:229] offset:0
    ds_write_b64 v203, v[230:231] offset:0
    ds_read_b128 v[0:3], v249 offset:0
    ds_read_b128 v[4:7], v249 offset:1024
    ds_read_b128 v[8:11], v249 offset:2048
    ds_read_b128 v[12:15], v249 offset:3072
    v_accvgpr_read_b32 v208, a64
    v_accvgpr_read_b32 v209, a65
    v_accvgpr_read_b32 v210, a66
    v_accvgpr_read_b32 v211, a67
    v_accvgpr_read_b32 v212, a68
    v_accvgpr_read_b32 v213, a69
    v_accvgpr_read_b32 v214, a70
    v_accvgpr_read_b32 v215, a71
    v_xor_b32 v200, 0, v248
    v_xor_b32 v201, 16, v248
    s_add_u32 s57, s58, 0
    s_waitcnt lgkmcnt(3)
    buffer_store_dwordx4 v[0:3], v251, s[16:19], s57 offen sc1
    s_add_u32 s57, s58, 32768
    s_waitcnt lgkmcnt(2)
    buffer_store_dwordx4 v[4:7], v251, s[16:19], s57 offen sc1
    s_add_u32 s57, s58, 65536
    s_waitcnt lgkmcnt(1)
    buffer_store_dwordx4 v[8:11], v251, s[16:19], s57 offen sc1
    s_add_u32 s57, s58, 98304
    s_waitcnt lgkmcnt(0)
    buffer_store_dwordx4 v[12:15], v251, s[16:19], s57 offen sc1
    v_mul_f32 v208, v208, v194
    v_mul_f32 v209, v209, v194
    v_mul_f32 v210, v210, v194
    v_mul_f32 v211, v211, v194
    v_mul_f32 v212, v212, v194
    v_mul_f32 v213, v213, v194
    v_mul_f32 v214, v214, v194
    v_mul_f32 v215, v215, v194
    s_waitcnt vmcnt(15)
    v_lshlrev_b32 v240, 16, v16
    v_and_b32 v241, 0xffff0000, v16
    v_fmac_f32 v208, v240, v198
    v_fmac_f32 v209, v241, v198
    v_lshlrev_b32 v240, 16, v17
    v_and_b32 v241, 0xffff0000, v17
    v_fmac_f32 v210, v240, v198
    v_fmac_f32 v211, v241, v198
    v_lshlrev_b32 v240, 16, v18
    v_and_b32 v241, 0xffff0000, v18
    v_fmac_f32 v212, v240, v198
    v_fmac_f32 v213, v241, v198
    v_lshlrev_b32 v240, 16, v19
    v_and_b32 v241, 0xffff0000, v19
    v_fmac_f32 v214, v240, v198
    v_fmac_f32 v215, v241, v198
    v_cvt_pk_bf16_f32 v224, v208, v209
    v_cvt_pk_bf16_f32 v225, v210, v211
    v_cvt_pk_bf16_f32 v226, v212, v213
    v_cvt_pk_bf16_f32 v227, v214, v215
    ds_write_b64 v200, v[224:225] offset:4096
    ds_write_b64 v201, v[226:227] offset:4096
    v_accvgpr_read_b32 v216, a72
    v_accvgpr_read_b32 v217, a73
    v_accvgpr_read_b32 v218, a74
    v_accvgpr_read_b32 v219, a75
    v_accvgpr_read_b32 v220, a76
    v_accvgpr_read_b32 v221, a77
    v_accvgpr_read_b32 v222, a78
    v_accvgpr_read_b32 v223, a79
    v_xor_b32 v202, 32, v248
    v_xor_b32 v203, 48, v248
    v_mul_f32 v216, v216, v194
    v_mul_f32 v217, v217, v194
    v_mul_f32 v218, v218, v194
    v_mul_f32 v219, v219, v194
    v_mul_f32 v220, v220, v194
    v_mul_f32 v221, v221, v194
    v_mul_f32 v222, v222, v194
    v_mul_f32 v223, v223, v194
    s_waitcnt vmcnt(14)
    v_lshlrev_b32 v242, 16, v20
    v_and_b32 v243, 0xffff0000, v20
    v_fmac_f32 v216, v242, v198
    v_fmac_f32 v217, v243, v198
    v_lshlrev_b32 v242, 16, v21
    v_and_b32 v243, 0xffff0000, v21
    v_fmac_f32 v218, v242, v198
    v_fmac_f32 v219, v243, v198
    v_lshlrev_b32 v242, 16, v22
    v_and_b32 v243, 0xffff0000, v22
    v_fmac_f32 v220, v242, v198
    v_fmac_f32 v221, v243, v198
    v_lshlrev_b32 v242, 16, v23
    v_and_b32 v243, 0xffff0000, v23
    v_fmac_f32 v222, v242, v198
    v_fmac_f32 v223, v243, v198
    v_cvt_pk_bf16_f32 v228, v216, v217
    v_cvt_pk_bf16_f32 v229, v218, v219
    v_cvt_pk_bf16_f32 v230, v220, v221
    v_cvt_pk_bf16_f32 v231, v222, v223
    ds_write_b64 v202, v[228:229] offset:4096
    ds_write_b64 v203, v[230:231] offset:4096
    v_accvgpr_read_b32 v208, a80
    v_accvgpr_read_b32 v209, a81
    v_accvgpr_read_b32 v210, a82
    v_accvgpr_read_b32 v211, a83
    v_accvgpr_read_b32 v212, a84
    v_accvgpr_read_b32 v213, a85
    v_accvgpr_read_b32 v214, a86
    v_accvgpr_read_b32 v215, a87
    v_xor_b32 v200, 64, v248
    v_xor_b32 v201, 80, v248
    v_mul_f32 v208, v208, v194
    v_mul_f32 v209, v209, v194
    v_mul_f32 v210, v210, v194
    v_mul_f32 v211, v211, v194
    v_mul_f32 v212, v212, v194
    v_mul_f32 v213, v213, v194
    v_mul_f32 v214, v214, v194
    v_mul_f32 v215, v215, v194
    s_waitcnt vmcnt(13)
    v_lshlrev_b32 v240, 16, v24
    v_and_b32 v241, 0xffff0000, v24
    v_fmac_f32 v208, v240, v198
    v_fmac_f32 v209, v241, v198
    v_lshlrev_b32 v240, 16, v25
    v_and_b32 v241, 0xffff0000, v25
    v_fmac_f32 v210, v240, v198
    v_fmac_f32 v211, v241, v198
    v_lshlrev_b32 v240, 16, v26
    v_and_b32 v241, 0xffff0000, v26
    v_fmac_f32 v212, v240, v198
    v_fmac_f32 v213, v241, v198
    v_lshlrev_b32 v240, 16, v27
    v_and_b32 v241, 0xffff0000, v27
    v_fmac_f32 v214, v240, v198
    v_fmac_f32 v215, v241, v198
    v_cvt_pk_bf16_f32 v224, v208, v209
    v_cvt_pk_bf16_f32 v225, v210, v211
    v_cvt_pk_bf16_f32 v226, v212, v213
    v_cvt_pk_bf16_f32 v227, v214, v215
    ds_write_b64 v200, v[224:225] offset:4096
    ds_write_b64 v201, v[226:227] offset:4096
    v_accvgpr_read_b32 v216, a88
    v_accvgpr_read_b32 v217, a89
    v_accvgpr_read_b32 v218, a90
    v_accvgpr_read_b32 v219, a91
    v_accvgpr_read_b32 v220, a92
    v_accvgpr_read_b32 v221, a93
    v_accvgpr_read_b32 v222, a94
    v_accvgpr_read_b32 v223, a95
    v_xor_b32 v202, 96, v248
    v_xor_b32 v203, 112, v248
    v_mul_f32 v216, v216, v194
    v_mul_f32 v217, v217, v194
    v_mul_f32 v218, v218, v194
    v_mul_f32 v219, v219, v194
    v_mul_f32 v220, v220, v194
    v_mul_f32 v221, v221, v194
    v_mul_f32 v222, v222, v194
    v_mul_f32 v223, v223, v194
    s_waitcnt vmcnt(12)
    v_lshlrev_b32 v242, 16, v28
    v_and_b32 v243, 0xffff0000, v28
    v_fmac_f32 v216, v242, v198
    v_fmac_f32 v217, v243, v198
    v_lshlrev_b32 v242, 16, v29
    v_and_b32 v243, 0xffff0000, v29
    v_fmac_f32 v218, v242, v198
    v_fmac_f32 v219, v243, v198
    v_lshlrev_b32 v242, 16, v30
    v_and_b32 v243, 0xffff0000, v30
    v_fmac_f32 v220, v242, v198
    v_fmac_f32 v221, v243, v198
    v_lshlrev_b32 v242, 16, v31
    v_and_b32 v243, 0xffff0000, v31
    v_fmac_f32 v222, v242, v198
    v_fmac_f32 v223, v243, v198
    v_cvt_pk_bf16_f32 v228, v216, v217
    v_cvt_pk_bf16_f32 v229, v218, v219
    v_cvt_pk_bf16_f32 v230, v220, v221
    v_cvt_pk_bf16_f32 v231, v222, v223
    ds_write_b64 v202, v[228:229] offset:4096
    ds_write_b64 v203, v[230:231] offset:4096
    ds_read_b128 v[16:19], v249 offset:4096
    ds_read_b128 v[20:23], v249 offset:5120
    ds_read_b128 v[24:27], v249 offset:6144
    ds_read_b128 v[28:31], v249 offset:7168
    v_accvgpr_read_b32 v208, a32
    v_accvgpr_read_b32 v209, a33
    v_accvgpr_read_b32 v210, a34
    v_accvgpr_read_b32 v211, a35
    v_accvgpr_read_b32 v212, a36
    v_accvgpr_read_b32 v213, a37
    v_accvgpr_read_b32 v214, a38
    v_accvgpr_read_b32 v215, a39
    v_xor_b32 v200, 0, v248
    v_xor_b32 v201, 16, v248
    s_add_u32 s57, s58, 131072
    s_waitcnt lgkmcnt(3)
    buffer_store_dwordx4 v[16:19], v251, s[16:19], s57 offen sc1
    s_add_u32 s57, s58, 163840
    s_waitcnt lgkmcnt(2)
    buffer_store_dwordx4 v[20:23], v251, s[16:19], s57 offen sc1
    s_add_u32 s57, s58, 196608
    s_waitcnt lgkmcnt(1)
    buffer_store_dwordx4 v[24:27], v251, s[16:19], s57 offen sc1
    s_add_u32 s57, s58, 229376
    s_waitcnt lgkmcnt(0)
    buffer_store_dwordx4 v[28:31], v251, s[16:19], s57 offen sc1
    v_mul_f32 v208, v208, v192
    v_mul_f32 v209, v209, v192
    v_mul_f32 v210, v210, v192
    v_mul_f32 v211, v211, v192
    v_mul_f32 v212, v212, v192
    v_mul_f32 v213, v213, v192
    v_mul_f32 v214, v214, v192
    v_mul_f32 v215, v215, v192
    s_waitcnt vmcnt(15)
    v_lshlrev_b32 v240, 16, v32
    v_and_b32 v241, 0xffff0000, v32
    v_fmac_f32 v208, v240, v196
    v_fmac_f32 v209, v241, v196
    v_lshlrev_b32 v240, 16, v33
    v_and_b32 v241, 0xffff0000, v33
    v_fmac_f32 v210, v240, v196
    v_fmac_f32 v211, v241, v196
    v_lshlrev_b32 v240, 16, v34
    v_and_b32 v241, 0xffff0000, v34
    v_fmac_f32 v212, v240, v196
    v_fmac_f32 v213, v241, v196
    v_lshlrev_b32 v240, 16, v35
    v_and_b32 v241, 0xffff0000, v35
    v_fmac_f32 v214, v240, v196
    v_fmac_f32 v215, v241, v196
    v_cvt_pk_bf16_f32 v224, v208, v209
    v_cvt_pk_bf16_f32 v225, v210, v211
    v_cvt_pk_bf16_f32 v226, v212, v213
    v_cvt_pk_bf16_f32 v227, v214, v215
    ds_write_b64 v200, v[224:225] offset:0
    ds_write_b64 v201, v[226:227] offset:0
    v_accvgpr_read_b32 v216, a40
    v_accvgpr_read_b32 v217, a41
    v_accvgpr_read_b32 v218, a42
    v_accvgpr_read_b32 v219, a43
    v_accvgpr_read_b32 v220, a44
    v_accvgpr_read_b32 v221, a45
    v_accvgpr_read_b32 v222, a46
    v_accvgpr_read_b32 v223, a47
    v_xor_b32 v202, 32, v248
    v_xor_b32 v203, 48, v248
    v_mul_f32 v216, v216, v192
    v_mul_f32 v217, v217, v192
    v_mul_f32 v218, v218, v192
    v_mul_f32 v219, v219, v192
    v_mul_f32 v220, v220, v192
    v_mul_f32 v221, v221, v192
    v_mul_f32 v222, v222, v192
    v_mul_f32 v223, v223, v192
    s_waitcnt vmcnt(14)
    v_lshlrev_b32 v242, 16, v36
    v_and_b32 v243, 0xffff0000, v36
    v_fmac_f32 v216, v242, v196
    v_fmac_f32 v217, v243, v196
    v_lshlrev_b32 v242, 16, v37
    v_and_b32 v243, 0xffff0000, v37
    v_fmac_f32 v218, v242, v196
    v_fmac_f32 v219, v243, v196
    v_lshlrev_b32 v242, 16, v38
    v_and_b32 v243, 0xffff0000, v38
    v_fmac_f32 v220, v242, v196
    v_fmac_f32 v221, v243, v196
    v_lshlrev_b32 v242, 16, v39
    v_and_b32 v243, 0xffff0000, v39
    v_fmac_f32 v222, v242, v196
    v_fmac_f32 v223, v243, v196
    v_cvt_pk_bf16_f32 v228, v216, v217
    v_cvt_pk_bf16_f32 v229, v218, v219
    v_cvt_pk_bf16_f32 v230, v220, v221
    v_cvt_pk_bf16_f32 v231, v222, v223
    ds_write_b64 v202, v[228:229] offset:0
    ds_write_b64 v203, v[230:231] offset:0
    v_accvgpr_read_b32 v208, a48
    v_accvgpr_read_b32 v209, a49
    v_accvgpr_read_b32 v210, a50
    v_accvgpr_read_b32 v211, a51
    v_accvgpr_read_b32 v212, a52
    v_accvgpr_read_b32 v213, a53
    v_accvgpr_read_b32 v214, a54
    v_accvgpr_read_b32 v215, a55
    v_xor_b32 v200, 64, v248
    v_xor_b32 v201, 80, v248
    v_mul_f32 v208, v208, v192
    v_mul_f32 v209, v209, v192
    v_mul_f32 v210, v210, v192
    v_mul_f32 v211, v211, v192
    v_mul_f32 v212, v212, v192
    v_mul_f32 v213, v213, v192
    v_mul_f32 v214, v214, v192
    v_mul_f32 v215, v215, v192
    s_waitcnt vmcnt(13)
    v_lshlrev_b32 v240, 16, v40
    v_and_b32 v241, 0xffff0000, v40
    v_fmac_f32 v208, v240, v196
    v_fmac_f32 v209, v241, v196
    v_lshlrev_b32 v240, 16, v41
    v_and_b32 v241, 0xffff0000, v41
    v_fmac_f32 v210, v240, v196
    v_fmac_f32 v211, v241, v196
    v_lshlrev_b32 v240, 16, v42
    v_and_b32 v241, 0xffff0000, v42
    v_fmac_f32 v212, v240, v196
    v_fmac_f32 v213, v241, v196
    v_lshlrev_b32 v240, 16, v43
    v_and_b32 v241, 0xffff0000, v43
    v_fmac_f32 v214, v240, v196
    v_fmac_f32 v215, v241, v196
    v_cvt_pk_bf16_f32 v224, v208, v209
    v_cvt_pk_bf16_f32 v225, v210, v211
    v_cvt_pk_bf16_f32 v226, v212, v213
    v_cvt_pk_bf16_f32 v227, v214, v215
    ds_write_b64 v200, v[224:225] offset:0
    ds_write_b64 v201, v[226:227] offset:0
    v_accvgpr_read_b32 v216, a56
    v_accvgpr_read_b32 v217, a57
    v_accvgpr_read_b32 v218, a58
    v_accvgpr_read_b32 v219, a59
    v_accvgpr_read_b32 v220, a60
    v_accvgpr_read_b32 v221, a61
    v_accvgpr_read_b32 v222, a62
    v_accvgpr_read_b32 v223, a63
    v_xor_b32 v202, 96, v248
    v_xor_b32 v203, 112, v248
    v_mul_f32 v216, v216, v192
    v_mul_f32 v217, v217, v192
    v_mul_f32 v218, v218, v192
    v_mul_f32 v219, v219, v192
    v_mul_f32 v220, v220, v192
    v_mul_f32 v221, v221, v192
    v_mul_f32 v222, v222, v192
    v_mul_f32 v223, v223, v192
    s_waitcnt vmcnt(12)
    v_lshlrev_b32 v242, 16, v44
    v_and_b32 v243, 0xffff0000, v44
    v_fmac_f32 v216, v242, v196
    v_fmac_f32 v217, v243, v196
    v_lshlrev_b32 v242, 16, v45
    v_and_b32 v243, 0xffff0000, v45
    v_fmac_f32 v218, v242, v196
    v_fmac_f32 v219, v243, v196
    v_lshlrev_b32 v242, 16, v46
    v_and_b32 v243, 0xffff0000, v46
    v_fmac_f32 v220, v242, v196
    v_fmac_f32 v221, v243, v196
    v_lshlrev_b32 v242, 16, v47
    v_and_b32 v243, 0xffff0000, v47
    v_fmac_f32 v222, v242, v196
    v_fmac_f32 v223, v243, v196
    v_cvt_pk_bf16_f32 v228, v216, v217
    v_cvt_pk_bf16_f32 v229, v218, v219
    v_cvt_pk_bf16_f32 v230, v220, v221
    v_cvt_pk_bf16_f32 v231, v222, v223
    ds_write_b64 v202, v[228:229] offset:0
    ds_write_b64 v203, v[230:231] offset:0
    ds_read_b128 v[32:35], v249 offset:0
    ds_read_b128 v[36:39], v249 offset:1024
    ds_read_b128 v[40:43], v249 offset:2048
    ds_read_b128 v[44:47], v249 offset:3072
    v_accvgpr_read_b32 v208, a96
    v_accvgpr_read_b32 v209, a97
    v_accvgpr_read_b32 v210, a98
    v_accvgpr_read_b32 v211, a99
    v_accvgpr_read_b32 v212, a100
    v_accvgpr_read_b32 v213, a101
    v_accvgpr_read_b32 v214, a102
    v_accvgpr_read_b32 v215, a103
    v_xor_b32 v200, 0, v248
    v_xor_b32 v201, 16, v248
    s_add_u32 s57, s58, 128
    s_waitcnt lgkmcnt(3)
    buffer_store_dwordx4 v[32:35], v251, s[16:19], s57 offen sc1
    s_add_u32 s57, s58, 32896
    s_waitcnt lgkmcnt(2)
    buffer_store_dwordx4 v[36:39], v251, s[16:19], s57 offen sc1
    s_add_u32 s57, s58, 65664
    s_waitcnt lgkmcnt(1)
    buffer_store_dwordx4 v[40:43], v251, s[16:19], s57 offen sc1
    s_add_u32 s57, s58, 98432
    s_waitcnt lgkmcnt(0)
    buffer_store_dwordx4 v[44:47], v251, s[16:19], s57 offen sc1
    v_mul_f32 v208, v208, v194
    v_mul_f32 v209, v209, v194
    v_mul_f32 v210, v210, v194
    v_mul_f32 v211, v211, v194
    v_mul_f32 v212, v212, v194
    v_mul_f32 v213, v213, v194
    v_mul_f32 v214, v214, v194
    v_mul_f32 v215, v215, v194
    s_waitcnt vmcnt(15)
    v_lshlrev_b32 v240, 16, v48
    v_and_b32 v241, 0xffff0000, v48
    v_fmac_f32 v208, v240, v198
    v_fmac_f32 v209, v241, v198
    v_lshlrev_b32 v240, 16, v49
    v_and_b32 v241, 0xffff0000, v49
    v_fmac_f32 v210, v240, v198
    v_fmac_f32 v211, v241, v198
    v_lshlrev_b32 v240, 16, v50
    v_and_b32 v241, 0xffff0000, v50
    v_fmac_f32 v212, v240, v198
    v_fmac_f32 v213, v241, v198
    v_lshlrev_b32 v240, 16, v51
    v_and_b32 v241, 0xffff0000, v51
    v_fmac_f32 v214, v240, v198
    v_fmac_f32 v215, v241, v198
    v_cvt_pk_bf16_f32 v224, v208, v209
    v_cvt_pk_bf16_f32 v225, v210, v211
    v_cvt_pk_bf16_f32 v226, v212, v213
    v_cvt_pk_bf16_f32 v227, v214, v215
    ds_write_b64 v200, v[224:225] offset:4096
    ds_write_b64 v201, v[226:227] offset:4096
    v_accvgpr_read_b32 v216, a104
    v_accvgpr_read_b32 v217, a105
    v_accvgpr_read_b32 v218, a106
    v_accvgpr_read_b32 v219, a107
    v_accvgpr_read_b32 v220, a108
    v_accvgpr_read_b32 v221, a109
    v_accvgpr_read_b32 v222, a110
    v_accvgpr_read_b32 v223, a111
    v_xor_b32 v202, 32, v248
    v_xor_b32 v203, 48, v248
    v_mul_f32 v216, v216, v194
    v_mul_f32 v217, v217, v194
    v_mul_f32 v218, v218, v194
    v_mul_f32 v219, v219, v194
    v_mul_f32 v220, v220, v194
    v_mul_f32 v221, v221, v194
    v_mul_f32 v222, v222, v194
    v_mul_f32 v223, v223, v194
    s_waitcnt vmcnt(14)
    v_lshlrev_b32 v242, 16, v52
    v_and_b32 v243, 0xffff0000, v52
    v_fmac_f32 v216, v242, v198
    v_fmac_f32 v217, v243, v198
    v_lshlrev_b32 v242, 16, v53
    v_and_b32 v243, 0xffff0000, v53
    v_fmac_f32 v218, v242, v198
    v_fmac_f32 v219, v243, v198
    v_lshlrev_b32 v242, 16, v54
    v_and_b32 v243, 0xffff0000, v54
    v_fmac_f32 v220, v242, v198
    v_fmac_f32 v221, v243, v198
    v_lshlrev_b32 v242, 16, v55
    v_and_b32 v243, 0xffff0000, v55
    v_fmac_f32 v222, v242, v198
    v_fmac_f32 v223, v243, v198
    v_cvt_pk_bf16_f32 v228, v216, v217
    v_cvt_pk_bf16_f32 v229, v218, v219
    v_cvt_pk_bf16_f32 v230, v220, v221
    v_cvt_pk_bf16_f32 v231, v222, v223
    ds_write_b64 v202, v[228:229] offset:4096
    ds_write_b64 v203, v[230:231] offset:4096
    v_accvgpr_read_b32 v208, a112
    v_accvgpr_read_b32 v209, a113
    v_accvgpr_read_b32 v210, a114
    v_accvgpr_read_b32 v211, a115
    v_accvgpr_read_b32 v212, a116
    v_accvgpr_read_b32 v213, a117
    v_accvgpr_read_b32 v214, a118
    v_accvgpr_read_b32 v215, a119
    v_xor_b32 v200, 64, v248
    v_xor_b32 v201, 80, v248
    v_mul_f32 v208, v208, v194
    v_mul_f32 v209, v209, v194
    v_mul_f32 v210, v210, v194
    v_mul_f32 v211, v211, v194
    v_mul_f32 v212, v212, v194
    v_mul_f32 v213, v213, v194
    v_mul_f32 v214, v214, v194
    v_mul_f32 v215, v215, v194
    s_waitcnt vmcnt(13)
    v_lshlrev_b32 v240, 16, v56
    v_and_b32 v241, 0xffff0000, v56
    v_fmac_f32 v208, v240, v198
    v_fmac_f32 v209, v241, v198
    v_lshlrev_b32 v240, 16, v57
    v_and_b32 v241, 0xffff0000, v57
    v_fmac_f32 v210, v240, v198
    v_fmac_f32 v211, v241, v198
    v_lshlrev_b32 v240, 16, v58
    v_and_b32 v241, 0xffff0000, v58
    v_fmac_f32 v212, v240, v198
    v_fmac_f32 v213, v241, v198
    v_lshlrev_b32 v240, 16, v59
    v_and_b32 v241, 0xffff0000, v59
    v_fmac_f32 v214, v240, v198
    v_fmac_f32 v215, v241, v198
    v_cvt_pk_bf16_f32 v224, v208, v209
    v_cvt_pk_bf16_f32 v225, v210, v211
    v_cvt_pk_bf16_f32 v226, v212, v213
    v_cvt_pk_bf16_f32 v227, v214, v215
    ds_write_b64 v200, v[224:225] offset:4096
    ds_write_b64 v201, v[226:227] offset:4096
    v_accvgpr_read_b32 v216, a120
    v_accvgpr_read_b32 v217, a121
    v_accvgpr_read_b32 v218, a122
    v_accvgpr_read_b32 v219, a123
    v_accvgpr_read_b32 v220, a124
    v_accvgpr_read_b32 v221, a125
    v_accvgpr_read_b32 v222, a126
    v_accvgpr_read_b32 v223, a127
    v_xor_b32 v202, 96, v248
    v_xor_b32 v203, 112, v248
    v_mul_f32 v216, v216, v194
    v_mul_f32 v217, v217, v194
    v_mul_f32 v218, v218, v194
    v_mul_f32 v219, v219, v194
    v_mul_f32 v220, v220, v194
    v_mul_f32 v221, v221, v194
    v_mul_f32 v222, v222, v194
    v_mul_f32 v223, v223, v194
    s_waitcnt vmcnt(12)
    v_lshlrev_b32 v242, 16, v60
    v_and_b32 v243, 0xffff0000, v60
    v_fmac_f32 v216, v242, v198
    v_fmac_f32 v217, v243, v198
    v_lshlrev_b32 v242, 16, v61
    v_and_b32 v243, 0xffff0000, v61
    v_fmac_f32 v218, v242, v198
    v_fmac_f32 v219, v243, v198
    v_lshlrev_b32 v242, 16, v62
    v_and_b32 v243, 0xffff0000, v62
    v_fmac_f32 v220, v242, v198
    v_fmac_f32 v221, v243, v198
    v_lshlrev_b32 v242, 16, v63
    v_and_b32 v243, 0xffff0000, v63
    v_fmac_f32 v222, v242, v198
    v_fmac_f32 v223, v243, v198
    v_cvt_pk_bf16_f32 v228, v216, v217
    v_cvt_pk_bf16_f32 v229, v218, v219
    v_cvt_pk_bf16_f32 v230, v220, v221
    v_cvt_pk_bf16_f32 v231, v222, v223
    ds_write_b64 v202, v[228:229] offset:4096
    ds_write_b64 v203, v[230:231] offset:4096
    ds_read_b128 v[48:51], v249 offset:4096
    ds_read_b128 v[52:55], v249 offset:5120
    ds_read_b128 v[56:59], v249 offset:6144
    ds_read_b128 v[60:63], v249 offset:7168
    s_add_u32 s57, s58, 131200
    s_waitcnt lgkmcnt(3)
    buffer_store_dwordx4 v[48:51], v251, s[16:19], s57 offen sc1
    s_add_u32 s57, s58, 163968
    s_waitcnt lgkmcnt(2)
    buffer_store_dwordx4 v[52:55], v251, s[16:19], s57 offen sc1
    s_add_u32 s57, s58, 196736
    s_waitcnt lgkmcnt(1)
    buffer_store_dwordx4 v[56:59], v251, s[16:19], s57 offen sc1
    s_add_u32 s57, s58, 229504
    s_waitcnt lgkmcnt(0)
    buffer_store_dwordx4 v[60:63], v251, s[16:19], s57 offen sc1
    s_branch L_epi_done
L_tail0:
    s_waitcnt lgkmcnt(0)
    ds_read_b64_tr_b16 a[192:193], v168 offset:32768
    ds_read_b64_tr_b16 a[194:195], v168 offset:34816
    ds_read_b64_tr_b16 a[196:197], v168 offset:36864
    ds_read_b64_tr_b16 a[198:199], v168 offset:38912
    ds_read_b64_tr_b16 a[200:201], v168 offset:40960
    ds_read_b64_tr_b16 a[202:203], v168 offset:43008
    ds_read_b64_tr_b16 a[204:205], v168 offset:45056
    ds_read_b64_tr_b16 a[206:207], v168 offset:47104
    ds_read_b64_tr_b16 a[208:209], v169 offset:32768
    ds_read_b64_tr_b16 a[210:211], v169 offset:34816
    v_exp_f32 v16, v16
    v_exp_f32 v17, v17
    v_add_f32 v184, v184, v16
    v_exp_f32 v18, v18
    v_add_f32 v184, v184, v17
    v_cvt_pk_bf16_f32 v16, v16, v17
    v_exp_f32 v19, v19
    v_add_f32 v184, v184, v18
    v_exp_f32 v20, v20
    v_add_f32 v184, v184, v19
    v_cvt_pk_bf16_f32 v17, v18, v19
    v_exp_f32 v21, v21
    v_add_f32 v184, v184, v20
    v_exp_f32 v22, v22
    v_add_f32 v184, v184, v21
    v_cvt_pk_bf16_f32 v18, v20, v21
    v_exp_f32 v23, v23
    v_add_f32 v184, v184, v22
    v_exp_f32 v24, v24
    v_add_f32 v184, v184, v23
    v_cvt_pk_bf16_f32 v19, v22, v23
    v_exp_f32 v25, v25
    v_add_f32 v184, v184, v24
    v_exp_f32 v26, v26
    v_add_f32 v184, v184, v25
    v_cvt_pk_bf16_f32 v24, v24, v25
    v_exp_f32 v27, v27
    v_add_f32 v184, v184, v26
    v_exp_f32 v28, v28
    v_add_f32 v184, v184, v27
    v_cvt_pk_bf16_f32 v25, v26, v27
    v_exp_f32 v29, v29
    v_add_f32 v184, v184, v28
    v_exp_f32 v30, v30
    v_add_f32 v184, v184, v29
    v_cvt_pk_bf16_f32 v26, v28, v29
    v_exp_f32 v31, v31
    v_add_f32 v184, v184, v30
    v_exp_f32 v48, v48
    v_add_f32 v184, v184, v31
    v_cvt_pk_bf16_f32 v27, v30, v31
    v_exp_f32 v49, v49
    v_add_f32 v185, v185, v48
    v_exp_f32 v50, v50
    v_add_f32 v185, v185, v49
    v_cvt_pk_bf16_f32 v48, v48, v49
    v_exp_f32 v51, v51
    v_add_f32 v185, v185, v50
    v_exp_f32 v52, v52
    v_add_f32 v185, v185, v51
    v_cvt_pk_bf16_f32 v49, v50, v51
    v_exp_f32 v53, v53
    v_add_f32 v185, v185, v52
    v_exp_f32 v54, v54
    v_add_f32 v185, v185, v53
    v_cvt_pk_bf16_f32 v50, v52, v53
    v_exp_f32 v55, v55
    v_add_f32 v185, v185, v54
    v_exp_f32 v56, v56
    v_add_f32 v185, v185, v55
    v_cvt_pk_bf16_f32 v51, v54, v55
    v_exp_f32 v57, v57
    v_add_f32 v185, v185, v56
    v_exp_f32 v58, v58
    v_add_f32 v185, v185, v57
    v_cvt_pk_bf16_f32 v56, v56, v57
    v_exp_f32 v59, v59
    v_add_f32 v185, v185, v58
    v_exp_f32 v60, v60
    v_add_f32 v185, v185, v59
    v_cvt_pk_bf16_f32 v57, v58, v59
    v_exp_f32 v61, v61
    v_add_f32 v185, v185, v60
    v_exp_f32 v62, v62
    v_add_f32 v185, v185, v61
    v_cvt_pk_bf16_f32 v58, v60, v61
    v_exp_f32 v63, v63
    v_add_f32 v185, v185, v62
    s_nop 0
    v_add_f32 v185, v185, v63
    v_cvt_pk_bf16_f32 v59, v62, v63
    v_max_f32 v188, v184, v185
    s_nop 0
    v_cmp_nge_f32 vcc, s44, v188
    s_cbranch_vccnz L_stub_T0
L_back_T0:
    v_add_f32 v182, v182, v184
    v_add_f32 v183, v183, v185
    s_mov_b32 s58, s32
    s_mov_b32 s59, s55
    s_mov_b32 s30, s39
    s_bitcmp1_b32 s39, 0
    s_cbranch_scc0 L_nopf_T0
    s_mov_b64 s[32:33], s[64:65]
    s_mov_b64 s[34:35], s[66:67]
    s_mov_b64 s[36:37], s[68:69]
    s_mov_b64 s[38:39], s[70:71]
    s_call_b64 s[60:61], L_setup
L_nopf_T0:
    s_and_b32 s48, s59, 3
    s_lshr_b32 s49, s59, 4
    s_mul_i32 s56, s49, 17408
    s_cmp_eq_u32 s48, 1
    s_cbranch_scc1 L_prod_T0
    s_call_b64 s[60:61], L_epiaddr
    s_cmp_eq_u32 s48, 2
    s_cbranch_scc1 L_cons_T0
    v_mov_b32 v188, v182
    v_mov_b32 v189, v183
    s_nop 1
    v_permlane32_swap_b32 v182, v188
    v_permlane32_swap_b32 v183, v189
    s_nop 1
    v_add_f32 v182, v182, v188
    v_add_f32 v183, v183, v189
    v_rcp_f32 v192, v182
    v_rcp_f32 v194, v183
    s_nop 1
    v_mov_b32 v193, v192
    v_mov_b32 v195, v194
    s_waitcnt lgkmcnt(8)
    v_mfma_f32_32x32x16_bf16 a[0:15], a[192:195], v[0:3], a[0:15]
    ds_read_b64_tr_b16 a[212:213], v169 offset:36864
    s_waitcnt lgkmcnt(7)
    v_mfma_f32_32x32x16_bf16 a[0:15], a[196:199], v[8:11], a[0:15]
    ds_read_b64_tr_b16 a[214:215], v169 offset:38912
    v_mfma_f32_32x32x16_bf16 a[64:79], a[192:195], v[32:35], a[64:79]
    ds_read_b64_tr_b16 a[216:217], v169 offset:40960
    v_mfma_f32_32x32x16_bf16 a[64:79], a[196:199], v[40:43], a[64:79]
    ds_read_b64_tr_b16 a[218:219], v169 offset:43008
    s_waitcnt lgkmcnt(8)
    v_mfma_f32_32x32x16_bf16 a[0:15], a[200:203], v[16:19], a[0:15]
    ds_read_b64_tr_b16 a[220:221], v169 offset:45056
    s_waitcnt lgkmcnt(7)
    v_mfma_f32_32x32x16_bf16 a[0:15], a[204:207], v[24:27], a[0:15]
    ds_read_b64_tr_b16 a[222:223], v169 offset:47104
    v_mfma_f32_32x32x16_bf16 a[64:79], a[200:203], v[48:51], a[64:79]
    ds_read_b64_tr_b16 a[224:225], v170 offset:32768
    v_mfma_f32_32x32x16_bf16 a[64:79], a[204:207], v[56:59], a[64:79]
    ds_read_b64_tr_b16 a[226:227], v170 offset:34816
    s_waitcnt lgkmcnt(8)
    v_mfma_f32_32x32x16_bf16 a[16:31], a[208:211], v[0:3], a[16:31]
    ds_read_b64_tr_b16 a[228:229], v170 offset:36864
    s_waitcnt lgkmcnt(7)
    v_mfma_f32_32x32x16_bf16 a[16:31], a[212:215], v[8:11], a[16:31]
    ds_read_b64_tr_b16 a[230:231], v170 offset:38912
    s_nop 5
    v_accvgpr_read_b32 v208, a0
    v_accvgpr_read_b32 v209, a1
    v_accvgpr_read_b32 v210, a2
    v_accvgpr_read_b32 v211, a3
    v_accvgpr_read_b32 v212, a4
    v_mfma_f32_32x32x16_bf16 a[80:95], a[208:211], v[32:35], a[80:95]
    ds_read_b64_tr_b16 a[232:233], v170 offset:40960
    v_accvgpr_read_b32 v213, a5
    v_accvgpr_read_b32 v214, a6
    v_accvgpr_read_b32 v215, a7
    v_xor_b32 v200, 0, v248
    v_xor_b32 v201, 16, v248
    v_mfma_f32_32x32x16_bf16 a[80:95], a[212:215], v[40:43], a[80:95]
    ds_read_b64_tr_b16 a[234:235], v170 offset:43008
    v_mul_f32 v208, v208, v192
    v_mul_f32 v209, v209, v192
    v_mul_f32 v210, v210, v192
    v_mul_f32 v211, v211, v192
    v_mul_f32 v212, v212, v192
    s_waitcnt lgkmcnt(8)
    v_mfma_f32_32x32x16_bf16 a[16:31], a[216:219], v[16:19], a[16:31]
    ds_read_b64_tr_b16 a[236:237], v170 offset:45056
    v_mul_f32 v213, v213, v192
    v_mul_f32 v214, v214, v192
    v_mul_f32 v215, v215, v192
    v_cvt_pk_bf16_f32 v224, v208, v209
    v_cvt_pk_bf16_f32 v225, v210, v211
    s_waitcnt lgkmcnt(7)
    v_mfma_f32_32x32x16_bf16 a[16:31], a[220:223], v[24:27], a[16:31]
    ds_read_b64_tr_b16 a[238:239], v170 offset:47104
    v_cvt_pk_bf16_f32 v226, v212, v213
    v_cvt_pk_bf16_f32 v227, v214, v215
    ds_write_b64 v200, v[224:225] offset:0
    ds_write_b64 v201, v[226:227] offset:0
    v_accvgpr_read_b32 v216, a8
    v_mfma_f32_32x32x16_bf16 a[80:95], a[216:219], v[48:51], a[80:95]
    ds_read_b64_tr_b16 a[240:241], v171 offset:32768
    v_accvgpr_read_b32 v217, a9
    v_accvgpr_read_b32 v218, a10
    v_accvgpr_read_b32 v219, a11
    v_accvgpr_read_b32 v220, a12
    v_accvgpr_read_b32 v221, a13
    v_mfma_f32_32x32x16_bf16 a[80:95], a[220:223], v[56:59], a[80:95]
    ds_read_b64_tr_b16 a[242:243], v171 offset:34816
    v_accvgpr_read_b32 v222, a14
    v_accvgpr_read_b32 v223, a15
    v_xor_b32 v202, 32, v248
    v_xor_b32 v203, 48, v248
    v_mul_f32 v216, v216, v192
    s_waitcnt lgkmcnt(10)
    v_mfma_f32_32x32x16_bf16 a[32:47], a[224:227], v[0:3], a[32:47]
    ds_read_b64_tr_b16 a[244:245], v171 offset:36864
    v_mul_f32 v217, v217, v192
    v_mul_f32 v218, v218, v192
    v_mul_f32 v219, v219, v192
    v_mul_f32 v220, v220, v192
    v_mul_f32 v221, v221, v192
    s_waitcnt lgkmcnt(9)
    v_mfma_f32_32x32x16_bf16 a[32:47], a[228:231], v[8:11], a[32:47]
    ds_read_b64_tr_b16 a[246:247], v171 offset:38912
    v_mul_f32 v222, v222, v192
    v_mul_f32 v223, v223, v192
    v_cvt_pk_bf16_f32 v228, v216, v217
    v_cvt_pk_bf16_f32 v229, v218, v219
    v_cvt_pk_bf16_f32 v230, v220, v221
    v_mfma_f32_32x32x16_bf16 a[96:111], a[224:227], v[32:35], a[96:111]
    ds_read_b64_tr_b16 a[248:249], v171 offset:40960
    v_cvt_pk_bf16_f32 v231, v222, v223
    ds_write_b64 v202, v[228:229] offset:0
    ds_write_b64 v203, v[230:231] offset:0
    v_accvgpr_read_b32 v208, a16
    v_accvgpr_read_b32 v209, a17
    v_mfma_f32_32x32x16_bf16 a[96:111], a[228:231], v[40:43], a[96:111]
    ds_read_b64_tr_b16 a[250:251], v171 offset:43008
    v_accvgpr_read_b32 v210, a18
    v_accvgpr_read_b32 v211, a19
    v_accvgpr_read_b32 v212, a20
    v_accvgpr_read_b32 v213, a21
    v_accvgpr_read_b32 v214, a22
    s_waitcnt lgkmcnt(12)
    v_mfma_f32_32x32x16_bf16 a[32:47], a[232:235], v[16:19], a[32:47]
    ds_read_b64_tr_b16 a[252:253], v171 offset:45056
    v_accvgpr_read_b32 v215, a23
    v_xor_b32 v200, 64, v248
    v_xor_b32 v201, 80, v248
    v_mul_f32 v208, v208, v192
    v_mul_f32 v209, v209, v192
    s_waitcnt lgkmcnt(11)
    v_mfma_f32_32x32x16_bf16 a[32:47], a[236:239], v[24:27], a[32:47]
    ds_read_b64_tr_b16 a[254:255], v171 offset:47104
    v_mul_f32 v210, v210, v192
    v_mul_f32 v211, v211, v192
    v_mul_f32 v212, v212, v192
    v_mul_f32 v213, v213, v192
    v_mul_f32 v214, v214, v192
    v_mfma_f32_32x32x16_bf16 a[96:111], a[232:235], v[48:51], a[96:111]
    v_mul_f32 v215, v215, v192
    v_cvt_pk_bf16_f32 v224, v208, v209
    v_cvt_pk_bf16_f32 v225, v210, v211
    v_cvt_pk_bf16_f32 v226, v212, v213
    v_cvt_pk_bf16_f32 v227, v214, v215
    v_mfma_f32_32x32x16_bf16 a[96:111], a[236:239], v[56:59], a[96:111]
    ds_write_b64 v200, v[224:225] offset:0
    ds_write_b64 v201, v[226:227] offset:0
    v_accvgpr_read_b32 v216, a24
    v_accvgpr_read_b32 v217, a25
    v_accvgpr_read_b32 v218, a26
    s_waitcnt lgkmcnt(10)
    v_mfma_f32_32x32x16_bf16 a[48:63], a[240:243], v[0:3], a[48:63]
    v_accvgpr_read_b32 v219, a27
    v_accvgpr_read_b32 v220, a28
    v_accvgpr_read_b32 v221, a29
    v_accvgpr_read_b32 v222, a30
    v_accvgpr_read_b32 v223, a31
    s_waitcnt lgkmcnt(8)
    v_mfma_f32_32x32x16_bf16 a[48:63], a[244:247], v[8:11], a[48:63]
    v_xor_b32 v202, 96, v248
    v_xor_b32 v203, 112, v248
    v_mul_f32 v216, v216, v192
    v_mul_f32 v217, v217, v192
    v_mul_f32 v218, v218, v192
    v_mfma_f32_32x32x16_bf16 a[112:127], a[240:243], v[32:35], a[112:127]
    v_mul_f32 v219, v219, v192
    v_mul_f32 v220, v220, v192
    v_mul_f32 v221, v221, v192
    v_mul_f32 v222, v222, v192
    v_mul_f32 v223, v223, v192
    v_mfma_f32_32x32x16_bf16 a[112:127], a[244:247], v[40:43], a[112:127]
    v_cvt_pk_bf16_f32 v228, v216, v217
    v_cvt_pk_bf16_f32 v229, v218, v219
    v_cvt_pk_bf16_f32 v230, v220, v221
    v_cvt_pk_bf16_f32 v231, v222, v223
    ds_write_b64 v202, v[228:229] offset:0
    s_waitcnt lgkmcnt(5)
    v_mfma_f32_32x32x16_bf16 a[48:63], a[248:251], v[16:19], a[48:63]
    ds_write_b64 v203, v[230:231] offset:0
    ds_read_b128 v[64:67], v249 offset:0
    ds_read_b128 v[68:71], v249 offset:1024
    ds_read_b128 v[72:75], v249 offset:2048
    ds_read_b128 v[76:79], v249 offset:3072
    s_waitcnt lgkmcnt(8)
    v_mfma_f32_32x32x16_bf16 a[48:63], a[252:255], v[24:27], a[48:63]
    v_accvgpr_read_b32 v208, a64
    v_accvgpr_read_b32 v209, a65
    v_accvgpr_read_b32 v210, a66
    v_accvgpr_read_b32 v211, a67
    v_accvgpr_read_b32 v212, a68
    v_mfma_f32_32x32x16_bf16 a[112:127], a[248:251], v[48:51], a[112:127]
    v_accvgpr_read_b32 v213, a69
    v_accvgpr_read_b32 v214, a70
    v_accvgpr_read_b32 v215, a71
    v_xor_b32 v200, 0, v248
    v_xor_b32 v201, 16, v248
    v_mfma_f32_32x32x16_bf16 a[112:127], a[252:255], v[56:59], a[112:127]
    s_add_u32 s57, s58, 0
    s_waitcnt lgkmcnt(3)
    buffer_store_dwordx4 v[64:67], v251, s[16:19], s57 offen sc1
    s_add_u32 s57, s58, 32768
    s_waitcnt lgkmcnt(2)
    buffer_store_dwordx4 v[68:71], v251, s[16:19], s57 offen sc1
    s_add_u32 s57, s58, 65536
    s_waitcnt lgkmcnt(1)
    buffer_store_dwordx4 v[72:75], v251, s[16:19], s57 offen sc1
    s_add_u32 s57, s58, 98304
    s_waitcnt lgkmcnt(0)
    buffer_store_dwordx4 v[76:79], v251, s[16:19], s57 offen sc1
    v_mul_f32 v208, v208, v194
    v_mul_f32 v209, v209, v194
    v_mul_f32 v210, v210, v194
    v_mul_f32 v211, v211, v194
    v_mul_f32 v212, v212, v194
    v_mul_f32 v213, v213, v194
    v_mul_f32 v214, v214, v194
    v_mul_f32 v215, v215, v194
    v_cvt_pk_bf16_f32 v224, v208, v209
    v_cvt_pk_bf16_f32 v225, v210, v211
    v_cvt_pk_bf16_f32 v226, v212, v213
    v_cvt_pk_bf16_f32 v227, v214, v215
    ds_write_b64 v200, v[224:225] offset:4096
    ds_write_b64 v201, v[226:227] offset:4096
    v_accvgpr_read_b32 v216, a72
    v_accvgpr_read_b32 v217, a73
    v_accvgpr_read_b32 v218, a74
    v_accvgpr_read_b32 v219, a75
    v_accvgpr_read_b32 v220, a76
    v_accvgpr_read_b32 v221, a77
    v_accvgpr_read_b32 v222, a78
    v_accvgpr_read_b32 v223, a79
    v_xor_b32 v202, 32, v248
    v_xor_b32 v203, 48, v248
    v_mul_f32 v216, v216, v194
    v_mul_f32 v217, v217, v194
    v_mul_f32 v218, v218, v194
    v_mul_f32 v219, v219, v194
    v_mul_f32 v220, v220, v194
    v_mul_f32 v221, v221, v194
    v_mul_f32 v222, v222, v194
    v_mul_f32 v223, v223, v194
    v_cvt_pk_bf16_f32 v228, v216, v217
    v_cvt_pk_bf16_f32 v229, v218, v219
    v_cvt_pk_bf16_f32 v230, v220, v221
    v_cvt_pk_bf16_f32 v231, v222, v223
    ds_write_b64 v202, v[228:229] offset:4096
    ds_write_b64 v203, v[230:231] offset:4096
    v_accvgpr_read_b32 v208, a80
    v_accvgpr_read_b32 v209, a81
    v_accvgpr_read_b32 v210, a82
    v_accvgpr_read_b32 v211, a83
    v_accvgpr_read_b32 v212, a84
    v_accvgpr_read_b32 v213, a85
    v_accvgpr_read_b32 v214, a86
    v_accvgpr_read_b32 v215, a87
    v_xor_b32 v200, 64, v248
    v_xor_b32 v201, 80, v248
    v_mul_f32 v208, v208, v194
    v_mul_f32 v209, v209, v194
    v_mul_f32 v210, v210, v194
    v_mul_f32 v211, v211, v194
    v_mul_f32 v212, v212, v194
    v_mul_f32 v213, v213, v194
    v_mul_f32 v214, v214, v194
    v_mul_f32 v215, v215, v194
    v_cvt_pk_bf16_f32 v224, v208, v209
    v_cvt_pk_bf16_f32 v225, v210, v211
    v_cvt_pk_bf16_f32 v226, v212, v213
    v_cvt_pk_bf16_f32 v227, v214, v215
    ds_write_b64 v200, v[224:225] offset:4096
    ds_write_b64 v201, v[226:227] offset:4096
    v_accvgpr_read_b32 v216, a88
    v_accvgpr_read_b32 v217, a89
    v_accvgpr_read_b32 v218, a90
    v_accvgpr_read_b32 v219, a91
    v_accvgpr_read_b32 v220, a92
    v_accvgpr_read_b32 v221, a93
    v_accvgpr_read_b32 v222, a94
    v_accvgpr_read_b32 v223, a95
    v_xor_b32 v202, 96, v248
    v_xor_b32 v203, 112, v248
    v_mul_f32 v216, v216, v194
    v_mul_f32 v217, v217, v194
    v_mul_f32 v218, v218, v194
    v_mul_f32 v219, v219, v194
    v_mul_f32 v220, v220, v194
    v_mul_f32 v221, v221, v194
    v_mul_f32 v222, v222, v194
    v_mul_f32 v223, v223, v194
    v_cvt_pk_bf16_f32 v228, v216, v217
    v_cvt_pk_bf16_f32 v229, v218, v219
    v_cvt_pk_bf16_f32 v230, v220, v221
    v_cvt_pk_bf16_f32 v231, v222, v223
    ds_write_b64 v202, v[228:229] offset:4096
    ds_write_b64 v203, v[230:231] offset:4096
    ds_read_b128 v[80:83], v249 offset:4096
    ds_read_b128 v[84:87], v249 offset:5120
    ds_read_b128 v[88:91], v249 offset:6144
    ds_read_b128 v[92:95], v249 offset:7168
    v_accvgpr_read_b32 v208, a32
    v_accvgpr_read_b32 v209, a33
    v_accvgpr_read_b32 v210, a34
    v_accvgpr_read_b32 v211, a35
    v_accvgpr_read_b32 v212, a36
    v_accvgpr_read_b32 v213, a37
    v_accvgpr_read_b32 v214, a38
    v_accvgpr_read_b32 v215, a39
    v_xor_b32 v200, 0, v248
    v_xor_b32 v201, 16, v248
    s_add_u32 s57, s58, 131072
    s_waitcnt lgkmcnt(3)
    buffer_store_dwordx4 v[80:83], v251, s[16:19], s57 offen sc1
    s_add_u32 s57, s58, 163840
    s_waitcnt lgkmcnt(2)
    buffer_store_dwordx4 v[84:87], v251, s[16:19], s57 offen sc1
    s_add_u32 s57, s58, 196608
    s_waitcnt lgkmcnt(1)
    buffer_store_dwordx4 v[88:91], v251, s[16:19], s57 offen sc1
    s_add_u32 s57, s58, 229376
    s_waitcnt lgkmcnt(0)
    buffer_store_dwordx4 v[92:95], v251, s[16:19], s57 offen sc1
    v_mul_f32 v208, v208, v192
    v_mul_f32 v209, v209, v192
    v_mul_f32 v210, v210, v192
    v_mul_f32 v211, v211, v192
    v_mul_f32 v212, v212, v192
    v_mul_f32 v213, v213, v192
    v_mul_f32 v214, v214, v192
    v_mul_f32 v215, v215, v192
    v_cvt_pk_bf16_f32 v224, v208, v209
    v_cvt_pk_bf16_f32 v225, v210, v211
    v_cvt_pk_bf16_f32 v226, v212, v213
    v_cvt_pk_bf16_f32 v227, v214, v215
    ds_write_b64 v200, v[224:225] offset:0
    ds_write_b64 v201, v[226:227] offset:0
    v_accvgpr_read_b32 v216, a40
    v_accvgpr_read_b32 v217, a41
    v_accvgpr_read_b32 v218, a42
    v_accvgpr_read_b32 v219, a43
    v_accvgpr_read_b32 v220, a44
    v_accvgpr_read_b32 v221, a45
    v_accvgpr_read_b32 v222, a46
    v_accvgpr_read_b32 v223, a47
    v_xor_b32 v202, 32, v248
    v_xor_b32 v203, 48, v248
    v_mul_f32 v216, v216, v192
    v_mul_f32 v217, v217, v192
    v_mul_f32 v218, v218, v192
    v_mul_f32 v219, v219, v192
    v_mul_f32 v220, v220, v192
    v_mul_f32 v221, v221, v192
    v_mul_f32 v222, v222, v192
    v_mul_f32 v223, v223, v192
    v_cvt_pk_bf16_f32 v228, v216, v217
    v_cvt_pk_bf16_f32 v229, v218, v219
    v_cvt_pk_bf16_f32 v230, v220, v221
    v_cvt_pk_bf16_f32 v231, v222, v223
    ds_write_b64 v202, v[228:229] offset:0
    ds_write_b64 v203, v[230:231] offset:0
    v_accvgpr_read_b32 v208, a48
    v_accvgpr_read_b32 v209, a49
    v_accvgpr_read_b32 v210, a50
    v_accvgpr_read_b32 v211, a51
    v_accvgpr_read_b32 v212, a52
    v_accvgpr_read_b32 v213, a53
    v_accvgpr_read_b32 v214, a54
    v_accvgpr_read_b32 v215, a55
    v_xor_b32 v200, 64, v248
    v_xor_b32 v201, 80, v248
    v_mul_f32 v208, v208, v192
    v_mul_f32 v209, v209, v192
    v_mul_f32 v210, v210, v192
    v_mul_f32 v211, v211, v192
    v_mul_f32 v212, v212, v192
    v_mul_f32 v213, v213, v192
    v_mul_f32 v214, v214, v192
    v_mul_f32 v215, v215, v192
    v_cvt_pk_bf16_f32 v224, v208, v209
    v_cvt_pk_bf16_f32 v225, v210, v211
    v_cvt_pk_bf16_f32 v226, v212, v213
    v_cvt_pk_bf16_f32 v227, v214, v215
    ds_write_b64 v200, v[224:225] offset:0
    ds_write_b64 v201, v[226:227] offset:0
    v_accvgpr_read_b32 v216, a56
    v_accvgpr_read_b32 v217, a57
    v_accvgpr_read_b32 v218, a58
    v_accvgpr_read_b32 v219, a59
    v_accvgpr_read_b32 v220, a60
    v_accvgpr_read_b32 v221, a61
    v_accvgpr_read_b32 v222, a62
    v_accvgpr_read_b32 v223, a63
    v_xor_b32 v202, 96, v248
    v_xor_b32 v203, 112, v248
    v_mul_f32 v216, v216, v192
    v_mul_f32 v217, v217, v192
    v_mul_f32 v218, v218, v192
    v_mul_f32 v219, v219, v192
    v_mul_f32 v220, v220, v192
    v_mul_f32 v221, v221, v192
    v_mul_f32 v222, v222, v192
    v_mul_f32 v223, v223, v192
    v_cvt_pk_bf16_f32 v228, v216, v217
    v_cvt_pk_bf16_f32 v229, v218, v219
    v_cvt_pk_bf16_f32 v230, v220, v221
    v_cvt_pk_bf16_f32 v231, v222, v223
    ds_write_b64 v202, v[228:229] offset:0
    ds_write_b64 v203, v[230:231] offset:0
    ds_read_b128 v[96:99], v249 offset:0
    ds_read_b128 v[100:103], v249 offset:1024
    ds_read_b128 v[104:107], v249 offset:2048
    ds_read_b128 v[108:111], v249 offset:3072
    v_accvgpr_read_b32 v208, a96
    v_accvgpr_read_b32 v209, a97
    v_accvgpr_read_b32 v210, a98
    v_accvgpr_read_b32 v211, a99
    v_accvgpr_read_b32 v212, a100
    v_accvgpr_read_b32 v213, a101
    v_accvgpr_read_b32 v214, a102
    v_accvgpr_read_b32 v215, a103
    v_xor_b32 v200, 0, v248
    v_xor_b32 v201, 16, v248
    s_add_u32 s57, s58, 128
    s_waitcnt lgkmcnt(3)
    buffer_store_dwordx4 v[96:99], v251, s[16:19], s57 offen sc1
    s_add_u32 s57, s58, 32896
    s_waitcnt lgkmcnt(2)
    buffer_store_dwordx4 v[100:103], v251, s[16:19], s57 offen sc1
    s_add_u32 s57, s58, 65664
    s_waitcnt lgkmcnt(1)
    buffer_store_dwordx4 v[104:107], v251, s[16:19], s57 offen sc1
    s_add_u32 s57, s58, 98432
    s_waitcnt lgkmcnt(0)
    buffer_store_dwordx4 v[108:111], v251, s[16:19], s57 offen sc1
    v_mul_f32 v208, v208, v194
    v_mul_f32 v209, v209, v194
    v_mul_f32 v210, v210, v194
    v_mul_f32 v211, v211, v194
    v_mul_f32 v212, v212, v194
    v_mul_f32 v213, v213, v194
    v_mul_f32 v214, v214, v194
    v_mul_f32 v215, v215, v194
    v_cvt_pk_bf16_f32 v224, v208, v209
    v_cvt_pk_bf16_f32 v225, v210, v211
    v_cvt_pk_bf16_f32 v226, v212, v213
    v_cvt_pk_bf16_f32 v227, v214, v215
    ds_write_b64 v200, v[224:225] offset:4096
    ds_write_b64 v201, v[226:227] offset:4096
    v_accvgpr_read_b32 v216, a104
    v_accvgpr_read_b32 v217, a105
    v_accvgpr_read_b32 v218, a106
    v_accvgpr_read_b32 v219, a107
    v_accvgpr_read_b32 v220, a108
    v_accvgpr_read_b32 v221, a109
    v_accvgpr_read_b32 v222, a110
    v_accvgpr_read_b32 v223, a111
    v_xor_b32 v202, 32, v248
    v_xor_b32 v203, 48, v248
    v_mul_f32 v216, v216, v194
    v_mul_f32 v217, v217, v194
    v_mul_f32 v218, v218, v194
    v_mul_f32 v219, v219, v194
    v_mul_f32 v220, v220, v194
    v_mul_f32 v221, v221, v194
    v_mul_f32 v222, v222, v194
    v_mul_f32 v223, v223, v194
    v_cvt_pk_bf16_f32 v228, v216, v217
    v_cvt_pk_bf16_f32 v229, v218, v219
    v_cvt_pk_bf16_f32 v230, v220, v221
    v_cvt_pk_bf16_f32 v231, v222, v223
    ds_write_b64 v202, v[228:229] offset:4096
    ds_write_b64 v203, v[230:231] offset:4096
    v_accvgpr_read_b32 v208, a112
    v_accvgpr_read_b32 v209, a113
    v_accvgpr_read_b32 v210, a114
    v_accvgpr_read_b32 v211, a115
    v_accvgpr_read_b32 v212, a116
    v_accvgpr_read_b32 v213, a117
    v_accvgpr_read_b32 v214, a118
    v_accvgpr_read_b32 v215, a119
    v_xor_b32 v200, 64, v248
    v_xor_b32 v201, 80, v248
    v_mul_f32 v208, v208, v194
    v_mul_f32 v209, v209, v194
    v_mul_f32 v210, v210, v194
    v_mul_f32 v211, v211, v194
    v_mul_f32 v212, v212, v194
    v_mul_f32 v213, v213, v194
    v_mul_f32 v214, v214, v194
    v_mul_f32 v215, v215, v194
    v_cvt_pk_bf16_f32 v224, v208, v209
    v_cvt_pk_bf16_f32 v225, v210, v211
    v_cvt_pk_bf16_f32 v226, v212, v213
    v_cvt_pk_bf16_f32 v227, v214, v215
    ds_write_b64 v200, v[224:225] offset:4096
    ds_write_b64 v201, v[226:227] offset:4096
    v_accvgpr_read_b32 v216, a120
    v_accvgpr_read_b32 v217, a121
    v_accvgpr_read_b32 v218, a122
    v_accvgpr_read_b32 v219, a123
    v_accvgpr_read_b32 v220, a124
    v_accvgpr_read_b32 v221, a125
    v_accvgpr_read_b32 v222, a126
    v_accvgpr_read_b32 v223, a127
    v_xor_b32 v202, 96, v248
    v_xor_b32 v203, 112, v248
    v_mul_f32 v216, v216, v194
    v_mul_f32 v217, v217, v194
    v_mul_f32 v218, v218, v194
    v_mul_f32 v219, v219, v194
    v_mul_f32 v220, v220, v194
    v_mul_f32 v221, v221, v194
    v_mul_f32 v222, v222, v194
    v_mul_f32 v223, v223, v194
    v_cvt_pk_bf16_f32 v228, v216, v217
    v_cvt_pk_bf16_f32 v229, v218, v219
    v_cvt_pk_bf16_f32 v230, v220, v221
    v_cvt_pk_bf16_f32 v231, v222, v223
    ds_write_b64 v202, v[228:229] offset:4096
    ds_write_b64 v203, v[230:231] offset:4096
    ds_read_b128 v[112:115], v249 offset:4096
    ds_read_b128 v[116:119], v249 offset:5120
    ds_read_b128 v[120:123], v249 offset:6144
    ds_read_b128 v[124:127], v249 offset:7168
    s_add_u32 s57, s58, 131200
    s_waitcnt lgkmcnt(3)
    buffer_store_dwordx4 v[112:115], v251, s[16:19], s57 offen sc1
    s_add_u32 s57, s58, 163968
    s_waitcnt lgkmcnt(2)
    buffer_store_dwordx4 v[116:119], v251, s[16:19], s57 offen sc1
    s_add_u32 s57, s58, 196736
    s_waitcnt lgkmcnt(1)
    buffer_store_dwordx4 v[120:123], v251, s[16:19], s57 offen sc1
    s_add_u32 s57, s58, 229504
    s_waitcnt lgkmcnt(0)
    buffer_store_dwordx4 v[124:127], v251, s[16:19], s57 offen sc1
    s_branch L_epi_done
L_prod_T0:
    v_mov_b32 v188, v128
    v_mov_b32 v189, v144
    v_mov_b32 v190, v182
    v_mov_b32 v191, v183
    s_add_u32 s57, s56, 16384
    buffer_store_dwordx4 v[188:191], v181, s[20:23], s57 offen sc1
    s_waitcnt lgkmcnt(8)
    v_mfma_f32_32x32x16_bf16 a[0:15], a[192:195], v[0:3], a[0:15]
    ds_read_b64_tr_b16 a[212:213], v169 offset:36864
    s_waitcnt lgkmcnt(7)
    v_mfma_f32_32x32x16_bf16 a[0:15], a[196:199], v[8:11], a[0:15]
    ds_read_b64_tr_b16 a[214:215], v169 offset:38912
    v_mfma_f32_32x32x16_bf16 a[64:79], a[192:195], v[32:35], a[64:79]
    ds_read_b64_tr_b16 a[216:217], v169 offset:40960
    v_mfma_f32_32x32x16_bf16 a[64:79], a[196:199], v[40:43], a[64:79]
    ds_read_b64_tr_b16 a[218:219], v169 offset:43008
    s_waitcnt lgkmcnt(8)
    v_mfma_f32_32x32x16_bf16 a[0:15], a[200:203], v[16:19], a[0:15]
    ds_read_b64_tr_b16 a[220:221], v169 offset:45056
    s_waitcnt lgkmcnt(7)
    v_mfma_f32_32x32x16_bf16 a[0:15], a[204:207], v[24:27], a[0:15]
    ds_read_b64_tr_b16 a[222:223], v169 offset:47104
    v_mfma_f32_32x32x16_bf16 a[64:79], a[200:203], v[48:51], a[64:79]
    ds_read_b64_tr_b16 a[224:225], v170 offset:32768
    v_mfma_f32_32x32x16_bf16 a[64:79], a[204:207], v[56:59], a[64:79]
    ds_read_b64_tr_b16 a[226:227], v170 offset:34816
    s_waitcnt lgkmcnt(8)
    v_mfma_f32_32x32x16_bf16 a[16:31], a[208:211], v[0:3], a[16:31]
    ds_read_b64_tr_b16 a[228:229], v170 offset:36864
    s_waitcnt lgkmcnt(7)
    v_mfma_f32_32x32x16_bf16 a[16:31], a[212:215], v[8:11], a[16:31]
    ds_read_b64_tr_b16 a[230:231], v170 offset:38912
    s_nop 5
    v_accvgpr_read_b32 v208, a0
    v_accvgpr_read_b32 v209, a1
    v_accvgpr_read_b32 v210, a2
    v_accvgpr_read_b32 v211, a3
    v_accvgpr_read_b32 v212, a4
    v_mfma_f32_32x32x16_bf16 a[80:95], a[208:211], v[32:35], a[80:95]
    ds_read_b64_tr_b16 a[232:233], v170 offset:40960
    v_accvgpr_read_b32 v213, a5
    v_accvgpr_read_b32 v214, a6
    v_accvgpr_read_b32 v215, a7
    v_cvt_pk_bf16_f32 v224, v208, v209
    v_cvt_pk_bf16_f32 v225, v210, v211
    v_mfma_f32_32x32x16_bf16 a[80:95], a[212:215], v[40:43], a[80:95]
    ds_read_b64_tr_b16 a[234:235], v170 offset:43008
    v_cvt_pk_bf16_f32 v226, v212, v213
    v_cvt_pk_bf16_f32 v227, v214, v215
    s_add_u32 s57, s56, 0
    buffer_store_dwordx4 v[224:227], v181, s[20:23], s57 offen offset:0 sc1
    v_accvgpr_read_b32 v216, a8
    s_waitcnt lgkmcnt(8)
    v_mfma_f32_32x32x16_bf16 a[16:31], a[216:219], v[16:19], a[16:31]
    ds_read_b64_tr_b16 a[236:237], v170 offset:45056
    v_accvgpr_read_b32 v217, a9
    v_accvgpr_read_b32 v218, a10
    v_accvgpr_read_b32 v219, a11
    v_accvgpr_read_b32 v220, a12
    v_accvgpr_read_b32 v221, a13
    s_waitcnt lgkmcnt(7)
    v_mfma_f32_32x32x16_bf16 a[16:31], a[220:223], v[24:27], a[16:31]
    ds_read_b64_tr_b16 a[238:239], v170 offset:47104
    v_accvgpr_read_b32 v222, a14
    v_accvgpr_read_b32 v223, a15
    v_cvt_pk_bf16_f32 v228, v216, v217
    v_cvt_pk_bf16_f32 v229, v218, v219
    v_cvt_pk_bf16_f32 v230, v220, v221
    v_mfma_f32_32x32x16_bf16 a[80:95], a[216:219], v[48:51], a[80:95]
    ds_read_b64_tr_b16 a[240:241], v171 offset:32768
    v_cvt_pk_bf16_f32 v231, v222, v223
    s_add_u32 s57, s56, 0
    buffer_store_dwordx4 v[228:231], v181, s[20:23], s57 offen offset:1024 sc1
    v_mfma_f32_32x32x16_bf16 a[80:95], a[220:223], v[56:59], a[80:95]
    ds_read_b64_tr_b16 a[242:243], v171 offset:34816
    s_waitcnt lgkmcnt(8)
    v_mfma_f32_32x32x16_bf16 a[32:47], a[224:227], v[0:3], a[32:47]
    ds_read_b64_tr_b16 a[244:245], v171 offset:36864
    s_waitcnt lgkmcnt(7)
    v_mfma_f32_32x32x16_bf16 a[32:47], a[228:231], v[8:11], a[32:47]
    ds_read_b64_tr_b16 a[246:247], v171 offset:38912
    s_nop 5
    v_accvgpr_read_b32 v208, a16
    v_accvgpr_read_b32 v209, a17
    v_accvgpr_read_b32 v210, a18
    v_accvgpr_read_b32 v211, a19
    v_accvgpr_read_b32 v212, a20
    v_mfma_f32_32x32x16_bf16 a[96:111], a[224:227], v[32:35], a[96:111]
    ds_read_b64_tr_b16 a[248:249], v171 offset:40960
    v_accvgpr_read_b32 v213, a21
    v_accvgpr_read_b32 v214, a22
    v_accvgpr_read_b32 v215, a23
    v_cvt_pk_bf16_f32 v232, v208, v209
    v_cvt_pk_bf16_f32 v233, v210, v211
    v_mfma_f32_32x32x16_bf16 a[96:111], a[228:231], v[40:43], a[96:111]
    ds_read_b64_tr_b16 a[250:251], v171 offset:43008
    v_cvt_pk_bf16_f32 v234, v212, v213
    v_cvt_pk_bf16_f32 v235, v214, v215
    s_add_u32 s57, s56, 0
    buffer_store_dwordx4 v[232:235], v181, s[20:23], s57 offen offset:2048 sc1
    v_accvgpr_read_b32 v216, a24
    s_waitcnt lgkmcnt(8)
    v_mfma_f32_32x32x16_bf16 a[32:47], a[232:235], v[16:19], a[32:47]
    ds_read_b64_tr_b16 a[252:253], v171 offset:45056
    v_accvgpr_read_b32 v217, a25
    v_accvgpr_read_b32 v218, a26
    v_accvgpr_read_b32 v219, a27
    v_accvgpr_read_b32 v220, a28
    v_accvgpr_read_b32 v221, a29
    s_waitcnt lgkmcnt(7)
    v_mfma_f32_32x32x16_bf16 a[32:47], a[236:239], v[24:27], a[32:47]
    ds_read_b64_tr_b16 a[254:255], v171 offset:47104
    v_accvgpr_read_b32 v222, a30
    v_accvgpr_read_b32 v223, a31
    v_cvt_pk_bf16_f32 v236, v216, v217
    v_cvt_pk_bf16_f32 v237, v218, v219
    v_cvt_pk_bf16_f32 v238, v220, v221
    v_mfma_f32_32x32x16_bf16 a[96:111], a[232:235], v[48:51], a[96:111]
    v_cvt_pk_bf16_f32 v239, v222, v223
    s_add_u32 s57, s56, 0
    buffer_store_dwordx4 v[236:239], v181, s[20:23], s57 offen offset:3072 sc1
    v_accvgpr_read_b32 v208, a64
    v_accvgpr_read_b32 v209, a65
    v_mfma_f32_32x32x16_bf16 a[96:111], a[236:239], v[56:59], a[96:111]
    v_accvgpr_read_b32 v210, a66
    v_accvgpr_read_b32 v211, a67
    v_accvgpr_read_b32 v212, a68
    v_accvgpr_read_b32 v213, a69
    v_accvgpr_read_b32 v214, a70
    s_waitcnt lgkmcnt(6)
    v_mfma_f32_32x32x16_bf16 a[48:63], a[240:243], v[0:3], a[48:63]
    v_accvgpr_read_b32 v215, a71
    v_cvt_pk_bf16_f32 v224, v208, v209
    v_cvt_pk_bf16_f32 v225, v210, v211
    v_cvt_pk_bf16_f32 v226, v212, v213
    v_cvt_pk_bf16_f32 v227, v214, v215
    s_waitcnt lgkmcnt(4)
    v_mfma_f32_32x32x16_bf16 a[48:63], a[244:247], v[8:11], a[48:63]
    s_add_u32 s57, s56, 4096
    buffer_store_dwordx4 v[224:227], v181, s[20:23], s57 offen offset:0 sc1
    v_accvgpr_read_b32 v216, a72
    v_accvgpr_read_b32 v217, a73
    v_accvgpr_read_b32 v218, a74
    v_mfma_f32_32x32x16_bf16 a[112:127], a[240:243], v[32:35], a[112:127]
    v_accvgpr_read_b32 v219, a75
    v_accvgpr_read_b32 v220, a76
    v_accvgpr_read_b32 v221, a77
    v_accvgpr_read_b32 v222, a78
    v_accvgpr_read_b32 v223, a79
    v_mfma_f32_32x32x16_bf16 a[112:127], a[244:247], v[40:43], a[112:127]
    v_cvt_pk_bf16_f32 v228, v216, v217
    v_cvt_pk_bf16_f32 v229, v218, v219
    v_cvt_pk_bf16_f32 v230, v220, v221
    v_cvt_pk_bf16_f32 v231, v222, v223
    s_add_u32 s57, s56, 4096
    s_waitcnt lgkmcnt(2)
    v_mfma_f32_32x32x16_bf16 a[48:63], a[248:251], v[16:19], a[48:63]
    buffer_store_dwordx4 v[228:231], v181, s[20:23], s57 offen offset:1024 sc1
    v_accvgpr_read_b32 v208, a80
    v_accvgpr_read_b32 v209, a81
    v_accvgpr_read_b32 v210, a82
    v_accvgpr_read_b32 v211, a83
    s_waitcnt lgkmcnt(0)
    v_mfma_f32_32x32x16_bf16 a[48:63], a[252:255], v[24:27], a[48:63]
    v_accvgpr_read_b32 v212, a84
    v_accvgpr_read_b32 v213, a85
    v_accvgpr_read_b32 v214, a86
    v_accvgpr_read_b32 v215, a87
    v_cvt_pk_bf16_f32 v232, v208, v209
    v_mfma_f32_32x32x16_bf16 a[112:127], a[248:251], v[48:51], a[112:127]
    v_cvt_pk_bf16_f32 v233, v210, v211
    v_cvt_pk_bf16_f32 v234, v212, v213
    v_cvt_pk_bf16_f32 v235, v214, v215
    s_add_u32 s57, s56, 4096
    buffer_store_dwordx4 v[232:235], v181, s[20:23], s57 offen offset:2048 sc1
    v_mfma_f32_32x32x16_bf16 a[112:127], a[252:255], v[56:59], a[112:127]
    v_accvgpr_read_b32 v216, a88
    v_accvgpr_read_b32 v217, a89
    v_accvgpr_read_b32 v218, a90
    v_accvgpr_read_b32 v219, a91
    v_accvgpr_read_b32 v220, a92
    v_accvgpr_read_b32 v221, a93
    v_accvgpr_read_b32 v222, a94
    v_accvgpr_read_b32 v223, a95
    v_cvt_pk_bf16_f32 v236, v216, v217
    v_cvt_pk_bf16_f32 v237, v218, v219
    v_cvt_pk_bf16_f32 v238, v220, v221
    v_cvt_pk_bf16_f32 v239, v222, v223
    s_add_u32 s57, s56, 4096
    buffer_store_dwordx4 v[236:239], v181, s[20:23], s57 offen offset:3072 sc1
    v_accvgpr_read_b32 v208, a32
    v_accvgpr_read_b32 v209, a33
    v_accvgpr_read_b32 v210, a34
    v_accvgpr_read_b32 v211, a35
    v_accvgpr_read_b32 v212, a36
    v_accvgpr_read_b32 v213, a37
    v_accvgpr_read_b32 v214, a38
    v_accvgpr_read_b32 v215, a39
    v_cvt_pk_bf16_f32 v224, v208, v209
    v_cvt_pk_bf16_f32 v225, v210, v211
    v_cvt_pk_bf16_f32 v226, v212, v213
    v_cvt_pk_bf16_f32 v227, v214, v215
    s_add_u32 s57, s56, 8192
    buffer_store_dwordx4 v[224:227], v181, s[20:23], s57 offen offset:0 sc1
    v_accvgpr_read_b32 v216, a40
    v_accvgpr_read_b32 v217, a41
    v_accvgpr_read_b32 v218, a42
    v_accvgpr_read_b32 v219, a43
    v_accvgpr_read_b32 v220, a44
    v_accvgpr_read_b32 v221, a45
    v_accvgpr_read_b32 v222, a46
    v_accvgpr_read_b32 v223, a47
    v_cvt_pk_bf16_f32 v228, v216, v217
    v_cvt_pk_bf16_f32 v229, v218, v219
    v_cvt_pk_bf16_f32 v230, v220, v221
    v_cvt_pk_bf16_f32 v231, v222, v223
    s_add_u32 s57, s56, 8192
    buffer_store_dwordx4 v[228:231], v181, s[20:23], s57 offen offset:1024 sc1
    v_accvgpr_read_b32 v208, a48
    v_accvgpr_read_b32 v209, a49
    v_accvgpr_read_b32 v210, a50
    v_accvgpr_read_b32 v211, a51
    v_accvgpr_read_b32 v212, a52
    v_accvgpr_read_b32 v213, a53
    v_accvgpr_read_b32 v214, a54
    v_accvgpr_read_b32 v215, a55
    v_cvt_pk_bf16_f32 v232, v208, v209
    v_cvt_pk_bf16_f32 v233, v210, v211
    v_cvt_pk_bf16_f32 v234, v212, v213
    v_cvt_pk_bf16_f32 v235, v214, v215
    s_add_u32 s57, s56, 8192
    buffer_store_dwordx4 v[232:235], v181, s[20:23], s57 offen offset:2048 sc1
    v_accvgpr_read_b32 v216, a56
    v_accvgpr_read_b32 v217, a57
    v_accvgpr_read_b32 v218, a58
    v_accvgpr_read_b32 v219, a59
    v_accvgpr_read_b32 v220, a60
    v_accvgpr_read_b32 v221, a61
    v_accvgpr_read_b32 v222, a62
    v_accvgpr_read_b32 v223, a63
    v_cvt_pk_bf16_f32 v236, v216, v217
    v_cvt_pk_bf16_f32 v237, v218, v219
    v_cvt_pk_bf16_f32 v238, v220, v221
    v_cvt_pk_bf16_f32 v239, v222, v223
    s_add_u32 s57, s56, 8192
    buffer_store_dwordx4 v[236:239], v181, s[20:23], s57 offen offset:3072 sc1
    v_accvgpr_read_b32 v208, a96
    v_accvgpr_read_b32 v209, a97
    v_accvgpr_read_b32 v210, a98
    v_accvgpr_read_b32 v211, a99
    v_accvgpr_read_b32 v212, a100
    v_accvgpr_read_b32 v213, a101
    v_accvgpr_read_b32 v214, a102
    v_accvgpr_read_b32 v215, a103
    v_cvt_pk_bf16_f32 v224, v208, v209
    v_cvt_pk_bf16_f32 v225, v210, v211
    v_cvt_pk_bf16_f32 v226, v212, v213
    v_cvt_pk_bf16_f32 v227, v214, v215
    s_add_u32 s57, s56, 12288
    buffer_store_dwordx4 v[224:227], v181, s[20:23], s57 offen offset:0 sc1
    v_accvgpr_read_b32 v216, a104
    v_accvgpr_read_b32 v217, a105
    v_accvgpr_read_b32 v218, a106
    v_accvgpr_read_b32 v219, a107
    v_accvgpr_read_b32 v220, a108
    v_accvgpr_read_b32 v221, a109
    v_accvgpr_read_b32 v222, a110
    v_accvgpr_read_b32 v223, a111
    v_cvt_pk_bf16_f32 v228, v216, v217
    v_cvt_pk_bf16_f32 v229, v218, v219
    v_cvt_pk_bf16_f32 v230, v220, v221
    v_cvt_pk_bf16_f32 v231, v222, v223
    s_add_u32 s57, s56, 12288
    buffer_store_dwordx4 v[228:231], v181, s[20:23], s57 offen offset:1024 sc1
    v_accvgpr_read_b32 v208, a112
    v_accvgpr_read_b32 v209, a113
    v_accvgpr_read_b32 v210, a114
    v_accvgpr_read_b32 v211, a115
    v_accvgpr_read_b32 v212, a116
    v_accvgpr_read_b32 v213, a117
    v_accvgpr_read_b32 v214, a118
    v_accvgpr_read_b32 v215, a119
    v_cvt_pk_bf16_f32 v232, v208, v209
    v_cvt_pk_bf16_f32 v233, v210, v211
    v_cvt_pk_bf16_f32 v234, v212, v213
    v_cvt_pk_bf16_f32 v235, v214, v215
    s_add_u32 s57, s56, 12288
    buffer_store_dwordx4 v[232:235], v181, s[20:23], s57 offen offset:2048 sc1
    v_accvgpr_read_b32 v216, a120
    v_accvgpr_read_b32 v217, a121
    v_accvgpr_read_b32 v218, a122
    v_accvgpr_read_b32 v219, a123
    v_accvgpr_read_b32 v220, a124
    v_accvgpr_read_b32 v221, a125
    v_accvgpr_read_b32 v222, a126
    v_accvgpr_read_b32 v223, a127
    v_cvt_pk_bf16_f32 v236, v216, v217
    v_cvt_pk_bf16_f32 v237, v218, v219
    v_cvt_pk_bf16_f32 v238, v220, v221
    v_cvt_pk_bf16_f32 v239, v222, v223
    s_add_u32 s57, s56, 12288
    buffer_store_dwordx4 v[236:239], v181, s[20:23], s57 offen offset:3072 sc1
    s_add_u32 s80, s49, 1
    s_branch L_epi_done
L_cons_T0:
    s_cmp_eq_u32 s83, 0
    s_cbranch_scc0 L_consd_T0
    s_lshl_b32 s57, s28, 14
    s_add_u32 s57, s57, 65536
    v_add_u32 v188, s57, v181
    s_waitcnt vmcnt(0)
    ds_read_b128 v[64:67], v188 offset:0
    ds_read_b128 v[68:71], v188 offset:1024
    ds_read_b128 v[72:75], v188 offset:2048
    ds_read_b128 v[76:79], v188 offset:3072
    ds_read_b128 v[80:83], v188 offset:4096
    ds_read_b128 v[84:87], v188 offset:5120
    ds_read_b128 v[88:91], v188 offset:6144
    ds_read_b128 v[92:95], v188 offset:7168
    ds_read_b128 v[96:99], v188 offset:8192
    ds_read_b128 v[100:103], v188 offset:9216
    ds_read_b128 v[104:107], v188 offset:10240
    ds_read_b128 v[108:111], v188 offset:11264
    ds_read_b128 v[112:115], v188 offset:12288
    ds_read_b128 v[116:119], v188 offset:13312
    ds_read_b128 v[120:123], v188 offset:14336
    ds_read_b128 v[124:127], v188 offset:15360
    s_waitcnt lgkmcnt(0)
    s_branch L_consj_T0
L_consd_T0:
    s_and_b32 s49, s49, 31
L_poll_T0:
    v_readfirstlane_b32 s57, v187
    s_bitcmp1_b32 s57, 0
    s_cbranch_scc1 L_polled_T0
    s_sleep 16
    buffer_load_ubyte v187, v253, s[24:27], 0 offen sc1
    s_waitcnt vmcnt(0)
    s_branch L_poll_T0
L_polled_T0:
    s_add_u32 s57, s56, 16384
    buffer_load_dwordx4 v[232:235], v181, s[20:23], s57 offen sc1
    s_add_u32 s57, s56, 0
    buffer_load_dwordx4 v[64:67], v181, s[20:23], s57 offen offset:0 sc1
    buffer_load_dwordx4 v[68:71], v181, s[20:23], s57 offen offset:1024 sc1
    buffer_load_dwordx4 v[72:75], v181, s[20:23], s57 offen offset:2048 sc1
    buffer_load_dwordx4 v[76:79], v181, s[20:23], s57 offen offset:3072 sc1
    s_add_u32 s57, s56, 4096
    buffer_load_dwordx4 v[80:83], v181, s[20:23], s57 offen offset:0 sc1
    buffer_load_dwordx4 v[84:87], v181, s[20:23], s57 offen offset:1024 sc1
    buffer_load_dwordx4 v[88:91], v181, s[20:23], s57 offen offset:2048 sc1
    buffer_load_dwordx4 v[92:95], v181, s[20:23], s57 offen offset:3072 sc1
    s_add_u32 s57, s56, 8192
    buffer_load_dwordx4 v[96:99], v181, s[20:23], s57 offen offset:0 sc1
    buffer_load_dwordx4 v[100:103], v181, s[20:23], s57 offen offset:1024 sc1
    buffer_load_dwordx4 v[104:107], v181, s[20:23], s57 offen offset:2048 sc1
    buffer_load_dwordx4 v[108:111], v181, s[20:23], s57 offen offset:3072 sc1
    s_add_u32 s57, s56, 12288
    buffer_load_dwordx4 v[112:115], v181, s[20:23], s57 offen offset:0 sc1
    buffer_load_dwordx4 v[116:119], v181, s[20:23], s57 offen offset:1024 sc1
    buffer_load_dwordx4 v[120:123], v181, s[20:23], s57 offen offset:2048 sc1
    buffer_load_dwordx4 v[124:127], v181, s[20:23], s57 offen offset:3072 sc1
    s_waitcnt vmcnt(16)
L_consj_T0:
    s_mov_b32 s82, 0
    s_mov_b32 s81, 0
    v_min_f32 v188, v128, v232
    v_sub_f32 v236, v188, v128
    v_sub_f32 v238, v188, v232
    v_exp_f32 v236, v236
    v_exp_f32 v238, v238
    s_nop 0
    v_mul_f32 v182, v182, v236
    v_fmac_f32 v182, v234, v238
    v_min_f32 v188, v144, v233
    v_sub_f32 v237, v188, v144
    v_sub_f32 v239, v188, v233
    v_exp_f32 v237, v237
    v_exp_f32 v239, v239
    s_nop 0
    v_mul_f32 v183, v183, v237
    v_fmac_f32 v183, v235, v239
    v_mov_b32 v188, v182
    v_mov_b32 v189, v183
    s_nop 1
    v_permlane32_swap_b32 v182, v188
    v_permlane32_swap_b32 v183, v189
    s_nop 1
    v_add_f32 v182, v182, v188
    v_add_f32 v183, v183, v189
    v_rcp_f32 v182, v182
    v_rcp_f32 v183, v183
    s_nop 1
    v_mul_f32 v192, v236, v182
    v_mul_f32 v193, v236, v182
    v_mul_f32 v196, v238, v182
    v_mul_f32 v197, v238, v182
    v_mul_f32 v194, v237, v183
    v_mul_f32 v195, v237, v183
    v_mul_f32 v198, v239, v183
    v_mul_f32 v199, v239, v183
    s_waitcnt lgkmcnt(8)
    v_mfma_f32_32x32x16_bf16 a[0:15], a[192:195], v[0:3], a[0:15]
    ds_read_b64_tr_b16 a[212:213], v169 offset:36864
    s_waitcnt lgkmcnt(7)
    v_mfma_f32_32x32x16_bf16 a[0:15], a[196:199], v[8:11], a[0:15]
    ds_read_b64_tr_b16 a[214:215], v169 offset:38912
    v_mfma_f32_32x32x16_bf16 a[64:79], a[192:195], v[32:35], a[64:79]
    ds_read_b64_tr_b16 a[216:217], v169 offset:40960
    v_mfma_f32_32x32x16_bf16 a[64:79], a[196:199], v[40:43], a[64:79]
    ds_read_b64_tr_b16 a[218:219], v169 offset:43008
    s_waitcnt lgkmcnt(8)
    v_mfma_f32_32x32x16_bf16 a[0:15], a[200:203], v[16:19], a[0:15]
    ds_read_b64_tr_b16 a[220:221], v169 offset:45056
    s_waitcnt lgkmcnt(7)
    v_mfma_f32_32x32x16_bf16 a[0:15], a[204:207], v[24:27], a[0:15]
    ds_read_b64_tr_b16 a[222:223], v169 offset:47104
    v_mfma_f32_32x32x16_bf16 a[64:79], a[200:203], v[48:51], a[64:79]
    ds_read_b64_tr_b16 a[224:225], v170 offset:32768
    v_mfma_f32_32x32x16_bf16 a[64:79], a[204:207], v[56:59], a[64:79]
    ds_read_b64_tr_b16 a[226:227], v170 offset:34816
    s_waitcnt lgkmcnt(8)
    v_mfma_f32_32x32x16_bf16 a[16:31], a[208:211], v[0:3], a[16:31]
    ds_read_b64_tr_b16 a[228:229], v170 offset:36864
    s_waitcnt lgkmcnt(7)
    v_mfma_f32_32x32x16_bf16 a[16:31], a[212:215], v[8:11], a[16:31]
    ds_read_b64_tr_b16 a[230:231], v170 offset:38912
    s_nop 5
    v_accvgpr_read_b32 v208, a0
    v_accvgpr_read_b32 v209, a1
    v_accvgpr_read_b32 v210, a2
    v_accvgpr_read_b32 v211, a3
    v_accvgpr_read_b32 v212, a4
    v_mfma_f32_32x32x16_bf16 a[80:95], a[208:211], v[32:35], a[80:95]
    ds_read_b64_tr_b16 a[232:233], v170 offset:40960
    v_accvgpr_read_b32 v213, a5
    v_accvgpr_read_b32 v214, a6
    v_accvgpr_read_b32 v215, a7
    v_xor_b32 v200, 0, v248
    v_xor_b32 v201, 16, v248
    v_mfma_f32_32x32x16_bf16 a[80:95], a[212:215], v[40:43], a[80:95]
    ds_read_b64_tr_b16 a[234:235], v170 offset:43008
    v_mul_f32 v208, v208, v192
    v_mul_f32 v209, v209, v192
    v_mul_f32 v210, v210, v192
    v_mul_f32 v211, v211, v192
    v_mul_f32 v212, v212, v192
    s_waitcnt lgkmcnt(8)
    v_mfma_f32_32x32x16_bf16 a[16:31], a[216:219], v[16:19], a[16:31]
    ds_read_b64_tr_b16 a[236:237], v170 offset:45056
    v_mul_f32 v213, v213, v192
    v_mul_f32 v214, v214, v192
    v_mul_f32 v215, v215, v192
    s_waitcnt vmcnt(15)
    v_lshlrev_b32 v240, 16, v64
    s_waitcnt lgkmcnt(7)
    v_mfma_f32_32x32x16_bf16 a[16:31], a[220:223], v[24:27], a[16:31]
    ds_read_b64_tr_b16 a[238:239], v170 offset:47104
    v_and_b32 v241, 0xffff0000, v64
    v_fmac_f32 v208, v240, v196
    v_fmac_f32 v209, v241, v196
    v_lshlrev_b32 v240, 16, v65
    v_and_b32 v241, 0xffff0000, v65
    v_mfma_f32_32x32x16_bf16 a[80:95], a[216:219], v[48:51], a[80:95]
    ds_read_b64_tr_b16 a[240:241], v171 offset:32768
    v_fmac_f32 v210, v240, v196
    v_fmac_f32 v211, v241, v196
    v_lshlrev_b32 v240, 16, v66
    v_and_b32 v241, 0xffff0000, v66
    v_fmac_f32 v212, v240, v196
    v_mfma_f32_32x32x16_bf16 a[80:95], a[220:223], v[56:59], a[80:95]
    ds_read_b64_tr_b16 a[242:243], v171 offset:34816
    v_fmac_f32 v213, v241, v196
    v_lshlrev_b32 v240, 16, v67
    v_and_b32 v241, 0xffff0000, v67
    v_fmac_f32 v214, v240, v196
    v_fmac_f32 v215, v241, v196
    s_waitcnt lgkmcnt(8)
    v_mfma_f32_32x32x16_bf16 a[32:47], a[224:227], v[0:3], a[32:47]
    ds_read_b64_tr_b16 a[244:245], v171 offset:36864
    v_cvt_pk_bf16_f32 v224, v208, v209
    v_cvt_pk_bf16_f32 v225, v210, v211
    v_cvt_pk_bf16_f32 v226, v212, v213
    v_cvt_pk_bf16_f32 v227, v214, v215
    ds_write_b64 v200, v[224:225] offset:0
    s_waitcnt lgkmcnt(8)
    v_mfma_f32_32x32x16_bf16 a[32:47], a[228:231], v[8:11], a[32:47]
    ds_read_b64_tr_b16 a[246:247], v171 offset:38912
    ds_write_b64 v201, v[226:227] offset:0
    v_accvgpr_read_b32 v216, a8
    v_accvgpr_read_b32 v217, a9
    v_accvgpr_read_b32 v218, a10
    v_accvgpr_read_b32 v219, a11
    v_mfma_f32_32x32x16_bf16 a[96:111], a[224:227], v[32:35], a[96:111]
    ds_read_b64_tr_b16 a[248:249], v171 offset:40960
    v_accvgpr_read_b32 v220, a12
    v_accvgpr_read_b32 v221, a13
    v_accvgpr_read_b32 v222, a14
    v_accvgpr_read_b32 v223, a15
    v_xor_b32 v202, 32, v248
    v_mfma_f32_32x32x16_bf16 a[96:111], a[228:231], v[40:43], a[96:111]
    ds_read_b64_tr_b16 a[250:251], v171 offset:43008
    v_xor_b32 v203, 48, v248
    v_mul_f32 v216, v216, v192
    v_mul_f32 v217, v217, v192
    v_mul_f32 v218, v218, v192
    v_mul_f32 v219, v219, v192
    s_waitcnt lgkmcnt(10)
    v_mfma_f32_32x32x16_bf16 a[32:47], a[232:235], v[16:19], a[32:47]
    ds_read_b64_tr_b16 a[252:253], v171 offset:45056
    v_mul_f32 v220, v220, v192
    v_mul_f32 v221, v221, v192
    v_mul_f32 v222, v222, v192
    v_mul_f32 v223, v223, v192
    s_waitcnt vmcnt(14)
    s_waitcnt lgkmcnt(9)
    v_mfma_f32_32x32x16_bf16 a[32:47], a[236:239], v[24:27], a[32:47]
    ds_read_b64_tr_b16 a[254:255], v171 offset:47104
    v_lshlrev_b32 v242, 16, v68
    v_and_b32 v243, 0xffff0000, v68
    v_fmac_f32 v216, v242, v196
    v_fmac_f32 v217, v243, v196
    v_lshlrev_b32 v242, 16, v69
    v_mfma_f32_32x32x16_bf16 a[96:111], a[232:235], v[48:51], a[96:111]
    v_and_b32 v243, 0xffff0000, v69
    v_fmac_f32 v218, v242, v196
    v_fmac_f32 v219, v243, v196
    v_lshlrev_b32 v242, 16, v70
    v_and_b32 v243, 0xffff0000, v70
    v_mfma_f32_32x32x16_bf16 a[96:111], a[236:239], v[56:59], a[96:111]
    v_fmac_f32 v220, v242, v196
    v_fmac_f32 v221, v243, v196
    v_lshlrev_b32 v242, 16, v71
    v_and_b32 v243, 0xffff0000, v71
    v_fmac_f32 v222, v242, v196
    s_waitcnt lgkmcnt(8)
    v_mfma_f32_32x32x16_bf16 a[48:63], a[240:243], v[0:3], a[48:63]
    v_fmac_f32 v223, v243, v196
    v_cvt_pk_bf16_f32 v228, v216, v217
    v_cvt_pk_bf16_f32 v229, v218, v219
    v_cvt_pk_bf16_f32 v230, v220, v221
    v_cvt_pk_bf16_f32 v231, v222, v223
    s_waitcnt lgkmcnt(5)
    v_mfma_f32_32x32x16_bf16 a[48:63], a[244:247], v[8:11], a[48:63]
    ds_write_b64 v202, v[228:229] offset:0
    ds_write_b64 v203, v[230:231] offset:0
    v_accvgpr_read_b32 v208, a16
    v_accvgpr_read_b32 v209, a17
    v_accvgpr_read_b32 v210, a18
    v_mfma_f32_32x32x16_bf16 a[112:127], a[240:243], v[32:35], a[112:127]
    v_accvgpr_read_b32 v211, a19
    v_accvgpr_read_b32 v212, a20
    v_accvgpr_read_b32 v213, a21
    v_accvgpr_read_b32 v214, a22
    v_accvgpr_read_b32 v215, a23
    v_mfma_f32_32x32x16_bf16 a[112:127], a[244:247], v[40:43], a[112:127]
    v_xor_b32 v200, 64, v248
    v_xor_b32 v201, 80, v248
    v_mul_f32 v208, v208, v192
    v_mul_f32 v209, v209, v192
    v_mul_f32 v210, v210, v192
    s_waitcnt lgkmcnt(4)
    v_mfma_f32_32x32x16_bf16 a[48:63], a[248:251], v[16:19], a[48:63]
    v_mul_f32 v211, v211, v192
    v_mul_f32 v212, v212, v192
    v_mul_f32 v213, v213, v192
    v_mul_f32 v214, v214, v192
    v_mul_f32 v215, v215, v192
    s_waitcnt lgkmcnt(2)
    v_mfma_f32_32x32x16_bf16 a[48:63], a[252:255], v[24:27], a[48:63]
    s_waitcnt vmcnt(13)
    v_lshlrev_b32 v240, 16, v72
    v_and_b32 v241, 0xffff0000, v72
    v_fmac_f32 v208, v240, v196
    v_fmac_f32 v209, v241, v196
    v_mfma_f32_32x32x16_bf16 a[112:127], a[248:251], v[48:51], a[112:127]
    v_lshlrev_b32 v240, 16, v73
    v_and_b32 v241, 0xffff0000, v73
    v_fmac_f32 v210, v240, v196
    v_fmac_f32 v211, v241, v196
    v_lshlrev_b32 v240, 16, v74
    v_mfma_f32_32x32x16_bf16 a[112:127], a[252:255], v[56:59], a[112:127]
    v_and_b32 v241, 0xffff0000, v74
    v_fmac_f32 v212, v240, v196
    v_fmac_f32 v213, v241, v196
    v_lshlrev_b32 v240, 16, v75
    v_and_b32 v241, 0xffff0000, v75
    v_fmac_f32 v214, v240, v196
    v_fmac_f32 v215, v241, v196
    v_cvt_pk_bf16_f32 v224, v208, v209
    v_cvt_pk_bf16_f32 v225, v210, v211
    v_cvt_pk_bf16_f32 v226, v212, v213
    v_cvt_pk_bf16_f32 v227, v214, v215
    ds_write_b64 v200, v[224:225] offset:0
    ds_write_b64 v201, v[226:227] offset:0
    v_accvgpr_read_b32 v216, a24
    v_accvgpr_read_b32 v217, a25
    v_accvgpr_read_b32 v218, a26
    v_accvgpr_read_b32 v219, a27
    v_accvgpr_read_b32 v220, a28
    v_accvgpr_read_b32 v221, a29
    v_accvgpr_read_b32 v222, a30
    v_accvgpr_read_b32 v223, a31
    v_xor_b32 v202, 96, v248
    v_xor_b32 v203, 112, v248
    v_mul_f32 v216, v216, v192
    v_mul_f32 v217, v217, v192
    v_mul_f32 v218, v218, v192
    v_mul_f32 v219, v219, v192
    v_mul_f32 v220, v220, v192
    v_mul_f32 v221, v221, v192
    v_mul_f32 v222, v222, v192
    v_mul_f32 v223, v223, v192
    s_waitcnt vmcnt(12)
    v_lshlrev_b32 v242, 16, v76
    v_and_b32 v243, 0xffff0000, v76
    v_fmac_f32 v216, v242, v196
    v_fmac_f32 v217, v243, v196
    v_lshlrev_b32 v242, 16, v77
    v_and_b32 v243, 0xffff0000, v77
    v_fmac_f32 v218, v242, v196
    v_fmac_f32 v219, v243, v196
    v_lshlrev_b32 v242, 16, v78
    v_and_b32 v243, 0xffff0000, v78
    v_fmac_f32 v220, v242, v196
    v_fmac_f32 v221, v243, v196
    v_lshlrev_b32 v242, 16, v79
    v_and_b32 v243, 0xffff0000, v79
    v_fmac_f32 v222, v242, v196
    v_fmac_f32 v223, v243, v196
    v_cvt_pk_bf16_f32 v228, v216, v217
    v_cvt_pk_bf16_f32 v229, v218, v219
    v_cvt_pk_bf16_f32 v230, v220, v221
    v_cvt_pk_bf16_f32 v231, v222, v223
    ds_write_b64 v202, v[228:229] offset:0
    ds_write_b64 v203, v[230:231] offset:0
    ds_read_b128 v[64:67], v249 offset:0
    ds_read_b128 v[68:71], v249 offset:1024
    ds_read_b128 v[72:75], v249 offset:2048
    ds_read_b128 v[76:79], v249 offset:3072
    v_accvgpr_read_b32 v208, a64
    v_accvgpr_read_b32 v209, a65
    v_accvgpr_read_b32 v210, a66
    v_accvgpr_read_b32 v211, a67
    v_accvgpr_read_b32 v212, a68
    v_accvgpr_read_b32 v213, a69
    v_accvgpr_read_b32 v214, a70
    v_accvgpr_read_b32 v215, a71
    v_xor_b32 v200, 0, v248
    v_xor_b32 v201, 16, v248
    s_add_u32 s57, s58, 0
    s_waitcnt lgkmcnt(3)
    buffer_store_dwordx4 v[64:67], v251, s[16:19], s57 offen sc1
    s_add_u32 s57, s58, 32768
    s_waitcnt lgkmcnt(2)
    buffer_store_dwordx4 v[68:71], v251, s[16:19], s57 offen sc1
    s_add_u32 s57, s58, 65536
    s_waitcnt lgkmcnt(1)
    buffer_store_dwordx4 v[72:75], v251, s[16:19], s57 offen sc1
    s_add_u32 s57, s58, 98304
    s_waitcnt lgkmcnt(0)
    buffer_store_dwordx4 v[76:79], v251, s[16:19], s57 offen sc1
    v_mul_f32 v208, v208, v194
    v_mul_f32 v209, v209, v194
    v_mul_f32 v210, v210, v194
    v_mul_f32 v211, v211, v194
    v_mul_f32 v212, v212, v194
    v_mul_f32 v213, v213, v194
    v_mul_f32 v214, v214, v194
    v_mul_f32 v215, v215, v194
    s_waitcnt vmcnt(15)
    v_lshlrev_b32 v240, 16, v80
    v_and_b32 v241, 0xffff0000, v80
    v_fmac_f32 v208, v240, v198
    v_fmac_f32 v209, v241, v198
    v_lshlrev_b32 v240, 16, v81
    v_and_b32 v241, 0xffff0000, v81
    v_fmac_f32 v210, v240, v198
    v_fmac_f32 v211, v241, v198
    v_lshlrev_b32 v240, 16, v82
    v_and_b32 v241, 0xffff0000, v82
    v_fmac_f32 v212, v240, v198
    v_fmac_f32 v213, v241, v198
    v_lshlrev_b32 v240, 16, v83
    v_and_b32 v241, 0xffff0000, v83
    v_fmac_f32 v214, v240, v198
    v_fmac_f32 v215, v241, v198
    v_cvt_pk_bf16_f32 v224, v208, v209
    v_cvt_pk_bf16_f32 v225, v210, v211
    v_cvt_pk_bf16_f32 v226, v212, v213
    v_cvt_pk_bf16_f32 v227, v214, v215
    ds_write_b64 v200, v[224:225] offset:4096
    ds_write_b64 v201, v[226:227] offset:4096
    v_accvgpr_read_b32 v216, a72
    v_accvgpr_read_b32 v217, a73
    v_accvgpr_read_b32 v218, a74
    v_accvgpr_read_b32 v219, a75
    v_accvgpr_read_b32 v220, a76
    v_accvgpr_read_b32 v221, a77
    v_accvgpr_read_b32 v222, a78
    v_accvgpr_read_b32 v223, a79
    v_xor_b32 v202, 32, v248
    v_xor_b32 v203, 48, v248
    v_mul_f32 v216, v216, v194
    v_mul_f32 v217, v217, v194
    v_mul_f32 v218, v218, v194
    v_mul_f32 v219, v219, v194
    v_mul_f32 v220, v220, v194
    v_mul_f32 v221, v221, v194
    v_mul_f32 v222, v222, v194
    v_mul_f32 v223, v223, v194
    s_waitcnt vmcnt(14)
    v_lshlrev_b32 v242, 16, v84
    v_and_b32 v243, 0xffff0000, v84
    v_fmac_f32 v216, v242, v198
    v_fmac_f32 v217, v243, v198
    v_lshlrev_b32 v242, 16, v85
    v_and_b32 v243, 0xffff0000, v85
    v_fmac_f32 v218, v242, v198
    v_fmac_f32 v219, v243, v198
    v_lshlrev_b32 v242, 16, v86
    v_and_b32 v243, 0xffff0000, v86
    v_fmac_f32 v220, v242, v198
    v_fmac_f32 v221, v243, v198
    v_lshlrev_b32 v242, 16, v87
    v_and_b32 v243, 0xffff0000, v87
    v_fmac_f32 v222, v242, v198
    v_fmac_f32 v223, v243, v198
    v_cvt_pk_bf16_f32 v228, v216, v217
    v_cvt_pk_bf16_f32 v229, v218, v219
    v_cvt_pk_bf16_f32 v230, v220, v221
    v_cvt_pk_bf16_f32 v231, v222, v223
    ds_write_b64 v202, v[228:229] offset:4096
    ds_write_b64 v203, v[230:231] offset:4096
    v_accvgpr_read_b32 v208, a80
    v_accvgpr_read_b32 v209, a81
    v_accvgpr_read_b32 v210, a82
    v_accvgpr_read_b32 v211, a83
    v_accvgpr_read_b32 v212, a84
    v_accvgpr_read_b32 v213, a85
    v_accvgpr_read_b32 v214, a86
    v_accvgpr_read_b32 v215, a87
    v_xor_b32 v200, 64, v248
    v_xor_b32 v201, 80, v248
    v_mul_f32 v208, v208, v194
    v_mul_f32 v209, v209, v194
    v_mul_f32 v210, v210, v194
    v_mul_f32 v211, v211, v194
    v_mul_f32 v212, v212, v194
    v_mul_f32 v213, v213, v194
    v_mul_f32 v214, v214, v194
    v_mul_f32 v215, v215, v194
    s_waitcnt vmcnt(13)
    v_lshlrev_b32 v240, 16, v88
    v_and_b32 v241, 0xffff0000, v88
    v_fmac_f32 v208, v240, v198
    v_fmac_f32 v209, v241, v198
    v_lshlrev_b32 v240, 16, v89
    v_and_b32 v241, 0xffff0000, v89
    v_fmac_f32 v210, v240, v198
    v_fmac_f32 v211, v241, v198
    v_lshlrev_b32 v240, 16, v90
    v_and_b32 v241, 0xffff0000, v90
    v_fmac_f32 v212, v240, v198
    v_fmac_f32 v213, v241, v198
    v_lshlrev_b32 v240, 16, v91
    v_and_b32 v241, 0xffff0000, v91
    v_fmac_f32 v214, v240, v198
    v_fmac_f32 v215, v241, v198
    v_cvt_pk_bf16_f32 v224, v208, v209
    v_cvt_pk_bf16_f32 v225, v210, v211
    v_cvt_pk_bf16_f32 v226, v212, v213
    v_cvt_pk_bf16_f32 v227, v214, v215
    ds_write_b64 v200, v[224:225] offset:4096
    ds_write_b64 v201, v[226:227] offset:4096
    v_accvgpr_read_b32 v216, a88
    v_accvgpr_read_b32 v217, a89
    v_accvgpr_read_b32 v218, a90
    v_accvgpr_read_b32 v219, a91
    v_accvgpr_read_b32 v220, a92
    v_accvgpr_read_b32 v221, a93
    v_accvgpr_read_b32 v222, a94
    v_accvgpr_read_b32 v223, a95
    v_xor_b32 v202, 96, v248
    v_xor_b32 v203, 112, v248
    v_mul_f32 v216, v216, v194
    v_mul_f32 v217, v217, v194
    v_mul_f32 v218, v218, v194
    v_mul_f32 v219, v219, v194
    v_mul_f32 v220, v220, v194
    v_mul_f32 v221, v221, v194
    v_mul_f32 v222, v222, v194
    v_mul_f32 v223, v223, v194
    s_waitcnt vmcnt(12)
    v_lshlrev_b32 v242, 16, v92
    v_and_b32 v243, 0xffff0000, v92
    v_fmac_f32 v216, v242, v198
    v_fmac_f32 v217, v243, v198
    v_lshlrev_b32 v242, 16, v93
    v_and_b32 v243, 0xffff0000, v93
    v_fmac_f32 v218, v242, v198
    v_fmac_f32 v219, v243, v198
    v_lshlrev_b32 v242, 16, v94
    v_and_b32 v243, 0xffff0000, v94
    v_fmac_f32 v220, v242, v198
    v_fmac_f32 v221, v243, v198
    v_lshlrev_b32 v242, 16, v95
    v_and_b32 v243, 0xffff0000, v95
    v_fmac_f32 v222, v242, v198
    v_fmac_f32 v223, v243, v198
    v_cvt_pk_bf16_f32 v228, v216, v217
    v_cvt_pk_bf16_f32 v229, v218, v219
    v_cvt_pk_bf16_f32 v230, v220, v221
    v_cvt_pk_bf16_f32 v231, v222, v223
    ds_write_b64 v202, v[228:229] offset:4096
    ds_write_b64 v203, v[230:231] offset:4096
    ds_read_b128 v[80:83], v249 offset:4096
    ds_read_b128 v[84:87], v249 offset:5120
    ds_read_b128 v[88:91], v249 offset:6144
    ds_read_b128 v[92:95], v249 offset:7168
    v_accvgpr_read_b32 v208, a32
    v_accvgpr_read_b32 v209, a33
    v_accvgpr_read_b32 v210, a34
    v_accvgpr_read_b32 v211, a35
    v_accvgpr_read_b32 v212, a36
    v_accvgpr_read_b32 v213, a37
    v_accvgpr_read_b32 v214, a38
    v_accvgpr_read_b32 v215, a39
    v_xor_b32 v200, 0, v248
    v_xor_b32 v201, 16, v248
    s_add_u32 s57, s58, 131072
    s_waitcnt lgkmcnt(3)
    buffer_store_dwordx4 v[80:83], v251, s[16:19], s57 offen sc1
    s_add_u32 s57, s58, 163840
    s_waitcnt lgkmcnt(2)
    buffer_store_dwordx4 v[84:87], v251, s[16:19], s57 offen sc1
    s_add_u32 s57, s58, 196608
    s_waitcnt lgkmcnt(1)
    buffer_store_dwordx4 v[88:91], v251, s[16:19], s57 offen sc1
    s_add_u32 s57, s58, 229376
    s_waitcnt lgkmcnt(0)
    buffer_store_dwordx4 v[92:95], v251, s[16:19], s57 offen sc1
    v_mul_f32 v208, v208, v192
    v_mul_f32 v209, v209, v192
    v_mul_f32 v210, v210, v192
    v_mul_f32 v211, v211, v192
    v_mul_f32 v212, v212, v192
    v_mul_f32 v213, v213, v192
    v_mul_f32 v214, v214, v192
    v_mul_f32 v215, v215, v192
    s_waitcnt vmcnt(15)
    v_lshlrev_b32 v240, 16, v96
    v_and_b32 v241, 0xffff0000, v96
    v_fmac_f32 v208, v240, v196
    v_fmac_f32 v209, v241, v196
    v_lshlrev_b32 v240, 16, v97
    v_and_b32 v241, 0xffff0000, v97
    v_fmac_f32 v210, v240, v196
    v_fmac_f32 v211, v241, v196
    v_lshlrev_b32 v240, 16, v98
    v_and_b32 v241, 0xffff0000, v98
    v_fmac_f32 v212, v240, v196
    v_fmac_f32 v213, v241, v196
    v_lshlrev_b32 v240, 16, v99
    v_and_b32 v241, 0xffff0000, v99
    v_fmac_f32 v214, v240, v196
    v_fmac_f32 v215, v241, v196
    v_cvt_pk_bf16_f32 v224, v208, v209
    v_cvt_pk_bf16_f32 v225, v210, v211
    v_cvt_pk_bf16_f32 v226, v212, v213
    v_cvt_pk_bf16_f32 v227, v214, v215
    ds_write_b64 v200, v[224:225] offset:0
    ds_write_b64 v201, v[226:227] offset:0
    v_accvgpr_read_b32 v216, a40
    v_accvgpr_read_b32 v217, a41
    v_accvgpr_read_b32 v218, a42
    v_accvgpr_read_b32 v219, a43
    v_accvgpr_read_b32 v220, a44
    v_accvgpr_read_b32 v221, a45
    v_accvgpr_read_b32 v222, a46
    v_accvgpr_read_b32 v223, a47
    v_xor_b32 v202, 32, v248
    v_xor_b32 v203, 48, v248
    v_mul_f32 v216, v216, v192
    v_mul_f32 v217, v217, v192
    v_mul_f32 v218, v218, v192
    v_mul_f32 v219, v219, v192
    v_mul_f32 v220, v220, v192
    v_mul_f32 v221, v221, v192
    v_mul_f32 v222, v222, v192
    v_mul_f32 v223, v223, v192
    s_waitcnt vmcnt(14)
    v_lshlrev_b32 v242, 16, v100
    v_and_b32 v243, 0xffff0000, v100
    v_fmac_f32 v216, v242, v196
    v_fmac_f32 v217, v243, v196
    v_lshlrev_b32 v242, 16, v101
    v_and_b32 v243, 0xffff0000, v101
    v_fmac_f32 v218, v242, v196
    v_fmac_f32 v219, v243, v196
    v_lshlrev_b32 v242, 16, v102
    v_and_b32 v243, 0xffff0000, v102
    v_fmac_f32 v220, v242, v196
    v_fmac_f32 v221, v243, v196
    v_lshlrev_b32 v242, 16, v103
    v_and_b32 v243, 0xffff0000, v103
    v_fmac_f32 v222, v242, v196
    v_fmac_f32 v223, v243, v196
    v_cvt_pk_bf16_f32 v228, v216, v217
    v_cvt_pk_bf16_f32 v229, v218, v219
    v_cvt_pk_bf16_f32 v230, v220, v221
    v_cvt_pk_bf16_f32 v231, v222, v223
    ds_write_b64 v202, v[228:229] offset:0
    ds_write_b64 v203, v[230:231] offset:0
    v_accvgpr_read_b32 v208, a48
    v_accvgpr_read_b32 v209, a49
    v_accvgpr_read_b32 v210, a50
    v_accvgpr_read_b32 v211, a51
    v_accvgpr_read_b32 v212, a52
    v_accvgpr_read_b32 v213, a53
    v_accvgpr_read_b32 v214, a54
    v_accvgpr_read_b32 v215, a55
    v_xor_b32 v200, 64, v248
    v_xor_b32 v201, 80, v248
    v_mul_f32 v208, v208, v192
    v_mul_f32 v209, v209, v192
    v_mul_f32 v210, v210, v192
    v_mul_f32 v211, v211, v192
    v_mul_f32 v212, v212, v192
    v_mul_f32 v213, v213, v192
    v_mul_f32 v214, v214, v192
    v_mul_f32 v215, v215, v192
    s_waitcnt vmcnt(13)
    v_lshlrev_b32 v240, 16, v104
    v_and_b32 v241, 0xffff0000, v104
    v_fmac_f32 v208, v240, v196
    v_fmac_f32 v209, v241, v196
    v_lshlrev_b32 v240, 16, v105
    v_and_b32 v241, 0xffff0000, v105
    v_fmac_f32 v210, v240, v196
    v_fmac_f32 v211, v241, v196
    v_lshlrev_b32 v240, 16, v106
    v_and_b32 v241, 0xffff0000, v106
    v_fmac_f32 v212, v240, v196
    v_fmac_f32 v213, v241, v196
    v_lshlrev_b32 v240, 16, v107
    v_and_b32 v241, 0xffff0000, v107
    v_fmac_f32 v214, v240, v196
    v_fmac_f32 v215, v241, v196
    v_cvt_pk_bf16_f32 v224, v208, v209
    v_cvt_pk_bf16_f32 v225, v210, v211
    v_cvt_pk_bf16_f32 v226, v212, v213
    v_cvt_pk_bf16_f32 v227, v214, v215
    ds_write_b64 v200, v[224:225] offset:0
    ds_write_b64 v201, v[226:227] offset:0
    v_accvgpr_read_b32 v216, a56
    v_accvgpr_read_b32 v217, a57
    v_accvgpr_read_b32 v218, a58
    v_accvgpr_read_b32 v219, a59
    v_accvgpr_read_b32 v220, a60
    v_accvgpr_read_b32 v221, a61
    v_accvgpr_read_b32 v222, a62
    v_accvgpr_read_b32 v223, a63
    v_xor_b32 v202, 96, v248
    v_xor_b32 v203, 112, v248
    v_mul_f32 v216, v216, v192
    v_mul_f32 v217, v217, v192
    v_mul_f32 v218, v218, v192
    v_mul_f32 v219, v219, v192
    v_mul_f32 v220, v220, v192
    v_mul_f32 v221, v221, v192
    v_mul_f32 v222, v222, v192
    v_mul_f32 v223, v223, v192
    s_waitcnt vmcnt(12)
    v_lshlrev_b32 v242, 16, v108
    v_and_b32 v243, 0xffff0000, v108
    v_fmac_f32 v216, v242, v196
    v_fmac_f32 v217, v243, v196
    v_lshlrev_b32 v242, 16, v109
    v_and_b32 v243, 0xffff0000, v109
    v_fmac_f32 v218, v242, v196
    v_fmac_f32 v219, v243, v196
    v_lshlrev_b32 v242, 16, v110
    v_and_b32 v243, 0xffff0000, v110
    v_fmac_f32 v220, v242, v196
    v_fmac_f32 v221, v243, v196
    v_lshlrev_b32 v242, 16, v111
    v_and_b32 v243, 0xffff0000, v111
    v_fmac_f32 v222, v242, v196
    v_fmac_f32 v223, v243, v196
    v_cvt_pk_bf16_f32 v228, v216, v217
    v_cvt_pk_bf16_f32 v229, v218, v219
    v_cvt_pk_bf16_f32 v230, v220, v221
    v_cvt_pk_bf16_f32 v231, v222, v223
    ds_write_b64 v202, v[228:229] offset:0
    ds_write_b64 v203, v[230:231] offset:0
    ds_read_b128 v[96:99], v249 offset:0
    ds_read_b128 v[100:103], v249 offset:1024
    ds_read_b128 v[104:107], v249 offset:2048
    ds_read_b128 v[108:111], v249 offset:3072
    v_accvgpr_read_b32 v208, a96
    v_accvgpr_read_b32 v209, a97
    v_accvgpr_read_b32 v210, a98
    v_accvgpr_read_b32 v211, a99
    v_accvgpr_read_b32 v212, a100
    v_accvgpr_read_b32 v213, a101
    v_accvgpr_read_b32 v214, a102
    v_accvgpr_read_b32 v215, a103
    v_xor_b32 v200, 0, v248
    v_xor_b32 v201, 16, v248
    s_add_u32 s57, s58, 128
    s_waitcnt lgkmcnt(3)
    buffer_store_dwordx4 v[96:99], v251, s[16:19], s57 offen sc1
    s_add_u32 s57, s58, 32896
    s_waitcnt lgkmcnt(2)
    buffer_store_dwordx4 v[100:103], v251, s[16:19], s57 offen sc1
    s_add_u32 s57, s58, 65664
    s_waitcnt lgkmcnt(1)
    buffer_store_dwordx4 v[104:107], v251, s[16:19], s57 offen sc1
    s_add_u32 s57, s58, 98432
    s_waitcnt lgkmcnt(0)
    buffer_store_dwordx4 v[108:111], v251, s[16:19], s57 offen sc1
    v_mul_f32 v208, v208, v194
    v_mul_f32 v209, v209, v194
    v_mul_f32 v210, v210, v194
    v_mul_f32 v211, v211, v194
    v_mul_f32 v212, v212, v194
    v_mul_f32 v213, v213, v194
    v_mul_f32 v214, v214, v194
    v_mul_f32 v215, v215, v194
    s_waitcnt vmcnt(15)
    v_lshlrev_b32 v240, 16, v112
    v_and_b32 v241, 0xffff0000, v112
    v_fmac_f32 v208, v240, v198
    v_fmac_f32 v209, v241, v198
    v_lshlrev_b32 v240, 16, v113
    v_and_b32 v241, 0xffff0000, v113
    v_fmac_f32 v210, v240, v198
    v_fmac_f32 v211, v241, v198
    v_lshlrev_b32 v240, 16, v114
    v_and_b32 v241, 0xffff0000, v114
    v_fmac_f32 v212, v240, v198
    v_fmac_f32 v213, v241, v198
    v_lshlrev_b32 v240, 16, v115
    v_and_b32 v241, 0xffff0000, v115
    v_fmac_f32 v214, v240, v198
    v_fmac_f32 v215, v241, v198
    v_cvt_pk_bf16_f32 v224, v208, v209
    v_cvt_pk_bf16_f32 v225, v210, v211
    v_cvt_pk_bf16_f32 v226, v212, v213
    v_cvt_pk_bf16_f32 v227, v214, v215
    ds_write_b64 v200, v[224:225] offset:4096
    ds_write_b64 v201, v[226:227] offset:4096
    v_accvgpr_read_b32 v216, a104
    v_accvgpr_read_b32 v217, a105
    v_accvgpr_read_b32 v218, a106
    v_accvgpr_read_b32 v219, a107
    v_accvgpr_read_b32 v220, a108
    v_accvgpr_read_b32 v221, a109
    v_accvgpr_read_b32 v222, a110
    v_accvgpr_read_b32 v223, a111
    v_xor_b32 v202, 32, v248
    v_xor_b32 v203, 48, v248
    v_mul_f32 v216, v216, v194
    v_mul_f32 v217, v217, v194
    v_mul_f32 v218, v218, v194
    v_mul_f32 v219, v219, v194
    v_mul_f32 v220, v220, v194
    v_mul_f32 v221, v221, v194
    v_mul_f32 v222, v222, v194
    v_mul_f32 v223, v223, v194
    s_waitcnt vmcnt(14)
    v_lshlrev_b32 v242, 16, v116
    v_and_b32 v243, 0xffff0000, v116
    v_fmac_f32 v216, v242, v198
    v_fmac_f32 v217, v243, v198
    v_lshlrev_b32 v242, 16, v117
    v_and_b32 v243, 0xffff0000, v117
    v_fmac_f32 v218, v242, v198
    v_fmac_f32 v219, v243, v198
    v_lshlrev_b32 v242, 16, v118
    v_and_b32 v243, 0xffff0000, v118
    v_fmac_f32 v220, v242, v198
    v_fmac_f32 v221, v243, v198
    v_lshlrev_b32 v242, 16, v119
    v_and_b32 v243, 0xffff0000, v119
    v_fmac_f32 v222, v242, v198
    v_fmac_f32 v223, v243, v198
    v_cvt_pk_bf16_f32 v228, v216, v217
    v_cvt_pk_bf16_f32 v229, v218, v219
    v_cvt_pk_bf16_f32 v230, v220, v221
    v_cvt_pk_bf16_f32 v231, v222, v223
    ds_write_b64 v202, v[228:229] offset:4096
    ds_write_b64 v203, v[230:231] offset:4096
    v_accvgpr_read_b32 v208, a112
    v_accvgpr_read_b32 v209, a113
    v_accvgpr_read_b32 v210, a114
    v_accvgpr_read_b32 v211, a115
    v_accvgpr_read_b32 v212, a116
    v_accvgpr_read_b32 v213, a117
    v_accvgpr_read_b32 v214, a118
    v_accvgpr_read_b32 v215, a119
    v_xor_b32 v200, 64, v248
    v_xor_b32 v201, 80, v248
    v_mul_f32 v208, v208, v194
    v_mul_f32 v209, v209, v194
    v_mul_f32 v210, v210, v194
    v_mul_f32 v211, v211, v194
    v_mul_f32 v212, v212, v194
    v_mul_f32 v213, v213, v194
    v_mul_f32 v214, v214, v194
    v_mul_f32 v215, v215, v194
    s_waitcnt vmcnt(13)
    v_lshlrev_b32 v240, 16, v120
    v_and_b32 v241, 0xffff0000, v120
    v_fmac_f32 v208, v240, v198
    v_fmac_f32 v209, v241, v198
    v_lshlrev_b32 v240, 16, v121
    v_and_b32 v241, 0xffff0000, v121
    v_fmac_f32 v210, v240, v198
    v_fmac_f32 v211, v241, v198
    v_lshlrev_b32 v240, 16, v122
    v_and_b32 v241, 0xffff0000, v122
    v_fmac_f32 v212, v240, v198
    v_fmac_f32 v213, v241, v198
    v_lshlrev_b32 v240, 16, v123
    v_and_b32 v241, 0xffff0000, v123
    v_fmac_f32 v214, v240, v198
    v_fmac_f32 v215, v241, v198
    v_cvt_pk_bf16_f32 v224, v208, v209
    v_cvt_pk_bf16_f32 v225, v210, v211
    v_cvt_pk_bf16_f32 v226, v212, v213
    v_cvt_pk_bf16_f32 v227, v214, v215
    ds_write_b64 v200, v[224:225] offset:4096
    ds_write_b64 v201, v[226:227] offset:4096
    v_accvgpr_read_b32 v216, a120
    v_accvgpr_read_b32 v217, a121
    v_accvgpr_read_b32 v218, a122
    v_accvgpr_read_b32 v219, a123
    v_accvgpr_read_b32 v220, a124
    v_accvgpr_read_b32 v221, a125
    v_accvgpr_read_b32 v222, a126
    v_accvgpr_read_b32 v223, a127
    v_xor_b32 v202, 96, v248
    v_xor_b32 v203, 112, v248
    v_mul_f32 v216, v216, v194
    v_mul_f32 v217, v217, v194
    v_mul_f32 v218, v218, v194
    v_mul_f32 v219, v219, v194
    v_mul_f32 v220, v220, v194
    v_mul_f32 v221, v221, v194
    v_mul_f32 v222, v222, v194
    v_mul_f32 v223, v223, v194
    s_waitcnt vmcnt(12)
    v_lshlrev_b32 v242, 16, v124
    v_and_b32 v243, 0xffff0000, v124
    v_fmac_f32 v216, v242, v198
    v_fmac_f32 v217, v243, v198
    v_lshlrev_b32 v242, 16, v125
    v_and_b32 v243, 0xffff0000, v125
    v_fmac_f32 v218, v242, v198
    v_fmac_f32 v219, v243, v198
    v_lshlrev_b32 v242, 16, v126
    v_and_b32 v243, 0xffff0000, v126
    v_fmac_f32 v220, v242, v198
    v_fmac_f32 v221, v243, v198
    v_lshlrev_b32 v242, 16, v127
    v_and_b32 v243, 0xffff0000, v127
    v_fmac_f32 v222, v242, v198
    v_fmac_f32 v223, v243, v198
    v_cvt_pk_bf16_f32 v228, v216, v217
    v_cvt_pk_bf16_f32 v229, v218, v219
    v_cvt_pk_bf16_f32 v230, v220, v221
    v_cvt_pk_bf16_f32 v231, v222, v223
    ds_write_b64 v202, v[228:229] offset:4096
    ds_write_b64 v203, v[230:231] offset:4096
    ds_read_b128 v[112:115], v249 offset:4096
    ds_read_b128 v[116:119], v249 offset:5120
    ds_read_b128 v[120:123], v249 offset:6144
    ds_read_b128 v[124:127], v249 offset:7168
    s_add_u32 s57, s58, 131200
    s_waitcnt lgkmcnt(3)
    buffer_store_dwordx4 v[112:115], v251, s[16:19], s57 offen sc1
    s_add_u32 s57, s58, 163968
    s_waitcnt lgkmcnt(2)
    buffer_store_dwordx4 v[116:119], v251, s[16:19], s57 offen sc1
    s_add_u32 s57, s58, 196736
    s_waitcnt lgkmcnt(1)
    buffer_store_dwordx4 v[120:123], v251, s[16:19], s57 offen sc1
    s_add_u32 s57, s58, 229504
    s_waitcnt lgkmcnt(0)
    buffer_store_dwordx4 v[124:127], v251, s[16:19], s57 offen sc1
    s_branch L_epi_done
L_epiaddr:
    v_lshrrev_b32 v188, 4, v181
    s_lshl_b32 s57, s28, 13
    s_add_u32 s57, s57, 131072
    v_and_b32 v189, 31, v188
    v_lshlrev_b32 v248, 7, v189
    v_lshl_add_u32 v248, v186, 1, v248
    v_and_b32 v189, 7, v188
    v_lshl_add_u32 v248, v189, 4, v248
    v_add_u32 v248, s57, v248
    v_lshrrev_b32 v190, 3, v188
    v_xor_b32 v191, v189, v190
    v_lshlrev_b32 v249, 7, v190
    v_lshl_add_u32 v249, v191, 4, v249
    v_add_u32 v249, s57, v249
    v_lshlrev_b32 v251, 12, v190
    v_lshl_add_u32 v251, v189, 4, v251
    s_setpc_b64 s[60:61]
L_epi_done:
    s_bitcmp1_b32 s30, 0
    s_cbranch_scc1 L_seg
    s_waitcnt vmcnt(0)
    s_barrier
    s_cmp_eq_u32 s80, 0
    s_cbranch_scc1 L_nopub_end
    s_sub_u32 s80, s80, 1
    s_lshr_b32 s56, s80, 2
    s_mov_b32 s80, 0
    s_cmp_eq_u32 s28, 0
    s_cbranch_scc0 L_nopub_end
    v_mov_b32 v192, s56
    v_mov_b32 v193, 1
    s_mov_b64 exec, 1
    buffer_store_byte v193, v192, s[24:27], 0 offen sc1
    s_mov_b64 exec, -1
L_nopub_end:
L_end:
    s_endpgm
L_stub_A0:
    s_call_b64 s[60:61], L_slow_0
    s_branch L_back_A0
L_stub_A1:
    s_call_b64 s[60:61], L_slow_1
    s_branch L_back_A1
L_stub_B0:
    s_call_b64 s[60:61], L_slow_0
    s_branch L_back_B0
L_stub_B1:
    s_call_b64 s[60:61], L_slow_1
    s_branch L_back_B1
L_stub_T0:
    s_call_b64 s[60:61], L_slow_0
    s_branch L_back_T0
L_stub_T1:
    s_call_b64 s[60:61], L_slow_1
    s_branch L_back_T1
L_evstub_0:
    s_call_b64 s[72:73], L_event
    s_branch L_evback_0
L_evstub_1:
    s_call_b64 s[72:73], L_event
    s_branch L_evback_1
L_evstub_2:
    s_call_b64 s[72:73], L_event
    s_branch L_evback_2
L_evstub_3:
    s_call_b64 s[72:73], L_event
    s_branch L_evback_3
L_event:
    s_cmp_eq_u32 s82, 4
    s_cbranch_scc1 L_ev_q
    s_cmp_eq_u32 s82, 3
    s_cbranch_scc1 L_ev_p
    s_cmp_eq_u32 s82, 2
    s_cbranch_scc1 L_ev_chk
    buffer_load_ubyte v187, v253, s[24:27], 0 offen sc1
    s_mov_b32 s82, 2
    s_setpc_b64 s[72:73]
L_ev_chk:
    v_readfirstlane_b32 s56, v187
    s_mov_b32 s82, 1
    s_bitcmp1_b32 s56, 0
    s_cbranch_scc0 L_ev_ret
    s_cmp_eq_u32 s54, 0
    s_cbranch_scc0 L_ev_stop
    s_mov_b32 s82, 3
    s_add_u32 s56, s84, 16384
    buffer_load_dwordx4 v[232:235], v181, s[20:23], s56 offen sc1
L_ev_p:
    s_mov_b32 m0, s85
    s_add_u32 s85, s85, 4096
    buffer_load_dwordx4 v181, s[20:23], s84 offen offset:0 sc1 lds
    buffer_load_dwordx4 v181, s[20:23], s84 offen offset:1024 sc1 lds
    buffer_load_dwordx4 v181, s[20:23], s84 offen offset:2048 sc1 lds
    buffer_load_dwordx4 v181, s[20:23], s84 offen offset:3072 sc1 lds
    s_add_u32 s84, s84, 4096
    s_branch L_ev_dec
L_ev_q:
    s_mov_b32 m0, s85
    s_add_u32 s85, s85, 4096
    buffer_load_dwordx4 v172, s[4:7], s84 offen offset:0 lds
    buffer_load_dwordx4 v173, s[4:7], s84 offen offset:1024 lds
    buffer_load_dwordx4 v174, s[4:7], s84 offen offset:2048 lds
    buffer_load_dwordx4 v175, s[4:7], s84 offen offset:3072 lds
    s_add_u32 s84, s84, 65536
L_ev_dec:
    s_sub_u32 s83, s83, 1
    s_cmp_eq_u32 s83, 0
    s_cbranch_scc0 L_ev_ret
L_ev_stop:
    s_mov_b32 s82, 0
    s_mov_b32 s81, 0
L_ev_ret:
    s_setpc_b64 s[72:73]
L_slow_0:
    s_nop 15
    s_nop 3
    s_add_u32 s56, s45, 0
    buffer_load_dwordx4 v[192:195], v180, s[8:11], s56 offen offset:0
    buffer_load_dwordx4 v[196:199], v180, s[8:11], s56 offen offset:32
    buffer_load_dwordx4 v[200:203], v180, s[8:11], s56 offen offset:64
    buffer_load_dwordx4 v[204:207], v180, s[8:11], s56 offen offset:96
    buffer_load_dwordx4 v[208:211], v180, s[8:11], s56 offen offset:128
    buffer_load_dwordx4 v[212:215], v180, s[8:11], s56 offen offset:160
    buffer_load_dwordx4 v[216:219], v180, s[8:11], s56 offen offset:192
    buffer_load_dwordx4 v[220:223], v180, s[8:11], s56 offen offset:224
    s_waitcnt vmcnt(0)
    v_mfma_f32_32x32x16_bf16 v[0:15], v[192:195], a[128:131], v[128:143]
    v_mfma_f32_32x32x16_bf16 v[32:47], v[192:195], a[160:163], v[144:159]
    v_mfma_f32_32x32x16_bf16 v[0:15], v[196:199], a[132:135], v[0:15]
    v_mfma_f32_32x32x16_bf16 v[32:47], v[196:199], a[164:167], v[32:47]
    v_mfma_f32_32x32x16_bf16 v[0:15], v[200:203], a[136:139], v[0:15]
    v_mfma_f32_32x32x16_bf16 v[32:47], v[200:203], a[168:171], v[32:47]
    v_mfma_f32_32x32x16_bf16 v[0:15], v[204:207], a[140:143], v[0:15]
    v_mfma_f32_32x32x16_bf16 v[32:47], v[204:207], a[172:175], v[32:47]
    v_mfma_f32_32x32x16_bf16 v[0:15], v[208:211], a[144:147], v[0:15]
    v_mfma_f32_32x32x16_bf16 v[32:47], v[208:211], a[176:179], v[32:47]
    v_mfma_f32_32x32x16_bf16 v[0:15], v[212:215], a[148:151], v[0:15]
    v_mfma_f32_32x32x16_bf16 v[32:47], v[212:215], a[180:183], v[32:47]
    v_mfma_f32_32x32x16_bf16 v[0:15], v[216:219], a[152:155], v[0:15]
    v_mfma_f32_32x32x16_bf16 v[32:47], v[216:219], a[184:187], v[32:47]
    v_mfma_f32_32x32x16_bf16 v[0:15], v[220:223], a[156:159], v[0:15]
    v_mfma_f32_32x32x16_bf16 v[32:47], v[220:223], a[188:191], v[32:47]
    s_nop 3
    s_add_u32 s56, s45, 131072
    buffer_load_dwordx4 v[192:195], v180, s[8:11], s56 offen offset:0
    buffer_load_dwordx4 v[196:199], v180, s[8:11], s56 offen offset:32
    buffer_load_dwordx4 v[200:203], v180, s[8:11], s56 offen offset:64
    buffer_load_dwordx4 v[204:207], v180, s[8:11], s56 offen offset:96
    buffer_load_dwordx4 v[208:211], v180, s[8:11], s56 offen offset:128
    buffer_load_dwordx4 v[212:215], v180, s[8:11], s56 offen offset:160
    buffer_load_dwordx4 v[216:219], v180, s[8:11], s56 offen offset:192
    buffer_load_dwordx4 v[220:223], v180, s[8:11], s56 offen offset:224
    s_waitcnt vmcnt(0)
    v_mfma_f32_32x32x16_bf16 v[16:31], v[192:195], a[128:131], v[128:143]
    v_mfma_f32_32x32x16_bf16 v[48:63], v[192:195], a[160:163], v[144:159]
    v_mfma_f32_32x32x16_bf16 v[16:31], v[196:199], a[132:135], v[16:31]
    v_mfma_f32_32x32x16_bf16 v[48:63], v[196:199], a[164:167], v[48:63]
    v_mfma_f32_32x32x16_bf16 v[16:31], v[200:203], a[136:139], v[16:31]
    v_mfma_f32_32x32x16_bf16 v[48:63], v[200:203], a[168:171], v[48:63]
    v_mfma_f32_32x32x16_bf16 v[16:31], v[204:207], a[140:143], v[16:31]
    v_mfma_f32_32x32x16_bf16 v[48:63], v[204:207], a[172:175], v[48:63]
    v_mfma_f32_32x32x16_bf16 v[16:31], v[208:211], a[144:147], v[16:31]
    v_mfma_f32_32x32x16_bf16 v[48:63], v[208:211], a[176:179], v[48:63]
    v_mfma_f32_32x32x16_bf16 v[16:31], v[212:215], a[148:151], v[16:31]
    v_mfma_f32_32x32x16_bf16 v[48:63], v[212:215], a[180:183], v[48:63]
    v_mfma_f32_32x32x16_bf16 v[16:31], v[216:219], a[152:155], v[16:31]
    v_mfma_f32_32x32x16_bf16 v[48:63], v[216:219], a[184:187], v[48:63]
    v_mfma_f32_32x32x16_bf16 v[16:31], v[220:223], a[156:159], v[16:31]
    v_mfma_f32_32x32x16_bf16 v[48:63], v[220:223], a[188:191], v[48:63]
    s_nop 3
    s_nop 15
    s_nop 3
    v_max3_f32 v224, v0, v1, v2
    v_max3_f32 v224, v224, v3, v4
    v_max3_f32 v224, v224, v5, v6
    v_max3_f32 v224, v224, v7, v8
    v_max3_f32 v224, v224, v9, v10
    v_max3_f32 v224, v224, v11, v12
    v_max3_f32 v224, v224, v13, v14
    v_max3_f32 v224, v224, v15, v16
    v_max3_f32 v224, v224, v17, v18
    v_max3_f32 v224, v224, v19, v20
    v_max3_f32 v224, v224, v21, v22
    v_max3_f32 v224, v224, v23, v24
    v_max3_f32 v224, v224, v25, v26
    v_max3_f32 v224, v224, v27, v28
    v_max3_f32 v224, v224, v29, v30
    v_max_f32 v224, v224, v31
    v_max3_f32 v225, v32, v33, v34
    v_max3_f32 v225, v225, v35, v36
    v_max3_f32 v225, v225, v37, v38
    v_max3_f32 v225, v225, v39, v40
    v_max3_f32 v225, v225, v41, v42
    v_max3_f32 v225, v225, v43, v44
    v_max3_f32 v225, v225, v45, v46
    v_max3_f32 v225, v225, v47, v48
    v_max3_f32 v225, v225, v49, v50
    v_max3_f32 v225, v225, v51, v52
    v_max3_f32 v225, v225, v53, v54
    v_max3_f32 v225, v225, v55, v56
    v_max3_f32 v225, v225, v57, v58
    v_max3_f32 v225, v225, v59, v60
    v_max3_f32 v225, v225, v61, v62
    v_max_f32 v225, v225, v63
    v_mov_b32 v226, v224
    v_mov_b32 v227, v225
    s_nop 1
    v_permlane32_swap_b32 v224, v226
    v_permlane32_swap_b32 v225, v227
    s_nop 1
    v_max_f32 v224, v224, v226
    v_max_f32 v225, v225, v227
    v_max_f32 v224, 0, v224
    v_max_f32 v225, 0, v225
    v_exp_f32 v228, -v224
    v_exp_f32 v229, -v225
    v_sub_f32 v128, v128, v224
    v_sub_f32 v129, v129, v224
    v_sub_f32 v130, v130, v224
    v_sub_f32 v131, v131, v224
    v_sub_f32 v132, v132, v224
    v_sub_f32 v133, v133, v224
    v_sub_f32 v134, v134, v224
    v_sub_f32 v135, v135, v224
    v_sub_f32 v136, v136, v224
    v_sub_f32 v137, v137, v224
    v_sub_f32 v138, v138, v224
    v_sub_f32 v139, v139, v224
    v_sub_f32 v140, v140, v224
    v_sub_f32 v141, v141, v224
    v_sub_f32 v142, v142, v224
    v_sub_f32 v143, v143, v224
    v_sub_f32 v0, v0, v224
    v_sub_f32 v1, v1, v224
    v_sub_f32 v2, v2, v224
    v_sub_f32 v3, v3, v224
    v_sub_f32 v4, v4, v224
    v_sub_f32 v5, v5, v224
    v_sub_f32 v6, v6, v224
    v_sub_f32 v7, v7, v224
    v_sub_f32 v8, v8, v224
    v_sub_f32 v9, v9, v224
    v_sub_f32 v10, v10, v224
    v_sub_f32 v11, v11, v224
    v_sub_f32 v12, v12, v224
    v_sub_f32 v13, v13, v224
    v_sub_f32 v14, v14, v224
    v_sub_f32 v15, v15, v224
    v_sub_f32 v16, v16, v224
    v_sub_f32 v17, v17, v224
    v_sub_f32 v18, v18, v224
    v_sub_f32 v19, v19, v224
    v_sub_f32 v20, v20, v224
    v_sub_f32 v21, v21, v224
    v_sub_f32 v22, v22, v224
    v_sub_f32 v23, v23, v224
    v_sub_f32 v24, v24, v224
    v_sub_f32 v25, v25, v224
    v_sub_f32 v26, v26, v224
    v_sub_f32 v27, v27, v224
    v_sub_f32 v28, v28, v224
    v_sub_f32 v29, v29, v224
    v_sub_f32 v30, v30, v224
    v_sub_f32 v31, v31, v224
    v_sub_f32 v64, v64, v224
    v_sub_f32 v65, v65, v224
    v_sub_f32 v66, v66, v224
    v_sub_f32 v67, v67, v224
    v_sub_f32 v68, v68, v224
    v_sub_f32 v69, v69, v224
    v_sub_f32 v70, v70, v224
    v_sub_f32 v71, v71, v224
    v_sub_f32 v72, v72, v224
    v_sub_f32 v73, v73, v224
    v_sub_f32 v74, v74, v224
    v_sub_f32 v75, v75, v224
    v_sub_f32 v76, v76, v224
    v_sub_f32 v77, v77, v224
    v_sub_f32 v78, v78, v224
    v_sub_f32 v79, v79, v224
    v_sub_f32 v80, v80, v224
    v_sub_f32 v81, v81, v224
    v_sub_f32 v82, v82, v224
    v_sub_f32 v83, v83, v224
    v_sub_f32 v84, v84, v224
    v_sub_f32 v85, v85, v224
    v_sub_f32 v86, v86, v224
    v_sub_f32 v87, v87, v224
    v_sub_f32 v88, v88, v224
    v_sub_f32 v89, v89, v224
    v_sub_f32 v90, v90, v224
    v_sub_f32 v91, v91, v224
    v_sub_f32 v92, v92, v224
    v_sub_f32 v93, v93, v224
    v_sub_f32 v94, v94, v224
    v_sub_f32 v95, v95, v224
    v_mul_f32 v182, v182, v228
    v_accvgpr_read_b32 v240, a0
    v_accvgpr_read_b32 v241, a1
    v_accvgpr_read_b32 v242, a2
    v_accvgpr_read_b32 v243, a3
    v_mul_f32 v240, v240, v228
    v_mul_f32 v241, v241, v228
    v_mul_f32 v242, v242, v228
    v_mul_f32 v243, v243, v228
    v_accvgpr_write_b32 a0, v240
    v_accvgpr_write_b32 a1, v241
    v_accvgpr_write_b32 a2, v242
    v_accvgpr_write_b32 a3, v243
    v_accvgpr_read_b32 v240, a4
    v_accvgpr_read_b32 v241, a5
    v_accvgpr_read_b32 v242, a6
    v_accvgpr_read_b32 v243, a7
    v_mul_f32 v240, v240, v228
    v_mul_f32 v241, v241, v228
    v_mul_f32 v242, v242, v228
    v_mul_f32 v243, v243, v228
    v_accvgpr_write_b32 a4, v240
    v_accvgpr_write_b32 a5, v241
    v_accvgpr_write_b32 a6, v242
    v_accvgpr_write_b32 a7, v243
    v_accvgpr_read_b32 v240, a8
    v_accvgpr_read_b32 v241, a9
    v_accvgpr_read_b32 v242, a10
    v_accvgpr_read_b32 v243, a11
    v_mul_f32 v240, v240, v228
    v_mul_f32 v241, v241, v228
    v_mul_f32 v242, v242, v228
    v_mul_f32 v243, v243, v228
    v_accvgpr_write_b32 a8, v240
    v_accvgpr_write_b32 a9, v241
    v_accvgpr_write_b32 a10, v242
    v_accvgpr_write_b32 a11, v243
    v_accvgpr_read_b32 v240, a12
    v_accvgpr_read_b32 v241, a13
    v_accvgpr_read_b32 v242, a14
    v_accvgpr_read_b32 v243, a15
    v_mul_f32 v240, v240, v228
    v_mul_f32 v241, v241, v228
    v_mul_f32 v242, v242, v228
    v_mul_f32 v243, v243, v228
    v_accvgpr_write_b32 a12, v240
    v_accvgpr_write_b32 a13, v241
    v_accvgpr_write_b32 a14, v242
    v_accvgpr_write_b32 a15, v243
    v_accvgpr_read_b32 v240, a16
    v_accvgpr_read_b32 v241, a17
    v_accvgpr_read_b32 v242, a18
    v_accvgpr_read_b32 v243, a19
    v_mul_f32 v240, v240, v228
    v_mul_f32 v241, v241, v228
    v_mul_f32 v242, v242, v228
    v_mul_f32 v243, v243, v228
    v_accvgpr_write_b32 a16, v240
    v_accvgpr_write_b32 a17, v241
    v_accvgpr_write_b32 a18, v242
    v_accvgpr_write_b32 a19, v243
    v_accvgpr_read_b32 v240, a20
    v_accvgpr_read_b32 v241, a21
    v_accvgpr_read_b32 v242, a22
    v_accvgpr_read_b32 v243, a23
    v_mul_f32 v240, v240, v228
    v_mul_f32 v241, v241, v228
    v_mul_f32 v242, v242, v228
    v_mul_f32 v243, v243, v228
    v_accvgpr_write_b32 a20, v240
    v_accvgpr_write_b32 a21, v241
    v_accvgpr_write_b32 a22, v242
    v_accvgpr_write_b32 a23, v243
    v_accvgpr_read_b32 v240, a24
    v_accvgpr_read_b32 v241, a25
    v_accvgpr_read_b32 v242, a26
    v_accvgpr_read_b32 v243, a27
    v_mul_f32 v240, v240, v228
    v_mul_f32 v241, v241, v228
    v_mul_f32 v242, v242, v228
    v_mul_f32 v243, v243, v228
    v_accvgpr_write_b32 a24, v240
    v_accvgpr_write_b32 a25, v241
    v_accvgpr_write_b32 a26, v242
    v_accvgpr_write_b32 a27, v243
    v_accvgpr_read_b32 v240, a28
    v_accvgpr_read_b32 v241, a29
    v_accvgpr_read_b32 v242, a30
    v_accvgpr_read_b32 v243, a31
    v_mul_f32 v240, v240, v228
    v_mul_f32 v241, v241, v228
    v_mul_f32 v242, v242, v228
    v_mul_f32 v243, v243, v228
    v_accvgpr_write_b32 a28, v240
    v_accvgpr_write_b32 a29, v241
    v_accvgpr_write_b32 a30, v242
    v_accvgpr_write_b32 a31, v243
    v_accvgpr_read_b32 v240, a32
    v_accvgpr_read_b32 v241, a33
    v_accvgpr_read_b32 v242, a34
    v_accvgpr_read_b32 v243, a35
    v_mul_f32 v240, v240, v228
    v_mul_f32 v241, v241, v228
    v_mul_f32 v242, v242, v228
    v_mul_f32 v243, v243, v228
    v_accvgpr_write_b32 a32, v240
    v_accvgpr_write_b32 a33, v241
    v_accvgpr_write_b32 a34, v242
    v_accvgpr_write_b32 a35, v243
    v_accvgpr_read_b32 v240, a36
    v_accvgpr_read_b32 v241, a37
    v_accvgpr_read_b32 v242, a38
    v_accvgpr_read_b32 v243, a39
    v_mul_f32 v240, v240, v228
    v_mul_f32 v241, v241, v228
    v_mul_f32 v242, v242, v228
    v_mul_f32 v243, v243, v228
    v_accvgpr_write_b32 a36, v240
    v_accvgpr_write_b32 a37, v241
    v_accvgpr_write_b32 a38, v242
    v_accvgpr_write_b32 a39, v243
    v_accvgpr_read_b32 v240, a40
    v_accvgpr_read_b32 v241, a41
    v_accvgpr_read_b32 v242, a42
    v_accvgpr_read_b32 v243, a43
    v_mul_f32 v240, v240, v228
    v_mul_f32 v241, v241, v228
    v_mul_f32 v242, v242, v228
    v_mul_f32 v243, v243, v228
    v_accvgpr_write_b32 a40, v240
    v_accvgpr_write_b32 a41, v241
    v_accvgpr_write_b32 a42, v242
    v_accvgpr_write_b32 a43, v243
    v_accvgpr_read_b32 v240, a44
    v_accvgpr_read_b32 v241, a45
    v_accvgpr_read_b32 v242, a46
    v_accvgpr_read_b32 v243, a47
    v_mul_f32 v240, v240, v228
    v_mul_f32 v241, v241, v228
    v_mul_f32 v242, v242, v228
    v_mul_f32 v243, v243, v228
    v_accvgpr_write_b32 a44, v240
    v_accvgpr_write_b32 a45, v241
    v_accvgpr_write_b32 a46, v242
    v_accvgpr_write_b32 a47, v243
    v_accvgpr_read_b32 v240, a48
    v_accvgpr_read_b32 v241, a49
    v_accvgpr_read_b32 v242, a50
    v_accvgpr_read_b32 v243, a51
    v_mul_f32 v240, v240, v228
    v_mul_f32 v241, v241, v228
    v_mul_f32 v242, v242, v228
    v_mul_f32 v243, v243, v228
    v_accvgpr_write_b32 a48, v240
    v_accvgpr_write_b32 a49, v241
    v_accvgpr_write_b32 a50, v242
    v_accvgpr_write_b32 a51, v243
    v_accvgpr_read_b32 v240, a52
    v_accvgpr_read_b32 v241, a53
    v_accvgpr_read_b32 v242, a54
    v_accvgpr_read_b32 v243, a55
    v_mul_f32 v240, v240, v228
    v_mul_f32 v241, v241, v228
    v_mul_f32 v242, v242, v228
    v_mul_f32 v243, v243, v228
    v_accvgpr_write_b32 a52, v240
    v_accvgpr_write_b32 a53, v241
    v_accvgpr_write_b32 a54, v242
    v_accvgpr_write_b32 a55, v243
    v_accvgpr_read_b32 v240, a56
    v_accvgpr_read_b32 v241, a57
    v_accvgpr_read_b32 v242, a58
    v_accvgpr_read_b32 v243, a59
    v_mul_f32 v240, v240, v228
    v_mul_f32 v241, v241, v228
    v_mul_f32 v242, v242, v228
    v_mul_f32 v243, v243, v228
    v_accvgpr_write_b32 a56, v240
    v_accvgpr_write_b32 a57, v241
    v_accvgpr_write_b32 a58, v242
    v_accvgpr_write_b32 a59, v243
    v_accvgpr_read_b32 v240, a60
    v_accvgpr_read_b32 v241, a61
    v_accvgpr_read_b32 v242, a62
    v_accvgpr_read_b32 v243, a63
    v_mul_f32 v240, v240, v228
    v_mul_f32 v241, v241, v228
    v_mul_f32 v242, v242, v228
    v_mul_f32 v243, v243, v228
    v_accvgpr_write_b32 a60, v240
    v_accvgpr_write_b32 a61, v241
    v_accvgpr_write_b32 a62, v242
    v_accvgpr_write_b32 a63, v243
    v_sub_f32 v144, v144, v225
    v_sub_f32 v145, v145, v225
    v_sub_f32 v146, v146, v225
    v_sub_f32 v147, v147, v225
    v_sub_f32 v148, v148, v225
    v_sub_f32 v149, v149, v225
    v_sub_f32 v150, v150, v225
    v_sub_f32 v151, v151, v225
    v_sub_f32 v152, v152, v225
    v_sub_f32 v153, v153, v225
    v_sub_f32 v154, v154, v225
    v_sub_f32 v155, v155, v225
    v_sub_f32 v156, v156, v225
    v_sub_f32 v157, v157, v225
    v_sub_f32 v158, v158, v225
    v_sub_f32 v159, v159, v225
    v_sub_f32 v32, v32, v225
    v_sub_f32 v33, v33, v225
    v_sub_f32 v34, v34, v225
    v_sub_f32 v35, v35, v225
    v_sub_f32 v36, v36, v225
    v_sub_f32 v37, v37, v225
    v_sub_f32 v38, v38, v225
    v_sub_f32 v39, v39, v225
    v_sub_f32 v40, v40, v225
    v_sub_f32 v41, v41, v225
    v_sub_f32 v42, v42, v225
    v_sub_f32 v43, v43, v225
    v_sub_f32 v44, v44, v225
    v_sub_f32 v45, v45, v225
    v_sub_f32 v46, v46, v225
    v_sub_f32 v47, v47, v225
    v_sub_f32 v48, v48, v225
    v_sub_f32 v49, v49, v225
    v_sub_f32 v50, v50, v225
    v_sub_f32 v51, v51, v225
    v_sub_f32 v52, v52, v225
    v_sub_f32 v53, v53, v225
    v_sub_f32 v54, v54, v225
    v_sub_f32 v55, v55, v225
    v_sub_f32 v56, v56, v225
    v_sub_f32 v57, v57, v225
    v_sub_f32 v58, v58, v225
    v_sub_f32 v59, v59, v225
    v_sub_f32 v60, v60, v225
    v_sub_f32 v61, v61, v225
    v_sub_f32 v62, v62, v225
    v_sub_f32 v63, v63, v225
    v_sub_f32 v96, v96, v225
    v_sub_f32 v97, v97, v225
    v_sub_f32 v98, v98, v225
    v_sub_f32 v99, v99, v225
    v_sub_f32 v100, v100, v225
    v_sub_f32 v101, v101, v225
    v_sub_f32 v102, v102, v225
    v_sub_f32 v103, v103, v225
    v_sub_f32 v104, v104, v225
    v_sub_f32 v105, v105, v225
    v_sub_f32 v106, v106, v225
    v_sub_f32 v107, v107, v225
    v_sub_f32 v108, v108, v225
    v_sub_f32 v109, v109, v225
    v_sub_f32 v110, v110, v225
    v_sub_f32 v111, v111, v225
    v_sub_f32 v112, v112, v225
    v_sub_f32 v113, v113, v225
    v_sub_f32 v114, v114, v225
    v_sub_f32 v115, v115, v225
    v_sub_f32 v116, v116, v225
    v_sub_f32 v117, v117, v225
    v_sub_f32 v118, v118, v225
    v_sub_f32 v119, v119, v225
    v_sub_f32 v120, v120, v225
    v_sub_f32 v121, v121, v225
    v_sub_f32 v122, v122, v225
    v_sub_f32 v123, v123, v225
    v_sub_f32 v124, v124, v225
    v_sub_f32 v125, v125, v225
    v_sub_f32 v126, v126, v225
    v_sub_f32 v127, v127, v225
    v_mul_f32 v183, v183, v229
    v_accvgpr_read_b32 v240, a64
    v_accvgpr_read_b32 v241, a65
    v_accvgpr_read_b32 v242, a66
    v_accvgpr_read_b32 v243, a67
    v_mul_f32 v240, v240, v229
    v_mul_f32 v241, v241, v229
    v_mul_f32 v242, v242, v229
    v_mul_f32 v243, v243, v229
    v_accvgpr_write_b32 a64, v240
    v_accvgpr_write_b32 a65, v241
    v_accvgpr_write_b32 a66, v242
    v_accvgpr_write_b32 a67, v243
    v_accvgpr_read_b32 v240, a68
    v_accvgpr_read_b32 v241, a69
    v_accvgpr_read_b32 v242, a70
    v_accvgpr_read_b32 v243, a71
    v_mul_f32 v240, v240, v229
    v_mul_f32 v241, v241, v229
    v_mul_f32 v242, v242, v229
    v_mul_f32 v243, v243, v229
    v_accvgpr_write_b32 a68, v240
    v_accvgpr_write_b32 a69, v241
    v_accvgpr_write_b32 a70, v242
    v_accvgpr_write_b32 a71, v243
    v_accvgpr_read_b32 v240, a72
    v_accvgpr_read_b32 v241, a73
    v_accvgpr_read_b32 v242, a74
    v_accvgpr_read_b32 v243, a75
    v_mul_f32 v240, v240, v229
    v_mul_f32 v241, v241, v229
    v_mul_f32 v242, v242, v229
    v_mul_f32 v243, v243, v229
    v_accvgpr_write_b32 a72, v240
    v_accvgpr_write_b32 a73, v241
    v_accvgpr_write_b32 a74, v242
    v_accvgpr_write_b32 a75, v243
    v_accvgpr_read_b32 v240, a76
    v_accvgpr_read_b32 v241, a77
    v_accvgpr_read_b32 v242, a78
    v_accvgpr_read_b32 v243, a79
    v_mul_f32 v240, v240, v229
    v_mul_f32 v241, v241, v229
    v_mul_f32 v242, v242, v229
    v_mul_f32 v243, v243, v229
    v_accvgpr_write_b32 a76, v240
    v_accvgpr_write_b32 a77, v241
    v_accvgpr_write_b32 a78, v242
    v_accvgpr_write_b32 a79, v243
    v_accvgpr_read_b32 v240, a80
    v_accvgpr_read_b32 v241, a81
    v_accvgpr_read_b32 v242, a82
    v_accvgpr_read_b32 v243, a83
    v_mul_f32 v240, v240, v229
    v_mul_f32 v241, v241, v229
    v_mul_f32 v242, v242, v229
    v_mul_f32 v243, v243, v229
    v_accvgpr_write_b32 a80, v240
    v_accvgpr_write_b32 a81, v241
    v_accvgpr_write_b32 a82, v242
    v_accvgpr_write_b32 a83, v243
    v_accvgpr_read_b32 v240, a84
    v_accvgpr_read_b32 v241, a85
    v_accvgpr_read_b32 v242, a86
    v_accvgpr_read_b32 v243, a87
    v_mul_f32 v240, v240, v229
    v_mul_f32 v241, v241, v229
    v_mul_f32 v242, v242, v229
    v_mul_f32 v243, v243, v229
    v_accvgpr_write_b32 a84, v240
    v_accvgpr_write_b32 a85, v241
    v_accvgpr_write_b32 a86, v242
    v_accvgpr_write_b32 a87, v243
    v_accvgpr_read_b32 v240, a88
    v_accvgpr_read_b32 v241, a89
    v_accvgpr_read_b32 v242, a90
    v_accvgpr_read_b32 v243, a91
    v_mul_f32 v240, v240, v229
    v_mul_f32 v241, v241, v229
    v_mul_f32 v242, v242, v229
    v_mul_f32 v243, v243, v229
    v_accvgpr_write_b32 a88, v240
    v_accvgpr_write_b32 a89, v241
    v_accvgpr_write_b32 a90, v242
    v_accvgpr_write_b32 a91, v243
    v_accvgpr_read_b32 v240, a92
    v_accvgpr_read_b32 v241, a93
    v_accvgpr_read_b32 v242, a94
    v_accvgpr_read_b32 v243, a95
    v_mul_f32 v240, v240, v229
    v_mul_f32 v241, v241, v229
    v_mul_f32 v242, v242, v229
    v_mul_f32 v243, v243, v229
    v_accvgpr_write_b32 a92, v240
    v_accvgpr_write_b32 a93, v241
    v_accvgpr_write_b32 a94, v242
    v_accvgpr_write_b32 a95, v243
    v_accvgpr_read_b32 v240, a96
    v_accvgpr_read_b32 v241, a97
    v_accvgpr_read_b32 v242, a98
    v_accvgpr_read_b32 v243, a99
    v_mul_f32 v240, v240, v229
    v_mul_f32 v241, v241, v229
    v_mul_f32 v242, v242, v229
    v_mul_f32 v243, v243, v229
    v_accvgpr_write_b32 a96, v240
    v_accvgpr_write_b32 a97, v241
    v_accvgpr_write_b32 a98, v242
    v_accvgpr_write_b32 a99, v243
    v_accvgpr_read_b32 v240, a100
    v_accvgpr_read_b32 v241, a101
    v_accvgpr_read_b32 v242, a102
    v_accvgpr_read_b32 v243, a103
    v_mul_f32 v240, v240, v229
    v_mul_f32 v241, v241, v229
    v_mul_f32 v242, v242, v229
    v_mul_f32 v243, v243, v229
    v_accvgpr_write_b32 a100, v240
    v_accvgpr_write_b32 a101, v241
    v_accvgpr_write_b32 a102, v242
    v_accvgpr_write_b32 a103, v243
    v_accvgpr_read_b32 v240, a104
    v_accvgpr_read_b32 v241, a105
    v_accvgpr_read_b32 v242, a106
    v_accvgpr_read_b32 v243, a107
    v_mul_f32 v240, v240, v229
    v_mul_f32 v241, v241, v229
    v_mul_f32 v242, v242, v229
    v_mul_f32 v243, v243, v229
    v_accvgpr_write_b32 a104, v240
    v_accvgpr_write_b32 a105, v241
    v_accvgpr_write_b32 a106, v242
    v_accvgpr_write_b32 a107, v243
    v_accvgpr_read_b32 v240, a108
    v_accvgpr_read_b32 v241, a109
    v_accvgpr_read_b32 v242, a110
    v_accvgpr_read_b32 v243, a111
    v_mul_f32 v240, v240, v229
    v_mul_f32 v241, v241, v229
    v_mul_f32 v242, v242, v229
    v_mul_f32 v243, v243, v229
    v_accvgpr_write_b32 a108, v240
    v_accvgpr_write_b32 a109, v241
    v_accvgpr_write_b32 a110, v242
    v_accvgpr_write_b32 a111, v243
    v_accvgpr_read_b32 v240, a112
    v_accvgpr_read_b32 v241, a113
    v_accvgpr_read_b32 v242, a114
    v_accvgpr_read_b32 v243, a115
    v_mul_f32 v240, v240, v229
    v_mul_f32 v241, v241, v229
    v_mul_f32 v242, v242, v229
    v_mul_f32 v243, v243, v229
    v_accvgpr_write_b32 a112, v240
    v_accvgpr_write_b32 a113, v241
    v_accvgpr_write_b32 a114, v242
    v_accvgpr_write_b32 a115, v243
    v_accvgpr_read_b32 v240, a116
    v_accvgpr_read_b32 v241, a117
    v_accvgpr_read_b32 v242, a118
    v_accvgpr_read_b32 v243, a119
    v_mul_f32 v240, v240, v229
    v_mul_f32 v241, v241, v229
    v_mul_f32 v242, v242, v229
    v_mul_f32 v243, v243, v229
    v_accvgpr_write_b32 a116, v240
    v_accvgpr_write_b32 a117, v241
    v_accvgpr_write_b32 a118, v242
    v_accvgpr_write_b32 a119, v243
    v_accvgpr_read_b32 v240, a120
    v_accvgpr_read_b32 v241, a121
    v_accvgpr_read_b32 v242, a122
    v_accvgpr_read_b32 v243, a123
    v_mul_f32 v240, v240, v229
    v_mul_f32 v241, v241, v229
    v_mul_f32 v242, v242, v229
    v_mul_f32 v243, v243, v229
    v_accvgpr_write_b32 a120, v240
    v_accvgpr_write_b32 a121, v241
    v_accvgpr_write_b32 a122, v242
    v_accvgpr_write_b32 a123, v243
    v_accvgpr_read_b32 v240, a124
    v_accvgpr_read_b32 v241, a125
    v_accvgpr_read_b32 v242, a126
    v_accvgpr_read_b32 v243, a127
    v_mul_f32 v240, v240, v229
    v_mul_f32 v241, v241, v229
    v_mul_f32 v242, v242, v229
    v_mul_f32 v243, v243, v229
    v_accvgpr_write_b32 a124, v240
    v_accvgpr_write_b32 a125, v241
    v_accvgpr_write_b32 a126, v242
    v_accvgpr_write_b32 a127, v243
    v_exp_f32 v0, v0
    v_exp_f32 v1, v1
    v_exp_f32 v2, v2
    v_add_f32 v184, v0, v1
    v_cvt_pk_bf16_f32 v0, v0, v1
    v_exp_f32 v3, v3
    v_add_f32 v184, v184, v2
    v_exp_f32 v4, v4
    v_add_f32 v184, v184, v3
    v_cvt_pk_bf16_f32 v1, v2, v3
    v_exp_f32 v5, v5
    v_add_f32 v184, v184, v4
    v_exp_f32 v6, v6
    v_add_f32 v184, v184, v5
    v_cvt_pk_bf16_f32 v2, v4, v5
    v_exp_f32 v7, v7
    v_add_f32 v184, v184, v6
    v_exp_f32 v8, v8
    v_add_f32 v184, v184, v7
    v_cvt_pk_bf16_f32 v3, v6, v7
    v_exp_f32 v9, v9
    v_add_f32 v184, v184, v8
    v_exp_f32 v10, v10
    v_add_f32 v184, v184, v9
    v_cvt_pk_bf16_f32 v8, v8, v9
    v_exp_f32 v11, v11
    v_add_f32 v184, v184, v10
    v_exp_f32 v12, v12
    v_add_f32 v184, v184, v11
    v_cvt_pk_bf16_f32 v9, v10, v11
    v_exp_f32 v13, v13
    v_add_f32 v184, v184, v12
    v_exp_f32 v14, v14
    v_add_f32 v184, v184, v13
    v_cvt_pk_bf16_f32 v10, v12, v13
    v_exp_f32 v15, v15
    v_add_f32 v184, v184, v14
    v_exp_f32 v32, v32
    v_add_f32 v184, v184, v15
    v_cvt_pk_bf16_f32 v11, v14, v15
    v_exp_f32 v33, v33
    v_exp_f32 v34, v34
    v_add_f32 v185, v32, v33
    v_cvt_pk_bf16_f32 v32, v32, v33
    v_exp_f32 v35, v35
    v_add_f32 v185, v185, v34
    v_exp_f32 v36, v36
    v_add_f32 v185, v185, v35
    v_cvt_pk_bf16_f32 v33, v34, v35
    v_exp_f32 v37, v37
    v_add_f32 v185, v185, v36
    v_exp_f32 v38, v38
    v_add_f32 v185, v185, v37
    v_cvt_pk_bf16_f32 v34, v36, v37
    v_exp_f32 v39, v39
    v_add_f32 v185, v185, v38
    v_exp_f32 v40, v40
    v_add_f32 v185, v185, v39
    v_cvt_pk_bf16_f32 v35, v38, v39
    v_exp_f32 v41, v41
    v_add_f32 v185, v185, v40
    v_exp_f32 v42, v42
    v_add_f32 v185, v185, v41
    v_cvt_pk_bf16_f32 v40, v40, v41
    v_exp_f32 v43, v43
    v_add_f32 v185, v185, v42
    v_exp_f32 v44, v44
    v_add_f32 v185, v185, v43
    v_cvt_pk_bf16_f32 v41, v42, v43
    v_exp_f32 v45, v45
    v_add_f32 v185, v185, v44
    v_exp_f32 v46, v46
    v_add_f32 v185, v185, v45
    v_cvt_pk_bf16_f32 v42, v44, v45
    v_exp_f32 v47, v47
    v_add_f32 v185, v185, v46
    s_nop 0
    v_add_f32 v185, v185, v47
    v_cvt_pk_bf16_f32 v43, v46, v47
    v_exp_f32 v16, v16
    v_exp_f32 v17, v17
    v_add_f32 v184, v184, v16
    v_exp_f32 v18, v18
    v_add_f32 v184, v184, v17
    v_cvt_pk_bf16_f32 v16, v16, v17
    v_exp_f32 v19, v19
    v_add_f32 v184, v184, v18
    v_exp_f32 v20, v20
    v_add_f32 v184, v184, v19
    v_cvt_pk_bf16_f32 v17, v18, v19
    v_exp_f32 v21, v21
    v_add_f32 v184, v184, v20
    v_exp_f32 v22, v22
    v_add_f32 v184, v184, v21
    v_cvt_pk_bf16_f32 v18, v20, v21
    v_exp_f32 v23, v23
    v_add_f32 v184, v184, v22
    v_exp_f32 v24, v24
    v_add_f32 v184, v184, v23
    v_cvt_pk_bf16_f32 v19, v22, v23
    v_exp_f32 v25, v25
    v_add_f32 v184, v184, v24
    v_exp_f32 v26, v26
    v_add_f32 v184, v184, v25
    v_cvt_pk_bf16_f32 v24, v24, v25
    v_exp_f32 v27, v27
    v_add_f32 v184, v184, v26
    v_exp_f32 v28, v28
    v_add_f32 v184, v184, v27
    v_cvt_pk_bf16_f32 v25, v26, v27
    v_exp_f32 v29, v29
    v_add_f32 v184, v184, v28
    v_exp_f32 v30, v30
    v_add_f32 v184, v184, v29
    v_cvt_pk_bf16_f32 v26, v28, v29
    v_exp_f32 v31, v31
    v_add_f32 v184, v184, v30
    v_exp_f32 v48, v48
    v_add_f32 v184, v184, v31
    v_cvt_pk_bf16_f32 v27, v30, v31
    v_exp_f32 v49, v49
    v_add_f32 v185, v185, v48
    v_exp_f32 v50, v50
    v_add_f32 v185, v185, v49
    v_cvt_pk_bf16_f32 v48, v48, v49
    v_exp_f32 v51, v51
    v_add_f32 v185, v185, v50
    v_exp_f32 v52, v52
    v_add_f32 v185, v185, v51
    v_cvt_pk_bf16_f32 v49, v50, v51
    v_exp_f32 v53, v53
    v_add_f32 v185, v185, v52
    v_exp_f32 v54, v54
    v_add_f32 v185, v185, v53
    v_cvt_pk_bf16_f32 v50, v52, v53
    v_exp_f32 v55, v55
    v_add_f32 v185, v185, v54
    v_exp_f32 v56, v56
    v_add_f32 v185, v185, v55
    v_cvt_pk_bf16_f32 v51, v54, v55
    v_exp_f32 v57, v57
    v_add_f32 v185, v185, v56
    v_exp_f32 v58, v58
    v_add_f32 v185, v185, v57
    v_cvt_pk_bf16_f32 v56, v56, v57
    v_exp_f32 v59, v59
    v_add_f32 v185, v185, v58
    v_exp_f32 v60, v60
    v_add_f32 v185, v185, v59
    v_cvt_pk_bf16_f32 v57, v58, v59
    v_exp_f32 v61, v61
    v_add_f32 v185, v185, v60
    v_exp_f32 v62, v62
    v_add_f32 v185, v185, v61
    v_cvt_pk_bf16_f32 v58, v60, v61
    v_exp_f32 v63, v63
    v_add_f32 v185, v185, v62
    s_nop 0
    v_add_f32 v185, v185, v63
    v_cvt_pk_bf16_f32 v59, v62, v63
    s_nop 3
    s_setpc_b64 s[60:61]
L_slow_1:
    s_nop 15
    s_nop 3
    s_add_u32 s56, s45, 0
    buffer_load_dwordx4 v[192:195], v180, s[8:11], s56 offen offset:0
    buffer_load_dwordx4 v[196:199], v180, s[8:11], s56 offen offset:32
    buffer_load_dwordx4 v[200:203], v180, s[8:11], s56 offen offset:64
    buffer_load_dwordx4 v[204:207], v180, s[8:11], s56 offen offset:96
    buffer_load_dwordx4 v[208:211], v180, s[8:11], s56 offen offset:128
    buffer_load_dwordx4 v[212:215], v180, s[8:11], s56 offen offset:160
    buffer_load_dwordx4 v[216:219], v180, s[8:11], s56 offen offset:192
    buffer_load_dwordx4 v[220:223], v180, s[8:11], s56 offen offset:224
    s_waitcnt vmcnt(0)
    v_mfma_f32_32x32x16_bf16 v[64:79], v[192:195], a[128:131], v[128:143]
    v_mfma_f32_32x32x16_bf16 v[96:111], v[192:195], a[160:163], v[144:159]
    v_mfma_f32_32x32x16_bf16 v[64:79], v[196:199], a[132:135], v[64:79]
    v_mfma_f32_32x32x16_bf16 v[96:111], v[196:199], a[164:167], v[96:111]
    v_mfma_f32_32x32x16_bf16 v[64:79], v[200:203], a[136:139], v[64:79]
    v_mfma_f32_32x32x16_bf16 v[96:111], v[200:203], a[168:171], v[96:111]
    v_mfma_f32_32x32x16_bf16 v[64:79], v[204:207], a[140:143], v[64:79]
    v_mfma_f32_32x32x16_bf16 v[96:111], v[204:207], a[172:175], v[96:111]
    v_mfma_f32_32x32x16_bf16 v[64:79], v[208:211], a[144:147], v[64:79]
    v_mfma_f32_32x32x16_bf16 v[96:111], v[208:211], a[176:179], v[96:111]
    v_mfma_f32_32x32x16_bf16 v[64:79], v[212:215], a[148:151], v[64:79]
    v_mfma_f32_32x32x16_bf16 v[96:111], v[212:215], a[180:183], v[96:111]
    v_mfma_f32_32x32x16_bf16 v[64:79], v[216:219], a[152:155], v[64:79]
    v_mfma_f32_32x32x16_bf16 v[96:111], v[216:219], a[184:187], v[96:111]
    v_mfma_f32_32x32x16_bf16 v[64:79], v[220:223], a[156:159], v[64:79]
    v_mfma_f32_32x32x16_bf16 v[96:111], v[220:223], a[188:191], v[96:111]
    s_nop 3
    s_add_u32 s56, s45, 131072
    buffer_load_dwordx4 v[192:195], v180, s[8:11], s56 offen offset:0
    buffer_load_dwordx4 v[196:199], v180, s[8:11], s56 offen offset:32
    buffer_load_dwordx4 v[200:203], v180, s[8:11], s56 offen offset:64
    buffer_load_dwordx4 v[204:207], v180, s[8:11], s56 offen offset:96
    buffer_load_dwordx4 v[208:211], v180, s[8:11], s56 offen offset:128
    buffer_load_dwordx4 v[212:215], v180, s[8:11], s56 offen offset:160
    buffer_load_dwordx4 v[216:219], v180, s[8:11], s56 offen offset:192
    buffer_load_dwordx4 v[220:223], v180, s[8:11], s56 offen offset:224
    s_waitcnt vmcnt(0)
    v_mfma_f32_32x32x16_bf16 v[80:95], v[192:195], a[128:131], v[128:143]
    v_mfma_f32_32x32x16_bf16 v[112:127], v[192:195], a[160:163], v[144:159]
    v_mfma_f32_32x32x16_bf16 v[80:95], v[196:199], a[132:135], v[80:95]
    v_mfma_f32_32x32x16_bf16 v[112:127], v[196:199], a[164:167], v[112:127]
    v_mfma_f32_32x32x16_bf16 v[80:95], v[200:203], a[136:139], v[80:95]
    v_mfma_f32_32x32x16_bf16 v[112:127], v[200:203], a[168:171], v[112:127]
    v_mfma_f32_32x32x16_bf16 v[80:95], v[204:207], a[140:143], v[80:95]
    v_mfma_f32_32x32x16_bf16 v[112:127], v[204:207], a[172:175], v[112:127]
    v_mfma_f32_32x32x16_bf16 v[80:95], v[208:211], a[144:147], v[80:95]
    v_mfma_f32_32x32x16_bf16 v[112:127], v[208:211], a[176:179], v[112:127]
    v_mfma_f32_32x32x16_bf16 v[80:95], v[212:215], a[148:151], v[80:95]
    v_mfma_f32_32x32x16_bf16 v[112:127], v[212:215], a[180:183], v[112:127]
    v_mfma_f32_32x32x16_bf16 v[80:95], v[216:219], a[152:155], v[80:95]
    v_mfma_f32_32x32x16_bf16 v[112:127], v[216:219], a[184:187], v[112:127]
    v_mfma_f32_32x32x16_bf16 v[80:95], v[220:223], a[156:159], v[80:95]
    v_mfma_f32_32x32x16_bf16 v[112:127], v[220:223], a[188:191], v[112:127]
    s_nop 3
    s_nop 15
    s_nop 3
    v_max3_f32 v224, v64, v65, v66
    v_max3_f32 v224, v224, v67, v68
    v_max3_f32 v224, v224, v69, v70
    v_max3_f32 v224, v224, v71, v72
    v_max3_f32 v224, v224, v73, v74
    v_max3_f32 v224, v224, v75, v76
    v_max3_f32 v224, v224, v77, v78
    v_max3_f32 v224, v224, v79, v80
    v_max3_f32 v224, v224, v81, v82
    v_max3_f32 v224, v224, v83, v84
    v_max3_f32 v224, v224, v85, v86
    v_max3_f32 v224, v224, v87, v88
    v_max3_f32 v224, v224, v89, v90
    v_max3_f32 v224, v224, v91, v92
    v_max3_f32 v224, v224, v93, v94
    v_max_f32 v224, v224, v95
    v_max3_f32 v225, v96, v97, v98
    v_max3_f32 v225, v225, v99, v100
    v_max3_f32 v225, v225, v101, v102
    v_max3_f32 v225, v225, v103, v104
    v_max3_f32 v225, v225, v105, v106
    v_max3_f32 v225, v225, v107, v108
    v_max3_f32 v225, v225, v109, v110
    v_max3_f32 v225, v225, v111, v112
    v_max3_f32 v225, v225, v113, v114
    v_max3_f32 v225, v225, v115, v116
    v_max3_f32 v225, v225, v117, v118
    v_max3_f32 v225, v225, v119, v120
    v_max3_f32 v225, v225, v121, v122
    v_max3_f32 v225, v225, v123, v124
    v_max3_f32 v225, v225, v125, v126
    v_max_f32 v225, v225, v127
    v_mov_b32 v226, v224
    v_mov_b32 v227, v225
    s_nop 1
    v_permlane32_swap_b32 v224, v226
    v_permlane32_swap_b32 v225, v227
    s_nop 1
    v_max_f32 v224, v224, v226
    v_max_f32 v225, v225, v227
    v_max_f32 v224, 0, v224
    v_max_f32 v225, 0, v225
    v_exp_f32 v228, -v224
    v_exp_f32 v229, -v225
    v_sub_f32 v128, v128, v224
    v_sub_f32 v129, v129, v224
    v_sub_f32 v130, v130, v224
    v_sub_f32 v131, v131, v224
    v_sub_f32 v132, v132, v224
    v_sub_f32 v133, v133, v224
    v_sub_f32 v134, v134, v224
    v_sub_f32 v135, v135, v224
    v_sub_f32 v136, v136, v224
    v_sub_f32 v137, v137, v224
    v_sub_f32 v138, v138, v224
    v_sub_f32 v139, v139, v224
    v_sub_f32 v140, v140, v224
    v_sub_f32 v141, v141, v224
    v_sub_f32 v142, v142, v224
    v_sub_f32 v143, v143, v224
    v_sub_f32 v0, v0, v224
    v_sub_f32 v1, v1, v224
    v_sub_f32 v2, v2, v224
    v_sub_f32 v3, v3, v224
    v_sub_f32 v4, v4, v224
    v_sub_f32 v5, v5, v224
    v_sub_f32 v6, v6, v224
    v_sub_f32 v7, v7, v224
    v_sub_f32 v8, v8, v224
    v_sub_f32 v9, v9, v224
    v_sub_f32 v10, v10, v224
    v_sub_f32 v11, v11, v224
    v_sub_f32 v12, v12, v224
    v_sub_f32 v13, v13, v224
    v_sub_f32 v14, v14, v224
    v_sub_f32 v15, v15, v224
    v_sub_f32 v16, v16, v224
    v_sub_f32 v17, v17, v224
    v_sub_f32 v18, v18, v224
    v_sub_f32 v19, v19, v224
    v_sub_f32 v20, v20, v224
    v_sub_f32 v21, v21, v224
    v_sub_f32 v22, v22, v224
    v_sub_f32 v23, v23, v224
    v_sub_f32 v24, v24, v224
    v_sub_f32 v25, v25, v224
    v_sub_f32 v26, v26, v224
    v_sub_f32 v27, v27, v224
    v_sub_f32 v28, v28, v224
    v_sub_f32 v29, v29, v224
    v_sub_f32 v30, v30, v224
    v_sub_f32 v31, v31, v224
    v_sub_f32 v64, v64, v224
    v_sub_f32 v65, v65, v224
    v_sub_f32 v66, v66, v224
    v_sub_f32 v67, v67, v224
    v_sub_f32 v68, v68, v224
    v_sub_f32 v69, v69, v224
    v_sub_f32 v70, v70, v224
    v_sub_f32 v71, v71, v224
    v_sub_f32 v72, v72, v224
    v_sub_f32 v73, v73, v224
    v_sub_f32 v74, v74, v224
    v_sub_f32 v75, v75, v224
    v_sub_f32 v76, v76, v224
    v_sub_f32 v77, v77, v224
    v_sub_f32 v78, v78, v224
    v_sub_f32 v79, v79, v224
    v_sub_f32 v80, v80, v224
    v_sub_f32 v81, v81, v224
    v_sub_f32 v82, v82, v224
    v_sub_f32 v83, v83, v224
    v_sub_f32 v84, v84, v224
    v_sub_f32 v85, v85, v224
    v_sub_f32 v86, v86, v224
    v_sub_f32 v87, v87, v224
    v_sub_f32 v88, v88, v224
    v_sub_f32 v89, v89, v224
    v_sub_f32 v90, v90, v224
    v_sub_f32 v91, v91, v224
    v_sub_f32 v92, v92, v224
    v_sub_f32 v93, v93, v224
    v_sub_f32 v94, v94, v224
    v_sub_f32 v95, v95, v224
    v_mul_f32 v182, v182, v228
    v_accvgpr_read_b32 v240, a0
    v_accvgpr_read_b32 v241, a1
    v_accvgpr_read_b32 v242, a2
    v_accvgpr_read_b32 v243, a3
    v_mul_f32 v240, v240, v228
    v_mul_f32 v241, v241, v228
    v_mul_f32 v242, v242, v228
    v_mul_f32 v243, v243, v228
    v_accvgpr_write_b32 a0, v240
    v_accvgpr_write_b32 a1, v241
    v_accvgpr_write_b32 a2, v242
    v_accvgpr_write_b32 a3, v243
    v_accvgpr_read_b32 v240, a4
    v_accvgpr_read_b32 v241, a5
    v_accvgpr_read_b32 v242, a6
    v_accvgpr_read_b32 v243, a7
    v_mul_f32 v240, v240, v228
    v_mul_f32 v241, v241, v228
    v_mul_f32 v242, v242, v228
    v_mul_f32 v243, v243, v228
    v_accvgpr_write_b32 a4, v240
    v_accvgpr_write_b32 a5, v241
    v_accvgpr_write_b32 a6, v242
    v_accvgpr_write_b32 a7, v243
    v_accvgpr_read_b32 v240, a8
    v_accvgpr_read_b32 v241, a9
    v_accvgpr_read_b32 v242, a10
    v_accvgpr_read_b32 v243, a11
    v_mul_f32 v240, v240, v228
    v_mul_f32 v241, v241, v228
    v_mul_f32 v242, v242, v228
    v_mul_f32 v243, v243, v228
    v_accvgpr_write_b32 a8, v240
    v_accvgpr_write_b32 a9, v241
    v_accvgpr_write_b32 a10, v242
    v_accvgpr_write_b32 a11, v243
    v_accvgpr_read_b32 v240, a12
    v_accvgpr_read_b32 v241, a13
    v_accvgpr_read_b32 v242, a14
    v_accvgpr_read_b32 v243, a15
    v_mul_f32 v240, v240, v228
    v_mul_f32 v241, v241, v228
    v_mul_f32 v242, v242, v228
    v_mul_f32 v243, v243, v228
    v_accvgpr_write_b32 a12, v240
    v_accvgpr_write_b32 a13, v241
    v_accvgpr_write_b32 a14, v242
    v_accvgpr_write_b32 a15, v243
    v_accvgpr_read_b32 v240, a16
    v_accvgpr_read_b32 v241, a17
    v_accvgpr_read_b32 v242, a18
    v_accvgpr_read_b32 v243, a19
    v_mul_f32 v240, v240, v228
    v_mul_f32 v241, v241, v228
    v_mul_f32 v242, v242, v228
    v_mul_f32 v243, v243, v228
    v_accvgpr_write_b32 a16, v240
    v_accvgpr_write_b32 a17, v241
    v_accvgpr_write_b32 a18, v242
    v_accvgpr_write_b32 a19, v243
    v_accvgpr_read_b32 v240, a20
    v_accvgpr_read_b32 v241, a21
    v_accvgpr_read_b32 v242, a22
    v_accvgpr_read_b32 v243, a23
    v_mul_f32 v240, v240, v228
    v_mul_f32 v241, v241, v228
    v_mul_f32 v242, v242, v228
    v_mul_f32 v243, v243, v228
    v_accvgpr_write_b32 a20, v240
    v_accvgpr_write_b32 a21, v241
    v_accvgpr_write_b32 a22, v242
    v_accvgpr_write_b32 a23, v243
    v_accvgpr_read_b32 v240, a24
    v_accvgpr_read_b32 v241, a25
    v_accvgpr_read_b32 v242, a26
    v_accvgpr_read_b32 v243, a27
    v_mul_f32 v240, v240, v228
    v_mul_f32 v241, v241, v228
    v_mul_f32 v242, v242, v228
    v_mul_f32 v243, v243, v228
    v_accvgpr_write_b32 a24, v240
    v_accvgpr_write_b32 a25, v241
    v_accvgpr_write_b32 a26, v242
    v_accvgpr_write_b32 a27, v243
    v_accvgpr_read_b32 v240, a28
    v_accvgpr_read_b32 v241, a29
    v_accvgpr_read_b32 v242, a30
    v_accvgpr_read_b32 v243, a31
    v_mul_f32 v240, v240, v228
    v_mul_f32 v241, v241, v228
    v_mul_f32 v242, v242, v228
    v_mul_f32 v243, v243, v228
    v_accvgpr_write_b32 a28, v240
    v_accvgpr_write_b32 a29, v241
    v_accvgpr_write_b32 a30, v242
    v_accvgpr_write_b32 a31, v243
    v_accvgpr_read_b32 v240, a32
    v_accvgpr_read_b32 v241, a33
    v_accvgpr_read_b32 v242, a34
    v_accvgpr_read_b32 v243, a35
    v_mul_f32 v240, v240, v228
    v_mul_f32 v241, v241, v228
    v_mul_f32 v242, v242, v228
    v_mul_f32 v243, v243, v228
    v_accvgpr_write_b32 a32, v240
    v_accvgpr_write_b32 a33, v241
    v_accvgpr_write_b32 a34, v242
    v_accvgpr_write_b32 a35, v243
    v_accvgpr_read_b32 v240, a36
    v_accvgpr_read_b32 v241, a37
    v_accvgpr_read_b32 v242, a38
    v_accvgpr_read_b32 v243, a39
    v_mul_f32 v240, v240, v228
    v_mul_f32 v241, v241, v228
    v_mul_f32 v242, v242, v228
    v_mul_f32 v243, v243, v228
    v_accvgpr_write_b32 a36, v240
    v_accvgpr_write_b32 a37, v241
    v_accvgpr_write_b32 a38, v242
    v_accvgpr_write_b32 a39, v243
    v_accvgpr_read_b32 v240, a40
    v_accvgpr_read_b32 v241, a41
    v_accvgpr_read_b32 v242, a42
    v_accvgpr_read_b32 v243, a43
    v_mul_f32 v240, v240, v228
    v_mul_f32 v241, v241, v228
    v_mul_f32 v242, v242, v228
    v_mul_f32 v243, v243, v228
    v_accvgpr_write_b32 a40, v240
    v_accvgpr_write_b32 a41, v241
    v_accvgpr_write_b32 a42, v242
    v_accvgpr_write_b32 a43, v243
    v_accvgpr_read_b32 v240, a44
    v_accvgpr_read_b32 v241, a45
    v_accvgpr_read_b32 v242, a46
    v_accvgpr_read_b32 v243, a47
    v_mul_f32 v240, v240, v228
    v_mul_f32 v241, v241, v228
    v_mul_f32 v242, v242, v228
    v_mul_f32 v243, v243, v228
    v_accvgpr_write_b32 a44, v240
    v_accvgpr_write_b32 a45, v241
    v_accvgpr_write_b32 a46, v242
    v_accvgpr_write_b32 a47, v243
    v_accvgpr_read_b32 v240, a48
    v_accvgpr_read_b32 v241, a49
    v_accvgpr_read_b32 v242, a50
    v_accvgpr_read_b32 v243, a51
    v_mul_f32 v240, v240, v228
    v_mul_f32 v241, v241, v228
    v_mul_f32 v242, v242, v228
    v_mul_f32 v243, v243, v228
    v_accvgpr_write_b32 a48, v240
    v_accvgpr_write_b32 a49, v241
    v_accvgpr_write_b32 a50, v242
    v_accvgpr_write_b32 a51, v243
    v_accvgpr_read_b32 v240, a52
    v_accvgpr_read_b32 v241, a53
    v_accvgpr_read_b32 v242, a54
    v_accvgpr_read_b32 v243, a55
    v_mul_f32 v240, v240, v228
    v_mul_f32 v241, v241, v228
    v_mul_f32 v242, v242, v228
    v_mul_f32 v243, v243, v228
    v_accvgpr_write_b32 a52, v240
    v_accvgpr_write_b32 a53, v241
    v_accvgpr_write_b32 a54, v242
    v_accvgpr_write_b32 a55, v243
    v_accvgpr_read_b32 v240, a56
    v_accvgpr_read_b32 v241, a57
    v_accvgpr_read_b32 v242, a58
    v_accvgpr_read_b32 v243, a59
    v_mul_f32 v240, v240, v228
    v_mul_f32 v241, v241, v228
    v_mul_f32 v242, v242, v228
    v_mul_f32 v243, v243, v228
    v_accvgpr_write_b32 a56, v240
    v_accvgpr_write_b32 a57, v241
    v_accvgpr_write_b32 a58, v242
    v_accvgpr_write_b32 a59, v243
    v_accvgpr_read_b32 v240, a60
    v_accvgpr_read_b32 v241, a61
    v_accvgpr_read_b32 v242, a62
    v_accvgpr_read_b32 v243, a63
    v_mul_f32 v240, v240, v228
    v_mul_f32 v241, v241, v228
    v_mul_f32 v242, v242, v228
    v_mul_f32 v243, v243, v228
    v_accvgpr_write_b32 a60, v240
    v_accvgpr_write_b32 a61, v241
    v_accvgpr_write_b32 a62, v242
    v_accvgpr_write_b32 a63, v243
    v_sub_f32 v144, v144, v225
    v_sub_f32 v145, v145, v225
    v_sub_f32 v146, v146, v225
    v_sub_f32 v147, v147, v225
    v_sub_f32 v148, v148, v225
    v_sub_f32 v149, v149, v225
    v_sub_f32 v150, v150, v225
    v_sub_f32 v151, v151, v225
    v_sub_f32 v152, v152, v225
    v_sub_f32 v153, v153, v225
    v_sub_f32 v154, v154, v225
    v_sub_f32 v155, v155, v225
    v_sub_f32 v156, v156, v225
    v_sub_f32 v157, v157, v225
    v_sub_f32 v158, v158, v225
    v_sub_f32 v159, v159, v225
    v_sub_f32 v32, v32, v225
    v_sub_f32 v33, v33, v225
    v_sub_f32 v34, v34, v225
    v_sub_f32 v35, v35, v225
    v_sub_f32 v36, v36, v225
    v_sub_f32 v37, v37, v225
    v_sub_f32 v38, v38, v225
    v_sub_f32 v39, v39, v225
    v_sub_f32 v40, v40, v225
    v_sub_f32 v41, v41, v225
    v_sub_f32 v42, v42, v225
    v_sub_f32 v43, v43, v225
    v_sub_f32 v44, v44, v225
    v_sub_f32 v45, v45, v225
    v_sub_f32 v46, v46, v225
    v_sub_f32 v47, v47, v225
    v_sub_f32 v48, v48, v225
    v_sub_f32 v49, v49, v225
    v_sub_f32 v50, v50, v225
    v_sub_f32 v51, v51, v225
    v_sub_f32 v52, v52, v225
    v_sub_f32 v53, v53, v225
    v_sub_f32 v54, v54, v225
    v_sub_f32 v55, v55, v225
    v_sub_f32 v56, v56, v225
    v_sub_f32 v57, v57, v225
    v_sub_f32 v58, v58, v225
    v_sub_f32 v59, v59, v225
    v_sub_f32 v60, v60, v225
    v_sub_f32 v61, v61, v225
    v_sub_f32 v62, v62, v225
    v_sub_f32 v63, v63, v225
    v_sub_f32 v96, v96, v225
    v_sub_f32 v97, v97, v225
    v_sub_f32 v98, v98, v225
    v_sub_f32 v99, v99, v225
    v_sub_f32 v100, v100, v225
    v_sub_f32 v101, v101, v225
    v_sub_f32 v102, v102, v225
    v_sub_f32 v103, v103, v225
    v_sub_f32 v104, v104, v225
    v_sub_f32 v105, v105, v225
    v_sub_f32 v106, v106, v225
    v_sub_f32 v107, v107, v225
    v_sub_f32 v108, v108, v225
    v_sub_f32 v109, v109, v225
    v_sub_f32 v110, v110, v225
    v_sub_f32 v111, v111, v225
    v_sub_f32 v112, v112, v225
    v_sub_f32 v113, v113, v225
    v_sub_f32 v114, v114, v225
    v_sub_f32 v115, v115, v225
    v_sub_f32 v116, v116, v225
    v_sub_f32 v117, v117, v225
    v_sub_f32 v118, v118, v225
    v_sub_f32 v119, v119, v225
    v_sub_f32 v120, v120, v225
    v_sub_f32 v121, v121, v225
    v_sub_f32 v122, v122, v225
    v_sub_f32 v123, v123, v225
    v_sub_f32 v124, v124, v225
    v_sub_f32 v125, v125, v225
    v_sub_f32 v126, v126, v225
    v_sub_f32 v127, v127, v225
    v_mul_f32 v183, v183, v229
    v_accvgpr_read_b32 v240, a64
    v_accvgpr_read_b32 v241, a65
    v_accvgpr_read_b32 v242, a66
    v_accvgpr_read_b32 v243, a67
    v_mul_f32 v240, v240, v229
    v_mul_f32 v241, v241, v229
    v_mul_f32 v242, v242, v229
    v_mul_f32 v243, v243, v229
    v_accvgpr_write_b32 a64, v240
    v_accvgpr_write_b32 a65, v241
    v_accvgpr_write_b32 a66, v242
    v_accvgpr_write_b32 a67, v243
    v_accvgpr_read_b32 v240, a68
    v_accvgpr_read_b32 v241, a69
    v_accvgpr_read_b32 v242, a70
    v_accvgpr_read_b32 v243, a71
    v_mul_f32 v240, v240, v229
    v_mul_f32 v241, v241, v229
    v_mul_f32 v242, v242, v229
    v_mul_f32 v243, v243, v229
    v_accvgpr_write_b32 a68, v240
    v_accvgpr_write_b32 a69, v241
    v_accvgpr_write_b32 a70, v242
    v_accvgpr_write_b32 a71, v243
    v_accvgpr_read_b32 v240, a72
    v_accvgpr_read_b32 v241, a73
    v_accvgpr_read_b32 v242, a74
    v_accvgpr_read_b32 v243, a75
    v_mul_f32 v240, v240, v229
    v_mul_f32 v241, v241, v229
    v_mul_f32 v242, v242, v229
    v_mul_f32 v243, v243, v229
    v_accvgpr_write_b32 a72, v240
    v_accvgpr_write_b32 a73, v241
    v_accvgpr_write_b32 a74, v242
    v_accvgpr_write_b32 a75, v243
    v_accvgpr_read_b32 v240, a76
    v_accvgpr_read_b32 v241, a77
    v_accvgpr_read_b32 v242, a78
    v_accvgpr_read_b32 v243, a79
    v_mul_f32 v240, v240, v229
    v_mul_f32 v241, v241, v229
    v_mul_f32 v242, v242, v229
    v_mul_f32 v243, v243, v229
    v_accvgpr_write_b32 a76, v240
    v_accvgpr_write_b32 a77, v241
    v_accvgpr_write_b32 a78, v242
    v_accvgpr_write_b32 a79, v243
    v_accvgpr_read_b32 v240, a80
    v_accvgpr_read_b32 v241, a81
    v_accvgpr_read_b32 v242, a82
    v_accvgpr_read_b32 v243, a83
    v_mul_f32 v240, v240, v229
    v_mul_f32 v241, v241, v229
    v_mul_f32 v242, v242, v229
    v_mul_f32 v243, v243, v229
    v_accvgpr_write_b32 a80, v240
    v_accvgpr_write_b32 a81, v241
    v_accvgpr_write_b32 a82, v242
    v_accvgpr_write_b32 a83, v243
    v_accvgpr_read_b32 v240, a84
    v_accvgpr_read_b32 v241, a85
    v_accvgpr_read_b32 v242, a86
    v_accvgpr_read_b32 v243, a87
    v_mul_f32 v240, v240, v229
    v_mul_f32 v241, v241, v229
    v_mul_f32 v242, v242, v229
    v_mul_f32 v243, v243, v229
    v_accvgpr_write_b32 a84, v240
    v_accvgpr_write_b32 a85, v241
    v_accvgpr_write_b32 a86, v242
    v_accvgpr_write_b32 a87, v243
    v_accvgpr_read_b32 v240, a88
    v_accvgpr_read_b32 v241, a89
    v_accvgpr_read_b32 v242, a90
    v_accvgpr_read_b32 v243, a91
    v_mul_f32 v240, v240, v229
    v_mul_f32 v241, v241, v229
    v_mul_f32 v242, v242, v229
    v_mul_f32 v243, v243, v229
    v_accvgpr_write_b32 a88, v240
    v_accvgpr_write_b32 a89, v241
    v_accvgpr_write_b32 a90, v242
    v_accvgpr_write_b32 a91, v243
    v_accvgpr_read_b32 v240, a92
    v_accvgpr_read_b32 v241, a93
    v_accvgpr_read_b32 v242, a94
    v_accvgpr_read_b32 v243, a95
    v_mul_f32 v240, v240, v229
    v_mul_f32 v241, v241, v229
    v_mul_f32 v242, v242, v229
    v_mul_f32 v243, v243, v229
    v_accvgpr_write_b32 a92, v240
    v_accvgpr_write_b32 a93, v241
    v_accvgpr_write_b32 a94, v242
    v_accvgpr_write_b32 a95, v243
    v_accvgpr_read_b32 v240, a96
    v_accvgpr_read_b32 v241, a97
    v_accvgpr_read_b32 v242, a98
    v_accvgpr_read_b32 v243, a99
    v_mul_f32 v240, v240, v229
    v_mul_f32 v241, v241, v229
    v_mul_f32 v242, v242, v229
    v_mul_f32 v243, v243, v229
    v_accvgpr_write_b32 a96, v240
    v_accvgpr_write_b32 a97, v241
    v_accvgpr_write_b32 a98, v242
    v_accvgpr_write_b32 a99, v243
    v_accvgpr_read_b32 v240, a100
    v_accvgpr_read_b32 v241, a101
    v_accvgpr_read_b32 v242, a102
    v_accvgpr_read_b32 v243, a103
    v_mul_f32 v240, v240, v229
    v_mul_f32 v241, v241, v229
    v_mul_f32 v242, v242, v229
    v_mul_f32 v243, v243, v229
    v_accvgpr_write_b32 a100, v240
    v_accvgpr_write_b32 a101, v241
    v_accvgpr_write_b32 a102, v242
    v_accvgpr_write_b32 a103, v243
    v_accvgpr_read_b32 v240, a104
    v_accvgpr_read_b32 v241, a105
    v_accvgpr_read_b32 v242, a106
    v_accvgpr_read_b32 v243, a107
    v_mul_f32 v240, v240, v229
    v_mul_f32 v241, v241, v229
    v_mul_f32 v242, v242, v229
    v_mul_f32 v243, v243, v229
    v_accvgpr_write_b32 a104, v240
    v_accvgpr_write_b32 a105, v241
    v_accvgpr_write_b32 a106, v242
    v_accvgpr_write_b32 a107, v243
    v_accvgpr_read_b32 v240, a108
    v_accvgpr_read_b32 v241, a109
    v_accvgpr_read_b32 v242, a110
    v_accvgpr_read_b32 v243, a111
    v_mul_f32 v240, v240, v229
    v_mul_f32 v241, v241, v229
    v_mul_f32 v242, v242, v229
    v_mul_f32 v243, v243, v229
    v_accvgpr_write_b32 a108, v240
    v_accvgpr_write_b32 a109, v241
    v_accvgpr_write_b32 a110, v242
    v_accvgpr_write_b32 a111, v243
    v_accvgpr_read_b32 v240, a112
    v_accvgpr_read_b32 v241, a113
    v_accvgpr_read_b32 v242, a114
    v_accvgpr_read_b32 v243, a115
    v_mul_f32 v240, v240, v229
    v_mul_f32 v241, v241, v229
    v_mul_f32 v242, v242, v229
    v_mul_f32 v243, v243, v229
    v_accvgpr_write_b32 a112, v240
    v_accvgpr_write_b32 a113, v241
    v_accvgpr_write_b32 a114, v242
    v_accvgpr_write_b32 a115, v243
    v_accvgpr_read_b32 v240, a116
    v_accvgpr_read_b32 v241, a117
    v_accvgpr_read_b32 v242, a118
    v_accvgpr_read_b32 v243, a119
    v_mul_f32 v240, v240, v229
    v_mul_f32 v241, v241, v229
    v_mul_f32 v242, v242, v229
    v_mul_f32 v243, v243, v229
    v_accvgpr_write_b32 a116, v240
    v_accvgpr_write_b32 a117, v241
    v_accvgpr_write_b32 a118, v242
    v_accvgpr_write_b32 a119, v243
    v_accvgpr_read_b32 v240, a120
    v_accvgpr_read_b32 v241, a121
    v_accvgpr_read_b32 v242, a122
    v_accvgpr_read_b32 v243, a123
    v_mul_f32 v240, v240, v229
    v_mul_f32 v241, v241, v229
    v_mul_f32 v242, v242, v229
    v_mul_f32 v243, v243, v229
    v_accvgpr_write_b32 a120, v240
    v_accvgpr_write_b32 a121, v241
    v_accvgpr_write_b32 a122, v242
    v_accvgpr_write_b32 a123, v243
    v_accvgpr_read_b32 v240, a124
    v_accvgpr_read_b32 v241, a125
    v_accvgpr_read_b32 v242, a126
    v_accvgpr_read_b32 v243, a127
    v_mul_f32 v240, v240, v229
    v_mul_f32 v241, v241, v229
    v_mul_f32 v242, v242, v229
    v_mul_f32 v243, v243, v229
    v_accvgpr_write_b32 a124, v240
    v_accvgpr_write_b32 a125, v241
    v_accvgpr_write_b32 a126, v242
    v_accvgpr_write_b32 a127, v243
    v_exp_f32 v64, v64
    v_exp_f32 v65, v65
    v_exp_f32 v66, v66
    v_add_f32 v184, v64, v65
    v_cvt_pk_bf16_f32 v64, v64, v65
    v_exp_f32 v67, v67
    v_add_f32 v184, v184, v66
    v_exp_f32 v68, v68
    v_add_f32 v184, v184, v67
    v_cvt_pk_bf16_f32 v65, v66, v67
    v_exp_f32 v69, v69
    v_add_f32 v184, v184, v68
    v_exp_f32 v70, v70
    v_add_f32 v184, v184, v69
    v_cvt_pk_bf16_f32 v66, v68, v69
    v_exp_f32 v71, v71
    v_add_f32 v184, v184, v70
    v_exp_f32 v72, v72
    v_add_f32 v184, v184, v71
    v_cvt_pk_bf16_f32 v67, v70, v71
    v_exp_f32 v73, v73
    v_add_f32 v184, v184, v72
    v_exp_f32 v74, v74
    v_add_f32 v184, v184, v73
    v_cvt_pk_bf16_f32 v72, v72, v73
    v_exp_f32 v75, v75
    v_add_f32 v184, v184, v74
    v_exp_f32 v76, v76
    v_add_f32 v184, v184, v75
    v_cvt_pk_bf16_f32 v73, v74, v75
    v_exp_f32 v77, v77
    v_add_f32 v184, v184, v76
    v_exp_f32 v78, v78
    v_add_f32 v184, v184, v77
    v_cvt_pk_bf16_f32 v74, v76, v77
    v_exp_f32 v79, v79
    v_add_f32 v184, v184, v78
    v_exp_f32 v96, v96
    v_add_f32 v184, v184, v79
    v_cvt_pk_bf16_f32 v75, v78, v79
    v_exp_f32 v97, v97
    v_exp_f32 v98, v98
    v_add_f32 v185, v96, v97
    v_cvt_pk_bf16_f32 v96, v96, v97
    v_exp_f32 v99, v99
    v_add_f32 v185, v185, v98
    v_exp_f32 v100, v100
    v_add_f32 v185, v185, v99
    v_cvt_pk_bf16_f32 v97, v98, v99
    v_exp_f32 v101, v101
    v_add_f32 v185, v185, v100
    v_exp_f32 v102, v102
    v_add_f32 v185, v185, v101
    v_cvt_pk_bf16_f32 v98, v100, v101
    v_exp_f32 v103, v103
    v_add_f32 v185, v185, v102
    v_exp_f32 v104, v104
    v_add_f32 v185, v185, v103
    v_cvt_pk_bf16_f32 v99, v102, v103
    v_exp_f32 v105, v105
    v_add_f32 v185, v185, v104
    v_exp_f32 v106, v106
    v_add_f32 v185, v185, v105
    v_cvt_pk_bf16_f32 v104, v104, v105
    v_exp_f32 v107, v107
    v_add_f32 v185, v185, v106
    v_exp_f32 v108, v108
    v_add_f32 v185, v185, v107
    v_cvt_pk_bf16_f32 v105, v106, v107
    v_exp_f32 v109, v109
    v_add_f32 v185, v185, v108
    v_exp_f32 v110, v110
    v_add_f32 v185, v185, v109
    v_cvt_pk_bf16_f32 v106, v108, v109
    v_exp_f32 v111, v111
    v_add_f32 v185, v185, v110
    s_nop 0
    v_add_f32 v185, v185, v111
    v_cvt_pk_bf16_f32 v107, v110, v111
    v_exp_f32 v80, v80
    v_exp_f32 v81, v81
    v_add_f32 v184, v184, v80
    v_exp_f32 v82, v82
    v_add_f32 v184, v184, v81
    v_cvt_pk_bf16_f32 v80, v80, v81
    v_exp_f32 v83, v83
    v_add_f32 v184, v184, v82
    v_exp_f32 v84, v84
    v_add_f32 v184, v184, v83
    v_cvt_pk_bf16_f32 v81, v82, v83
    v_exp_f32 v85, v85
    v_add_f32 v184, v184, v84
    v_exp_f32 v86, v86
    v_add_f32 v184, v184, v85
    v_cvt_pk_bf16_f32 v82, v84, v85
    v_exp_f32 v87, v87
    v_add_f32 v184, v184, v86
    v_exp_f32 v88, v88
    v_add_f32 v184, v184, v87
    v_cvt_pk_bf16_f32 v83, v86, v87
    v_exp_f32 v89, v89
    v_add_f32 v184, v184, v88
    v_exp_f32 v90, v90
    v_add_f32 v184, v184, v89
    v_cvt_pk_bf16_f32 v88, v88, v89
    v_exp_f32 v91, v91
    v_add_f32 v184, v184, v90
    v_exp_f32 v92, v92
    v_add_f32 v184, v184, v91
    v_cvt_pk_bf16_f32 v89, v90, v91
    v_exp_f32 v93, v93
    v_add_f32 v184, v184, v92
    v_exp_f32 v94, v94
    v_add_f32 v184, v184, v93
    v_cvt_pk_bf16_f32 v90, v92, v93
    v_exp_f32 v95, v95
    v_add_f32 v184, v184, v94
    v_exp_f32 v112, v112
    v_add_f32 v184, v184, v95
    v_cvt_pk_bf16_f32 v91, v94, v95
    v_exp_f32 v113, v113
    v_add_f32 v185, v185, v112
    v_exp_f32 v114, v114
    v_add_f32 v185, v185, v113
    v_cvt_pk_bf16_f32 v112, v112, v113
    v_exp_f32 v115, v115
    v_add_f32 v185, v185, v114
    v_exp_f32 v116, v116
    v_add_f32 v185, v185, v115
    v_cvt_pk_bf16_f32 v113, v114, v115
    v_exp_f32 v117, v117
    v_add_f32 v185, v185, v116
    v_exp_f32 v118, v118
    v_add_f32 v185, v185, v117
    v_cvt_pk_bf16_f32 v114, v116, v117
    v_exp_f32 v119, v119
    v_add_f32 v185, v185, v118
    v_exp_f32 v120, v120
    v_add_f32 v185, v185, v119
    v_cvt_pk_bf16_f32 v115, v118, v119
    v_exp_f32 v121, v121
    v_add_f32 v185, v185, v120
    v_exp_f32 v122, v122
    v_add_f32 v185, v185, v121
    v_cvt_pk_bf16_f32 v120, v120, v121
    v_exp_f32 v123, v123
    v_add_f32 v185, v185, v122
    v_exp_f32 v124, v124
    v_add_f32 v185, v185, v123
    v_cvt_pk_bf16_f32 v121, v122, v123
    v_exp_f32 v125, v125
    v_add_f32 v185, v185, v124
    v_exp_f32 v126, v126
    v_add_f32 v185, v185, v125
    v_cvt_pk_bf16_f32 v122, v124, v125
    v_exp_f32 v127, v127
    v_add_f32 v185, v185, v126
    s_nop 0
    v_add_f32 v185, v185, v127
    v_cvt_pk_bf16_f32 v123, v126, v127
    s_nop 3
    s_setpc_b64 s[60:61]
L_codeend:
.section .rodata,"a"
.p2align 6
.amdhsa_kernel standalone__varlen_attn_packed__ragged_kernel
  .amdhsa_next_free_vgpr 512
  .amdhsa_next_free_sgpr 102
  .amdhsa_accum_offset 256
  .amdhsa_group_segment_fixed_size 0
  .amdhsa_kernarg_size 56
  .amdhsa_user_sgpr_count 2
  .amdhsa_user_sgpr_kernarg_segment_ptr 1
  .amdhsa_system_sgpr_workgroup_id_x 1
.end_amdhsa_kernel
.p2align 8
L_table:
.long 13090816,13512704,9945088,6799360,1073742093,1,17,0
.long 3145728,3391488,3145728,0,1006633229,0,0,0
.long 0,0,0,0,0,0,0,0
.long 0,0,0,0,0,0,0,0
.long 0,0,0,0,0,0,0,0
.long 0,0,0,0,0,0,0,0
.long 0,0,0,0,0,0,0,0
.long 0,0,0,0,0,0,0,0
.long 13091072,13512704,9945344,6799616,1073742093,1153,1169,0
.long 3145984,3391488,3145984,256,1006633229,0,0,0
.long 0,0,0,0,0,0,0,0
.long 0,0,0,0,0,0,0,0
.long 0,0,0,0,0,0,0,0
.long 0,0,0,0,0,0,0,0
.long 0,0,0,0,0,0,0,0
.long 0,0,0,0,0,0,0,0
.long 13091328,13512704,9945600,6799872,1073742093,2305,2321,0
.long 3146240,3391488,3146240,512,1006633229,0,0,0
.long 0,0,0,0,0,0,0,0
.long 0,0,0,0,0,0,0,0
.long 0,0,0,0,0,0,0,0
.long 0,0,0,0,0,0,0,0
.long 0,0,0,0,0,0,0,0
.long 0,0,0,0,0,0,0,0
.long 13091584,13512704,9945856,6800128,1073742093,3457,3473,0
.long 3146496,3391488,3146496,768,1006633229,0,0,0
.long 0,0,0,0,0,0,0,0
.long 0,0,0,0,0,0,0,0
.long 0,0,0,0,0,0,0,0
.long 0,0,0,0,0,0,0,0
.long 0,0,0,0,0,0,0,0
.long 0,0,0,0,0,0,0,0
.long 13091840,13512704,9946112,6800384,1073742093,4609,4625,0
.long 3146752,3391488,3146752,1024,1006633229,0,0,0
.long 0,0,0,0,0,0,0,0
.long 0,0,0,0,0,0,0,0
.long 0,0,0,0,0,0,0,0
.long 0,0,0,0,0,0,0,0
.long 0,0,0,0,0,0,0,0
.long 0,0,0,0,0,0,0,0
.long 13092096,13512704,9946368,6800640,1073742093,5761,5777,0
.long 3147008,3391488,3147008,1280,1006633229,0,0,0
.long 0,0,0,0,0,0,0,0
.long 0,0,0,0,0,0,0,0
.long 0,0,0,0,0,0,0,0
.long 0,0,0,0,0,0,0,0
.long 0,0,0,0,0,0,0,0
.long 0,0,0,0,0,0,0,0
.long 13092352,13512704,9946624,6800896,1073742093,6913,6929,0
.long 3147264,3391488,3147264,1536,1006633229,0,0,0
.long 0,0,0,0,0,0,0,0
.long 0,0,0,0,0,0,0,0
.long 0,0,0,0,0,0,0,0
.long 0,0,0,0,0,0,0,0
.long 0,0,0,0,0,0,0,0
.long 0,0,0,0,0,0,0,0
.long 13092608,13512704,9946880,6801152,1073742093,8065,8081,0
.long 3147520,3391488,3147520,1792,1006633229,0,0,0
.long 0,0,0,0,0,0,0,0
.long 0,0,0,0,0,0,0,0
.long 0,0,0,0,0,0,0,0
.long 0,0,0,0,0,0,0,0
.long 0,0,0,0,0,0,0,0
.long 0,0,0,0,0,0,0,0
.long 13092864,13512704,9947136,6801408,1073742093,65,81,0
.long 3147776,3391488,3147776,2048,1006633229,0,0,0
.long 0,0,0,0,0,0,0,0
.long 0,0,0,0,0,0,0,0
.long 0,0,0,0,0,0,0,0
.long 0,0,0,0,0,0,0,0
.long 0,0,0,0,0,0,0,0
.long 0,0,0,0,0,0,0,0
.long 13093120,13512704,9947392,6801664,1073742093,1217,1233,0
.long 3148032,3391488,3148032,2304,1006633229,0,0,0
.long 0,0,0,0,0,0,0,0
.long 0,0,0,0,0,0,0,0
.long 0,0,0,0,0,0,0,0
.long 0,0,0,0,0,0,0,0
.long 0,0,0,0,0,0,0,0
.long 0,0,0,0,0,0,0,0
.long 13093376,13512704,9947648,6801920,1073742093,2369,2385,0
.long 3148288,3391488,3148288,2560,1006633229,0,0,0
.long 0,0,0,0,0,0,0,0
.long 0,0,0,0,0,0,0,0
.long 0,0,0,0,0,0,0,0
.long 0,0,0,0,0,0,0,0
.long 0,0,0,0,0,0,0,0
.long 0,0,0,0,0,0,0,0
.long 13093632,13512704,9947904,6802176,1073742093,3521,3537,0
.long 3148544,3391488,3148544,2816,1006633229,0,0,0
.long 0,0,0,0,0,0,0,0
.long 0,0,0,0,0,0,0,0
.long 0,0,0,0,0,0,0,0
.long 0,0,0,0,0,0,0,0
.long 0,0,0,0,0,0,0,0
.long 0,0,0,0,0,0,0,0
.long 13093888,13512704,9948160,6802432,1073742093,4673,4689,0
.long 3148800,3391488,3148800,3072,1006633229,0,0,0
.long 0,0,0,0,0,0,0,0
.long 0,0,0,0,0,0,0,0
.long 0,0,0,0,0,0,0,0
.long 0,0,0,0,0,0,0,0
.long 0,0,0,0,0,0,0,0
.long 0,0,0,0,0,0,0,0
.long 13094144,13512704,9948416,6802688,1073742093,5825,5841,0
.long 3149056,3391488,3149056,3328,1006633229,0,0,0
.long 0,0,0,0,0,0,0,0
.long 0,0,0,0,0,0,0,0
.long 0,0,0,0,0,0,0,0
.long 0,0,0,0,0,0,0,0
.long 0,0,0,0,0,0,0,0
.long 0,0,0,0,0,0,0,0
.long 13094400,13512704,9948672,6802944,1073742093,6977,6993,0
.long 3149312,3391488,3149312,3584,1006633229,0,0,0
.long 0,0,0,0,0,0,0,0
.long 0,0,0,0,0,0,0,0
.long 0,0,0,0,0,0,0,0
.long 0,0,0,0,0,0,0,0
.long 0,0,0,0,0,0,0,0
.long 0,0,0,0,0,0,0,0
.long 13094656,13512704,9948928,6803200,1073742093,8129,8145,0
.long 3149568,3391488,3149568,3840,1006633229,0,0,0
.long 0,0,0,0,0,0,0,0
.long 0,0,0,0,0,0,0,0
.long 0,0,0,0,0,0,0,0
.long 0,0,0,0,0,0,0,0
.long 0,0,0,0,0,0,0,0
.long 0,0,0,0,0,0,0,0
.long 6799360,13512704,8634368,6799360,1073741832,129,145,1
.long 7323648,13512704,8634368,6799360,1073741832,161,177,1
.long 13512704,15335424,15085568,13512704,1023410183,0,0,0
.long 14036992,15335424,15085568,13512704,1023410183,0,0,0
.long 0,0,0,0,0,0,0,0
.long 0,0,0,0,0,0,0,0
.long 0,0,0,0,0,0,0,0
.long 0,0,0,0,0,0,0,0
.long 6799616,13512704,8634624,6799616,1073741832,1281,1297,1
.long 7323904,13512704,8634624,6799616,1073741832,1313,1329,1
.long 13512960,15335424,15085824,13512960,1023410183,0,0,0
.long 14037248,15335424,15085824,13512960,1023410183,0,0,0
.long 0,0,0,0,0,0,0,0
.long 0,0,0,0,0,0,0,0
.long 0,0,0,0,0,0,0,0
.long 0,0,0,0,0,0,0,0
.long 6799872,13512704,8634880,6799872,1073741832,2433,2449,1
.long 7324160,13512704,8634880,6799872,1073741832,2465,2481,1
.long 13513216,15335424,15086080,13513216,1023410183,0,0,0
.long 14037504,15335424,15086080,13513216,1023410183,0,0,0
.long 0,0,0,0,0,0,0,0
.long 0,0,0,0,0,0,0,0
.long 0,0,0,0,0,0,0,0
.long 0,0,0,0,0,0,0,0
.long 6800128,13512704,8635136,6800128,1073741832,3585,3601,1
.long 7324416,13512704,8635136,6800128,1073741832,3617,3633,1
.long 13513472,15335424,15086336,13513472,1023410183,0,0,0
.long 14037760,15335424,15086336,13513472,1023410183,0,0,0
.long 0,0,0,0,0,0,0,0
.long 0,0,0,0,0,0,0,0
.long 0,0,0,0,0,0,0,0
.long 0,0,0,0,0,0,0,0
.long 6800384,13512704,8635392,6800384,1073741832,4737,4753,1
.long 7324672,13512704,8635392,6800384,1073741832,4769,4785,1
.long 13513728,15335424,15086592,13513728,1023410183,0,0,0
.long 14038016,15335424,15086592,13513728,1023410183,0,0,0
.long 0,0,0,0,0,0,0,0
.long 0,0,0,0,0,0,0,0
.long 0,0,0,0,0,0,0,0
.long 0,0,0,0,0,0,0,0
.long 6800640,13512704,8635648,6800640,1073741832,5889,5905,1
.long 7324928,13512704,8635648,6800640,1073741832,5921,5937,1
.long 13513984,15335424,15086848,13513984,1023410183,0,0,0
.long 14038272,15335424,15086848,13513984,1023410183,0,0,0
.long 0,0,0,0,0,0,0,0
.long 0,0,0,0,0,0,0,0
.long 0,0,0,0,0,0,0,0
.long 0,0,0,0,0,0,0,0
.long 6800896,13512704,8635904,6800896,1073741832,7041,7057,1
.long 7325184,13512704,8635904,6800896,1073741832,7073,7089,1
.long 13514240,15335424,15087104,13514240,1023410183,0,0,0
.long 14038528,15335424,15087104,13514240,1023410183,0,0,0
.long 0,0,0,0,0,0,0,0
.long 0,0,0,0,0,0,0,0
.long 0,0,0,0,0,0,0,0
.long 0,0,0,0,0,0,0,0
.long 6801152,13512704,8636160,6801152,1073741832,8193,8209,1
.long 7325440,13512704,8636160,6801152,1073741832,8225,8241,1
.long 13514496,15335424,15087360,13514496,1023410183,0,0,0
.long 14038784,15335424,15087360,13514496,1023410183,0,0,0
.long 0,0,0,0,0,0,0,0
.long 0,0,0,0,0,0,0,0
.long 0,0,0,0,0,0,0,0
.long 0,0,0,0,0,0,0,0
.long 7847936,13512704,8634368,6799360,1073741832,193,209,1
.long 8372224,13512704,8634368,6799360,1073741832,225,241,1
.long 14561280,15335424,15085568,13512704,1023410183,0,0,0
.long 15085568,15335424,15085568,13512704,1023410183,0,0,0
.long 0,0,0,0,0,0,0,0
.long 0,0,0,0,0,0,0,0
.long 0,0,0,0,0,0,0,0
.long 0,0,0,0,0,0,0,0
.long 7848192,13512704,8634624,6799616,1073741832,1345,1361,1
.long 8372480,13512704,8634624,6799616,1073741832,1377,1393,1
.long 14561536,15335424,15085824,13512960,1023410183,0,0,0
.long 15085824,15335424,15085824,13512960,1023410183,0,0,0
.long 0,0,0,0,0,0,0,0
.long 0,0,0,0,0,0,0,0
.long 0,0,0,0,0,0,0,0
.long 0,0,0,0,0,0,0,0
.long 7848448,13512704,8634880,6799872,1073741832,2497,2513,1
.long 8372736,13512704,8634880,6799872,1073741832,2529,2545,1
.long 14561792,15335424,15086080,13513216,1023410183,0,0,0
.long 15086080,15335424,15086080,13513216,1023410183,0,0,0
.long 0,0,0,0,0,0,0,0
.long 0,0,0,0,0,0,0,0
.long 0,0,0,0,0,0,0,0
.long 0,0,0,0,0,0,0,0
.long 7848704,13512704,8635136,6800128,1073741832,3649,3665,1
.long 8372992,13512704,8635136,6800128,1073741832,3681,3697,1
.long 14562048,15335424,15086336,13513472,1023410183,0,0,0
.long 15086336,15335424,15086336,13513472,1023410183,0,0,0
.long 0,0,0,0,0,0,0,0
.long 0,0,0,0,0,0,0,0
.long 0,0,0,0,0,0,0,0
.long 0,0,0,0,0,0,0,0
.long 7848960,13512704,8635392,6800384,1073741832,4801,4817,1
.long 8373248,13512704,8635392,6800384,1073741832,4833,4849,1
.long 14562304,15335424,15086592,13513728,1023410183,0,0,0
.long 15086592,15335424,15086592,13513728,1023410183,0,0,0
.long 0,0,0,0,0,0,0,0
.long 0,0,0,0,0,0,0,0
.long 0,0,0,0,0,0,0,0
.long 0,0,0,0,0,0,0,0
.long 7849216,13512704,8635648,6800640,1073741832,5953,5969,1
.long 8373504,13512704,8635648,6800640,1073741832,5985,6001,1
.long 14562560,15335424,15086848,13513984,1023410183,0,0,0
.long 15086848,15335424,15086848,13513984,1023410183,0,0,0
.long 0,0,0,0,0,0,0,0
.long 0,0,0,0,0,0,0,0
.long 0,0,0,0,0,0,0,0
.long 0,0,0,0,0,0,0,0
.long 7849472,13512704,8635904,6800896,1073741832,7105,7121,1
.long 8373760,13512704,8635904,6800896,1073741832,7137,7153,1
.long 14562816,15335424,15087104,13514240,1023410183,0,0,0
.long 15087104,15335424,15087104,13514240,1023410183,0,0,0
.long 0,0,0,0,0,0,0,0
.long 0,0,0,0,0,0,0,0
.long 0,0,0,0,0,0,0,0
.long 0,0,0,0,0,0,0,0
.long 7849728,13512704,8636160,6801152,1073741832,8257,8273,1
.long 8374016,13512704,8636160,6801152,1073741832,8289,8305,1
.long 14563072,15335424,15087360,13514496,1023410183,0,0,0
.long 15087360,15335424,15087360,13514496,1023410183,0,0,0
.long 0,0,0,0,0,0,0,0
.long 0,0,0,0,0,0,0,0
.long 0,0,0,0,0,0,0,0
.long 0,0,0,0,0,0,0,0
.long 8896512,13512704,8634368,6799360,1073741832,257,273,1
.long 9420800,13512704,8634368,6799360,1073741832,289,305,1
.long 13514752,15335424,15087616,13514752,1023410183,0,0,0
.long 14039040,15335424,15087616,13514752,1023410183,0,0,0
.long 0,0,0,0,0,0,0,0
.long 0,0,0,0,0,0,0,0
.long 0,0,0,0,0,0,0,0
.long 0,0,0,0,0,0,0,0
.long 8896768,13512704,8634624,6799616,1073741832,1409,1425,1
.long 9421056,13512704,8634624,6799616,1073741832,1441,1457,1
.long 13515008,15335424,15087872,13515008,1023410183,0,0,0
.long 14039296,15335424,15087872,13515008,1023410183,0,0,0
.long 0,0,0,0,0,0,0,0
.long 0,0,0,0,0,0,0,0
.long 0,0,0,0,0,0,0,0
.long 0,0,0,0,0,0,0,0
.long 8897024,13512704,8634880,6799872,1073741832,2561,2577,1
.long 9421312,13512704,8634880,6799872,1073741832,2593,2609,1
.long 13515264,15335424,15088128,13515264,1023410183,0,0,0
.long 14039552,15335424,15088128,13515264,1023410183,0,0,0
.long 0,0,0,0,0,0,0,0
.long 0,0,0,0,0,0,0,0
.long 0,0,0,0,0,0,0,0
.long 0,0,0,0,0,0,0,0
.long 8897280,13512704,8635136,6800128,1073741832,3713,3729,1
.long 9421568,13512704,8635136,6800128,1073741832,3745,3761,1
.long 13515520,15335424,15088384,13515520,1023410183,0,0,0
.long 14039808,15335424,15088384,13515520,1023410183,0,0,0
.long 0,0,0,0,0,0,0,0
.long 0,0,0,0,0,0,0,0
.long 0,0,0,0,0,0,0,0
.long 0,0,0,0,0,0,0,0
.long 8897536,13512704,8635392,6800384,1073741832,4865,4881,1
.long 9421824,13512704,8635392,6800384,1073741832,4897,4913,1
.long 13515776,15335424,15088640,13515776,1023410183,0,0,0
.long 14040064,15335424,15088640,13515776,1023410183,0,0,0
.long 0,0,0,0,0,0,0,0
.long 0,0,0,0,0,0,0,0
.long 0,0,0,0,0,0,0,0
.long 0,0,0,0,0,0,0,0
.long 8897792,13512704,8635648,6800640,1073741832,6017,6033,1
.long 9422080,13512704,8635648,6800640,1073741832,6049,6065,1
.long 13516032,15335424,15088896,13516032,1023410183,0,0,0
.long 14040320,15335424,15088896,13516032,1023410183,0,0,0
.long 0,0,0,0,0,0,0,0
.long 0,0,0,0,0,0,0,0
.long 0,0,0,0,0,0,0,0
.long 0,0,0,0,0,0,0,0
.long 8898048,13512704,8635904,6800896,1073741832,7169,7185,1
.long 9422336,13512704,8635904,6800896,1073741832,7201,7217,1
.long 13516288,15335424,15089152,13516288,1023410183,0,0,0
.long 14040576,15335424,15089152,13516288,1023410183,0,0,0
.long 0,0,0,0,0,0,0,0
.long 0,0,0,0,0,0,0,0
.long 0,0,0,0,0,0,0,0
.long 0,0,0,0,0,0,0,0
.long 8898304,13512704,8636160,6801152,1073741832,8321,8337,1
.long 9422592,13512704,8636160,6801152,1073741832,8353,8369,1
.long 13516544,15335424,15089408,13516544,1023410183,0,0,0
.long 14040832,15335424,15089408,13516544,1023410183,0,0,0
.long 0,0,0,0,0,0,0,0
.long 0,0,0,0,0,0,0,0
.long 0,0,0,0,0,0,0,0
.long 0,0,0,0,0,0,0,0
.long 9945088,13512704,8634368,6799360,1073741832,321,337,1
.long 10469376,13512704,8634368,6799360,1073741832,353,369,1
.long 14563328,15335424,15087616,13514752,1023410183,0,0,0
.long 15087616,15335424,15087616,13514752,1023410183,0,0,0
.long 0,0,0,0,0,0,0,0
.long 0,0,0,0,0,0,0,0
.long 0,0,0,0,0,0,0,0
.long 0,0,0,0,0,0,0,0
.long 9945344,13512704,8634624,6799616,1073741832,1473,1489,1
.long 10469632,13512704,8634624,6799616,1073741832,1505,1521,1
.long 14563584,15335424,15087872,13515008,1023410183,0,0,0
.long 15087872,15335424,15087872,13515008,1023410183,0,0,0
.long 0,0,0,0,0,0,0,0
.long 0,0,0,0,0,0,0,0
.long 0,0,0,0,0,0,0,0
.long 0,0,0,0,0,0,0,0
.long 9945600,13512704,8634880,6799872,1073741832,2625,2641,1
.long 10469888,13512704,8634880,6799872,1073741832,2657,2673,1
.long 14563840,15335424,15088128,13515264,1023410183,0,0,0
.long 15088128,15335424,15088128,13515264,1023410183,0,0,0
.long 0,0,0,0,0,0,0,0
.long 0,0,0,0,0,0,0,0
.long 0,0,0,0,0,0,0,0
.long 0,0,0,0,0,0,0,0
.long 9945856,13512704,8635136,6800128,1073741832,3777,3793,1
.long 10470144,13512704,8635136,6800128,1073741832,3809,3825,1
.long 14564096,15335424,15088384,13515520,1023410183,0,0,0
.long 15088384,15335424,15088384,13515520,1023410183,0,0,0
.long 0,0,0,0,0,0,0,0
.long 0,0,0,0,0,0,0,0
.long 0,0,0,0,0,0,0,0
.long 0,0,0,0,0,0,0,0
.long 9946112,13512704,8635392,6800384,1073741832,4929,4945,1
.long 10470400,13512704,8635392,6800384,1073741832,4961,4977,1
.long 14564352,15335424,15088640,13515776,1023410183,0,0,0
.long 15088640,15335424,15088640,13515776,1023410183,0,0,0
.long 0,0,0,0,0,0,0,0
.long 0,0,0,0,0,0,0,0
.long 0,0,0,0,0,0,0,0
.long 0,0,0,0,0,0,0,0
.long 9946368,13512704,8635648,6800640,1073741832,6081,6097,1
.long 10470656,13512704,8635648,6800640,1073741832,6113,6129,1
.long 14564608,15335424,15088896,13516032,1023410183,0,0,0
.long 15088896,15335424,15088896,13516032,1023410183,0,0,0
.long 0,0,0,0,0,0,0,0
.long 0,0,0,0,0,0,0,0
.long 0,0,0,0,0,0,0,0
.long 0,0,0,0,0,0,0,0
.long 9946624,13512704,8635904,6800896,1073741832,7233,7249,1
.long 10470912,13512704,8635904,6800896,1073741832,7265,7281,1
.long 14564864,15335424,15089152,13516288,1023410183,0,0,0
.long 15089152,15335424,15089152,13516288,1023410183,0,0,0
.long 0,0,0,0,0,0,0,0
.long 0,0,0,0,0,0,0,0
.long 0,0,0,0,0,0,0,0
.long 0,0,0,0,0,0,0,0
.long 9946880,13512704,8636160,6801152,1073741832,8385,8401,1
.long 10471168,13512704,8636160,6801152,1073741832,8417,8433,1
.long 14565120,15335424,15089408,13516544,1023410183,0,0,0
.long 15089408,15335424,15089408,13516544,1023410183,0,0,0
.long 0,0,0,0,0,0,0,0
.long 0,0,0,0,0,0,0,0
.long 0,0,0,0,0,0,0,0
.long 0,0,0,0,0,0,0,0
.long 0,3391488,786432,0,1073741828,897,913,1
.long 524288,3391488,786432,0,1073741828,929,945,1
.long 1050624,3391488,3147776,2048,1006632973,0,0,0
.long 1574912,3391488,3147776,2048,1006632973,0,0,0
.long 0,0,0,0,0,0,0,0
.long 0,0,0,0,0,0,0,0
.long 0,0,0,0,0,0,0,0
.long 0,0,0,0,0,0,0,0
.long 256,3391488,786688,256,1073741828,2049,2065,1
.long 524544,3391488,786688,256,1073741828,2081,2097,1
.long 1050880,3391488,3148032,2304,1006632973,0,0,0
.long 1575168,3391488,3148032,2304,1006632973,0,0,0
.long 0,0,0,0,0,0,0,0
.long 0,0,0,0,0,0,0,0
.long 0,0,0,0,0,0,0,0
.long 0,0,0,0,0,0,0,0
.long 512,3391488,786944,512,1073741828,3201,3217,1
.long 524800,3391488,786944,512,1073741828,3233,3249,1
.long 1051136,3391488,3148288,2560,1006632973,0,0,0
.long 1575424,3391488,3148288,2560,1006632973,0,0,0
.long 0,0,0,0,0,0,0,0
.long 0,0,0,0,0,0,0,0
.long 0,0,0,0,0,0,0,0
.long 0,0,0,0,0,0,0,0
.long 768,3391488,787200,768,1073741828,4353,4369,1
.long 525056,3391488,787200,768,1073741828,4385,4401,1
.long 1051392,3391488,3148544,2816,1006632973,0,0,0
.long 1575680,3391488,3148544,2816,1006632973,0,0,0
.long 0,0,0,0,0,0,0,0
.long 0,0,0,0,0,0,0,0
.long 0,0,0,0,0,0,0,0
.long 0,0,0,0,0,0,0,0
.long 1024,3391488,787456,1024,1073741828,5505,5521,1
.long 525312,3391488,787456,1024,1073741828,5537,5553,1
.long 1051648,3391488,3148800,3072,1006632973,0,0,0
.long 1575936,3391488,3148800,3072,1006632973,0,0,0
.long 0,0,0,0,0,0,0,0
.long 0,0,0,0,0,0,0,0
.long 0,0,0,0,0,0,0,0
.long 0,0,0,0,0,0,0,0
.long 1280,3391488,787712,1280,1073741828,6657,6673,1
.long 525568,3391488,787712,1280,1073741828,6689,6705,1
.long 1051904,3391488,3149056,3328,1006632973,0,0,0
.long 1576192,3391488,3149056,3328,1006632973,0,0,0
.long 0,0,0,0,0,0,0,0
.long 0,0,0,0,0,0,0,0
.long 0,0,0,0,0,0,0,0
.long 0,0,0,0,0,0,0,0
.long 1536,3391488,787968,1536,1073741828,7809,7825,1
.long 525824,3391488,787968,1536,1073741828,7841,7857,1
.long 1052160,3391488,3149312,3584,1006632973,0,0,0
.long 1576448,3391488,3149312,3584,1006632973,0,0,0
.long 0,0,0,0,0,0,0,0
.long 0,0,0,0,0,0,0,0
.long 0,0,0,0,0,0,0,0
.long 0,0,0,0,0,0,0,0
.long 1792,3391488,788224,1792,1073741828,8961,8977,1
.long 526080,3391488,788224,1792,1073741828,8993,9009,1
.long 1052416,3391488,3149568,3840,1006632973,0,0,0
.long 1576704,3391488,3149568,3840,1006632973,0,0,0
.long 0,0,0,0,0,0,0,0
.long 0,0,0,0,0,0,0,0
.long 0,0,0,0,0,0,0,0
.long 0,0,0,0,0,0,0,0
.long 1048576,3391488,786432,0,1073741828,961,977,1
.long 1572864,3391488,786432,0,1073741828,993,1009,1
.long 2099200,3391488,3147776,2048,1006632973,0,0,0
.long 2623488,3391488,3147776,2048,1006632973,0,0,0
.long 0,0,0,0,0,0,0,0
.long 0,0,0,0,0,0,0,0
.long 0,0,0,0,0,0,0,0
.long 0,0,0,0,0,0,0,0
.long 1048832,3391488,786688,256,1073741828,2113,2129,1
.long 1573120,3391488,786688,256,1073741828,2145,2161,1
.long 2099456,3391488,3148032,2304,1006632973,0,0,0
.long 2623744,3391488,3148032,2304,1006632973,0,0,0
.long 0,0,0,0,0,0,0,0
.long 0,0,0,0,0,0,0,0
.long 0,0,0,0,0,0,0,0
.long 0,0,0,0,0,0,0,0
.long 1049088,3391488,786944,512,1073741828,3265,3281,1
.long 1573376,3391488,786944,512,1073741828,3297,3313,1
.long 2099712,3391488,3148288,2560,1006632973,0,0,0
.long 2624000,3391488,3148288,2560,1006632973,0,0,0
.long 0,0,0,0,0,0,0,0
.long 0,0,0,0,0,0,0,0
.long 0,0,0,0,0,0,0,0
.long 0,0,0,0,0,0,0,0
.long 1049344,3391488,787200,768,1073741828,4417,4433,1
.long 1573632,3391488,787200,768,1073741828,4449,4465,1
.long 2099968,3391488,3148544,2816,1006632973,0,0,0
.long 2624256,3391488,3148544,2816,1006632973,0,0,0
.long 0,0,0,0,0,0,0,0
.long 0,0,0,0,0,0,0,0
.long 0,0,0,0,0,0,0,0
.long 0,0,0,0,0,0,0,0
.long 1049600,3391488,787456,1024,1073741828,5569,5585,1
.long 1573888,3391488,787456,1024,1073741828,5601,5617,1
.long 2100224,3391488,3148800,3072,1006632973,0,0,0
.long 2624512,3391488,3148800,3072,1006632973,0,0,0
.long 0,0,0,0,0,0,0,0
.long 0,0,0,0,0,0,0,0
.long 0,0,0,0,0,0,0,0
.long 0,0,0,0,0,0,0,0
.long 1049856,3391488,787712,1280,1073741828,6721,6737,1
.long 1574144,3391488,787712,1280,1073741828,6753,6769,1
.long 2100480,3391488,3149056,3328,1006632973,0,0,0
.long 2624768,3391488,3149056,3328,1006632973,0,0,0
.long 0,0,0,0,0,0,0,0
.long 0,0,0,0,0,0,0,0
.long 0,0,0,0,0,0,0,0
.long 0,0,0,0,0,0,0,0
.long 1050112,3391488,787968,1536,1073741828,7873,7889,1
.long 1574400,3391488,787968,1536,1073741828,7905,7921,1
.long 2100736,3391488,3149312,3584,1006632973,0,0,0
.long 2625024,3391488,3149312,3584,1006632973,0,0,0
.long 0,0,0,0,0,0,0,0
.long 0,0,0,0,0,0,0,0
.long 0,0,0,0,0,0,0,0
.long 0,0,0,0,0,0,0,0
.long 1050368,3391488,788224,1792,1073741828,9025,9041,1
.long 1574656,3391488,788224,1792,1073741828,9057,9073,1
.long 2100992,3391488,3149568,3840,1006632973,0,0,0
.long 2625280,3391488,3149568,3840,1006632973,0,0,0
.long 0,0,0,0,0,0,0,0
.long 0,0,0,0,0,0,0,0
.long 0,0,0,0,0,0,0,0
.long 0,0,0,0,0,0,0,0
.long 2097152,3391488,786432,0,1073741828,1025,1041,1
.long 2621440,3391488,786432,0,1073741828,1057,1073,1
.long 4442112,6799360,6539264,3393536,1073741837,0,0,0
.long 4966400,6799360,6539264,3393536,1073741837,0,0,0
.long 0,0,0,0,0,0,0,0
.long 0,0,0,0,0,0,0,0
.long 0,0,0,0,0,0,0,0
.long 0,0,0,0,0,0,0,0
.long 2097408,3391488,786688,256,1073741828,2177,2193,1
.long 2621696,3391488,786688,256,1073741828,2209,2225,1
.long 4442368,6799360,6539520,3393792,1073741837,0,0,0
.long 4966656,6799360,6539520,3393792,1073741837,0,0,0
.long 0,0,0,0,0,0,0,0
.long 0,0,0,0,0,0,0,0
.long 0,0,0,0,0,0,0,0
.long 0,0,0,0,0,0,0,0
.long 2097664,3391488,786944,512,1073741828,3329,3345,1
.long 2621952,3391488,786944,512,1073741828,3361,3377,1
.long 4442624,6799360,6539776,3394048,1073741837,0,0,0
.long 4966912,6799360,6539776,3394048,1073741837,0,0,0
.long 0,0,0,0,0,0,0,0
.long 0,0,0,0,0,0,0,0
.long 0,0,0,0,0,0,0,0
.long 0,0,0,0,0,0,0,0
.long 2097920,3391488,787200,768,1073741828,4481,4497,1
.long 2622208,3391488,787200,768,1073741828,4513,4529,1
.long 4442880,6799360,6540032,3394304,1073741837,0,0,0
.long 4967168,6799360,6540032,3394304,1073741837,0,0,0
.long 0,0,0,0,0,0,0,0
.long 0,0,0,0,0,0,0,0
.long 0,0,0,0,0,0,0,0
.long 0,0,0,0,0,0,0,0
.long 2098176,3391488,787456,1024,1073741828,5633,5649,1
.long 2622464,3391488,787456,1024,1073741828,5665,5681,1
.long 4443136,6799360,6540288,3394560,1073741837,0,0,0
.long 4967424,6799360,6540288,3394560,1073741837,0,0,0
.long 0,0,0,0,0,0,0,0
.long 0,0,0,0,0,0,0,0
.long 0,0,0,0,0,0,0,0
.long 0,0,0,0,0,0,0,0
.long 2098432,3391488,787712,1280,1073741828,6785,6801,1
.long 2622720,3391488,787712,1280,1073741828,6817,6833,1
.long 4443392,6799360,6540544,3394816,1073741837,0,0,0
.long 4967680,6799360,6540544,3394816,1073741837,0,0,0
.long 0,0,0,0,0,0,0,0
.long 0,0,0,0,0,0,0,0
.long 0,0,0,0,0,0,0,0
.long 0,0,0,0,0,0,0,0
.long 2098688,3391488,787968,1536,1073741828,7937,7953,1
.long 2622976,3391488,787968,1536,1073741828,7969,7985,1
.long 4443648,6799360,6540800,3395072,1073741837,0,0,0
.long 4967936,6799360,6540800,3395072,1073741837,0,0,0
.long 0,0,0,0,0,0,0,0
.long 0,0,0,0,0,0,0,0
.long 0,0,0,0,0,0,0,0
.long 0,0,0,0,0,0,0,0
.long 2098944,3391488,788224,1792,1073741828,9089,9105,1
.long 2623232,3391488,788224,1792,1073741828,9121,9137,1
.long 4443904,6799360,6541056,3395328,1073741837,0,0,0
.long 4968192,6799360,6541056,3395328,1073741837,0,0,0
.long 0,0,0,0,0,0,0,0
.long 0,0,0,0,0,0,0,0
.long 0,0,0,0,0,0,0,0
.long 0,0,0,0,0,0,0,0
.long 2048,3391488,788480,2048,1073741828,1089,1105,1
.long 526336,3391488,788480,2048,1073741828,1121,1137,1
.long 5490688,6799360,6539264,3393536,1073741837,0,0,0
.long 6014976,6799360,6539264,3393536,1073741837,0,0,0
.long 0,0,0,0,0,0,0,0
.long 0,0,0,0,0,0,0,0
.long 0,0,0,0,0,0,0,0
.long 0,0,0,0,0,0,0,0
.long 2304,3391488,788736,2304,1073741828,2241,2257,1
.long 526592,3391488,788736,2304,1073741828,2273,2289,1
.long 5490944,6799360,6539520,3393792,1073741837,0,0,0
.long 6015232,6799360,6539520,3393792,1073741837,0,0,0
.long 0,0,0,0,0,0,0,0
.long 0,0,0,0,0,0,0,0
.long 0,0,0,0,0,0,0,0
.long 0,0,0,0,0,0,0,0
.long 2560,3391488,788992,2560,1073741828,3393,3409,1
.long 526848,3391488,788992,2560,1073741828,3425,3441,1
.long 5491200,6799360,6539776,3394048,1073741837,0,0,0
.long 6015488,6799360,6539776,3394048,1073741837,0,0,0
.long 0,0,0,0,0,0,0,0
.long 0,0,0,0,0,0,0,0
.long 0,0,0,0,0,0,0,0
.long 0,0,0,0,0,0,0,0
.long 2816,3391488,789248,2816,1073741828,4545,4561,1
.long 527104,3391488,789248,2816,1073741828,4577,4593,1
.long 5491456,6799360,6540032,3394304,1073741837,0,0,0
.long 6015744,6799360,6540032,3394304,1073741837,0,0,0
.long 0,0,0,0,0,0,0,0
.long 0,0,0,0,0,0,0,0
.long 0,0,0,0,0,0,0,0
.long 0,0,0,0,0,0,0,0
.long 3072,3391488,789504,3072,1073741828,5697,5713,1
.long 527360,3391488,789504,3072,1073741828,5729,5745,1
.long 5491712,6799360,6540288,3394560,1073741837,0,0,0
.long 6016000,6799360,6540288,3394560,1073741837,0,0,0
.long 0,0,0,0,0,0,0,0
.long 0,0,0,0,0,0,0,0
.long 0,0,0,0,0,0,0,0
.long 0,0,0,0,0,0,0,0
.long 3328,3391488,789760,3328,1073741828,6849,6865,1
.long 527616,3391488,789760,3328,1073741828,6881,6897,1
.long 5491968,6799360,6540544,3394816,1073741837,0,0,0
.long 6016256,6799360,6540544,3394816,1073741837,0,0,0
.long 0,0,0,0,0,0,0,0
.long 0,0,0,0,0,0,0,0
.long 0,0,0,0,0,0,0,0
.long 0,0,0,0,0,0,0,0
.long 3584,3391488,790016,3584,1073741828,8001,8017,1
.long 527872,3391488,790016,3584,1073741828,8033,8049,1
.long 5492224,6799360,6540800,3395072,1073741837,0,0,0
.long 6016512,6799360,6540800,3395072,1073741837,0,0,0
.long 0,0,0,0,0,0,0,0
.long 0,0,0,0,0,0,0,0
.long 0,0,0,0,0,0,0,0
.long 0,0,0,0,0,0,0,0
.long 3840,3391488,790272,3840,1073741828,9153,9169,1
.long 528128,3391488,790272,3840,1073741828,9185,9201,1
.long 5492480,6799360,6541056,3395328,1073741837,0,0,0
.long 6016768,6799360,6541056,3395328,1073741837,0,0,0
.long 0,0,0,0,0,0,0,0
.long 0,0,0,0,0,0,0,0
.long 0,0,0,0,0,0,0,0
.long 0,0,0,0,0,0,0,0
.long 8898560,13512704,7849984,6801408,1073741829,641,657,1
.long 9422848,13512704,7849984,6801408,1073741829,673,689,1
.long 3391488,6799360,6537216,3391488,1073741837,0,0,0
.long 3915776,6799360,6537216,3391488,1073741837,0,0,0
.long 0,0,0,0,0,0,0,0
.long 0,0,0,0,0,0,0,0
.long 0,0,0,0,0,0,0,0
.long 0,0,0,0,0,0,0,0
.long 8898816,13512704,7850240,6801664,1073741829,1793,1809,1
.long 9423104,13512704,7850240,6801664,1073741829,1825,1841,1
.long 3391744,6799360,6537472,3391744,1073741837,0,0,0
.long 3916032,6799360,6537472,3391744,1073741837,0,0,0
.long 0,0,0,0,0,0,0,0
.long 0,0,0,0,0,0,0,0
.long 0,0,0,0,0,0,0,0
.long 0,0,0,0,0,0,0,0
.long 8899072,13512704,7850496,6801920,1073741829,2945,2961,1
.long 9423360,13512704,7850496,6801920,1073741829,2977,2993,1
.long 3392000,6799360,6537728,3392000,1073741837,0,0,0
.long 3916288,6799360,6537728,3392000,1073741837,0,0,0
.long 0,0,0,0,0,0,0,0
.long 0,0,0,0,0,0,0,0
.long 0,0,0,0,0,0,0,0
.long 0,0,0,0,0,0,0,0
.long 8899328,13512704,7850752,6802176,1073741829,4097,4113,1
.long 9423616,13512704,7850752,6802176,1073741829,4129,4145,1
.long 3392256,6799360,6537984,3392256,1073741837,0,0,0
.long 3916544,6799360,6537984,3392256,1073741837,0,0,0
.long 0,0,0,0,0,0,0,0
.long 0,0,0,0,0,0,0,0
.long 0,0,0,0,0,0,0,0
.long 0,0,0,0,0,0,0,0
.long 8899584,13512704,7851008,6802432,1073741829,5249,5265,1
.long 9423872,13512704,7851008,6802432,1073741829,5281,5297,1
.long 3392512,6799360,6538240,3392512,1073741837,0,0,0
.long 3916800,6799360,6538240,3392512,1073741837,0,0,0
.long 0,0,0,0,0,0,0,0
.long 0,0,0,0,0,0,0,0
.long 0,0,0,0,0,0,0,0
.long 0,0,0,0,0,0,0,0
.long 8899840,13512704,7851264,6802688,1073741829,6401,6417,1
.long 9424128,13512704,7851264,6802688,1073741829,6433,6449,1
.long 3392768,6799360,6538496,3392768,1073741837,0,0,0
.long 3917056,6799360,6538496,3392768,1073741837,0,0,0
.long 0,0,0,0,0,0,0,0
.long 0,0,0,0,0,0,0,0
.long 0,0,0,0,0,0,0,0
.long 0,0,0,0,0,0,0,0
.long 8900096,13512704,7851520,6802944,1073741829,7553,7569,1
.long 9424384,13512704,7851520,6802944,1073741829,7585,7601,1
.long 3393024,6799360,6538752,3393024,1073741837,0,0,0
.long 3917312,6799360,6538752,3393024,1073741837,0,0,0
.long 0,0,0,0,0,0,0,0
.long 0,0,0,0,0,0,0,0
.long 0,0,0,0,0,0,0,0
.long 0,0,0,0,0,0,0,0
.long 8900352,13512704,7851776,6803200,1073741829,8705,8721,1
.long 9424640,13512704,7851776,6803200,1073741829,8737,8753,1
.long 3393280,6799360,6539008,3393280,1073741837,0,0,0
.long 3917568,6799360,6539008,3393280,1073741837,0,0,0
.long 0,0,0,0,0,0,0,0
.long 0,0,0,0,0,0,0,0
.long 0,0,0,0,0,0,0,0
.long 0,0,0,0,0,0,0,0
.long 9947136,13512704,7849984,6801408,1073741829,705,721,1
.long 10471424,13512704,7849984,6801408,1073741829,737,753,1
.long 4440064,6799360,6537216,3391488,1073741837,0,0,0
.long 4964352,6799360,6537216,3391488,1073741837,0,0,0
.long 0,0,0,0,0,0,0,0
.long 0,0,0,0,0,0,0,0
.long 0,0,0,0,0,0,0,0
.long 0,0,0,0,0,0,0,0
.long 9947392,13512704,7850240,6801664,1073741829,1857,1873,1
.long 10471680,13512704,7850240,6801664,1073741829,1889,1905,1
.long 4440320,6799360,6537472,3391744,1073741837,0,0,0
.long 4964608,6799360,6537472,3391744,1073741837,0,0,0
.long 0,0,0,0,0,0,0,0
.long 0,0,0,0,0,0,0,0
.long 0,0,0,0,0,0,0,0
.long 0,0,0,0,0,0,0,0
.long 9947648,13512704,7850496,6801920,1073741829,3009,3025,1
.long 10471936,13512704,7850496,6801920,1073741829,3041,3057,1
.long 4440576,6799360,6537728,3392000,1073741837,0,0,0
.long 4964864,6799360,6537728,3392000,1073741837,0,0,0
.long 0,0,0,0,0,0,0,0
.long 0,0,0,0,0,0,0,0
.long 0,0,0,0,0,0,0,0
.long 0,0,0,0,0,0,0,0
.long 9947904,13512704,7850752,6802176,1073741829,4161,4177,1
.long 10472192,13512704,7850752,6802176,1073741829,4193,4209,1
.long 4440832,6799360,6537984,3392256,1073741837,0,0,0
.long 4965120,6799360,6537984,3392256,1073741837,0,0,0
.long 0,0,0,0,0,0,0,0
.long 0,0,0,0,0,0,0,0
.long 0,0,0,0,0,0,0,0
.long 0,0,0,0,0,0,0,0
.long 9948160,13512704,7851008,6802432,1073741829,5313,5329,1
.long 10472448,13512704,7851008,6802432,1073741829,5345,5361,1
.long 4441088,6799360,6538240,3392512,1073741837,0,0,0
.long 4965376,6799360,6538240,3392512,1073741837,0,0,0
.long 0,0,0,0,0,0,0,0
.long 0,0,0,0,0,0,0,0
.long 0,0,0,0,0,0,0,0
.long 0,0,0,0,0,0,0,0
.long 9948416,13512704,7851264,6802688,1073741829,6465,6481,1
.long 10472704,13512704,7851264,6802688,1073741829,6497,6513,1
.long 4441344,6799360,6538496,3392768,1073741837,0,0,0
.long 4965632,6799360,6538496,3392768,1073741837,0,0,0
.long 0,0,0,0,0,0,0,0
.long 0,0,0,0,0,0,0,0
.long 0,0,0,0,0,0,0,0
.long 0,0,0,0,0,0,0,0
.long 9948672,13512704,7851520,6802944,1073741829,7617,7633,1
.long 10472960,13512704,7851520,6802944,1073741829,7649,7665,1
.long 4441600,6799360,6538752,3393024,1073741837,0,0,0
.long 4965888,6799360,6538752,3393024,1073741837,0,0,0
.long 0,0,0,0,0,0,0,0
.long 0,0,0,0,0,0,0,0
.long 0,0,0,0,0,0,0,0
.long 0,0,0,0,0,0,0,0
.long 9948928,13512704,7851776,6803200,1073741829,8769,8785,1
.long 10473216,13512704,7851776,6803200,1073741829,8801,8817,1
.long 4441856,6799360,6539008,3393280,1073741837,0,0,0
.long 4966144,6799360,6539008,3393280,1073741837,0,0,0
.long 0,0,0,0,0,0,0,0
.long 0,0,0,0,0,0,0,0
.long 0,0,0,0,0,0,0,0
.long 0,0,0,0,0,0,0,0
.long 10995712,13512704,7849984,6801408,1073741829,769,785,1
.long 11520000,13512704,7849984,6801408,1073741829,801,817,1
.long 5488640,6799360,6537216,3391488,1073741837,0,0,0
.long 6012928,6799360,6537216,3391488,1073741837,0,0,0
.long 0,0,0,0,0,0,0,0
.long 0,0,0,0,0,0,0,0
.long 0,0,0,0,0,0,0,0
.long 0,0,0,0,0,0,0,0
.long 10995968,13512704,7850240,6801664,1073741829,1921,1937,1
.long 11520256,13512704,7850240,6801664,1073741829,1953,1969,1
.long 5488896,6799360,6537472,3391744,1073741837,0,0,0
.long 6013184,6799360,6537472,3391744,1073741837,0,0,0
.long 0,0,0,0,0,0,0,0
.long 0,0,0,0,0,0,0,0
.long 0,0,0,0,0,0,0,0
.long 0,0,0,0,0,0,0,0
.long 10996224,13512704,7850496,6801920,1073741829,3073,3089,1
.long 11520512,13512704,7850496,6801920,1073741829,3105,3121,1
.long 5489152,6799360,6537728,3392000,1073741837,0,0,0
.long 6013440,6799360,6537728,3392000,1073741837,0,0,0
.long 0,0,0,0,0,0,0,0
.long 0,0,0,0,0,0,0,0
.long 0,0,0,0,0,0,0,0
.long 0,0,0,0,0,0,0,0
.long 10996480,13512704,7850752,6802176,1073741829,4225,4241,1
.long 11520768,13512704,7850752,6802176,1073741829,4257,4273,1
.long 5489408,6799360,6537984,3392256,1073741837,0,0,0
.long 6013696,6799360,6537984,3392256,1073741837,0,0,0
.long 0,0,0,0,0,0,0,0
.long 0,0,0,0,0,0,0,0
.long 0,0,0,0,0,0,0,0
.long 0,0,0,0,0,0,0,0
.long 10996736,13512704,7851008,6802432,1073741829,5377,5393,1
.long 11521024,13512704,7851008,6802432,1073741829,5409,5425,1
.long 5489664,6799360,6538240,3392512,1073741837,0,0,0
.long 6013952,6799360,6538240,3392512,1073741837,0,0,0
.long 0,0,0,0,0,0,0,0
.long 0,0,0,0,0,0,0,0
.long 0,0,0,0,0,0,0,0
.long 0,0,0,0,0,0,0,0
.long 10996992,13512704,7851264,6802688,1073741829,6529,6545,1
.long 11521280,13512704,7851264,6802688,1073741829,6561,6577,1
.long 5489920,6799360,6538496,3392768,1073741837,0,0,0
.long 6014208,6799360,6538496,3392768,1073741837,0,0,0
.long 0,0,0,0,0,0,0,0
.long 0,0,0,0,0,0,0,0
.long 0,0,0,0,0,0,0,0
.long 0,0,0,0,0,0,0,0
.long 10997248,13512704,7851520,6802944,1073741829,7681,7697,1
.long 11521536,13512704,7851520,6802944,1073741829,7713,7729,1
.long 5490176,6799360,6538752,3393024,1073741837,0,0,0
.long 6014464,6799360,6538752,3393024,1073741837,0,0,0
.long 0,0,0,0,0,0,0,0
.long 0,0,0,0,0,0,0,0
.long 0,0,0,0,0,0,0,0
.long 0,0,0,0,0,0,0,0
.long 10997504,13512704,7851776,6803200,1073741829,8833,8849,1
.long 11521792,13512704,7851776,6803200,1073741829,8865,8881,1
.long 5490432,6799360,6539008,3393280,1073741837,0,0,0
.long 6014720,6799360,6539008,3393280,1073741837,0,0,0
.long 0,0,0,0,0,0,0,0
.long 0,0,0,0,0,0,0,0
.long 0,0,0,0,0,0,0,0
.long 0,0,0,0,0,0,0,0
.long 12044288,13512704,7849984,6801408,1073741829,833,849,1
.long 12568576,13512704,7849984,6801408,1073741829,865,881,1
.long 3393536,6799360,6539264,3393536,1073741837,0,0,0
.long 3917824,6799360,6539264,3393536,1073741837,0,0,0
.long 0,0,0,0,0,0,0,0
.long 0,0,0,0,0,0,0,0
.long 0,0,0,0,0,0,0,0
.long 0,0,0,0,0,0,0,0
.long 12044544,13512704,7850240,6801664,1073741829,1985,2001,1
.long 12568832,13512704,7850240,6801664,1073741829,2017,2033,1
.long 3393792,6799360,6539520,3393792,1073741837,0,0,0
.long 3918080,6799360,6539520,3393792,1073741837,0,0,0
.long 0,0,0,0,0,0,0,0
.long 0,0,0,0,0,0,0,0
.long 0,0,0,0,0,0,0,0
.long 0,0,0,0,0,0,0,0
.long 12044800,13512704,7850496,6801920,1073741829,3137,3153,1
.long 12569088,13512704,7850496,6801920,1073741829,3169,3185,1
.long 3394048,6799360,6539776,3394048,1073741837,0,0,0
.long 3918336,6799360,6539776,3394048,1073741837,0,0,0
.long 0,0,0,0,0,0,0,0
.long 0,0,0,0,0,0,0,0
.long 0,0,0,0,0,0,0,0
.long 0,0,0,0,0,0,0,0
.long 12045056,13512704,7850752,6802176,1073741829,4289,4305,1
.long 12569344,13512704,7850752,6802176,1073741829,4321,4337,1
.long 3394304,6799360,6540032,3394304,1073741837,0,0,0
.long 3918592,6799360,6540032,3394304,1073741837,0,0,0
.long 0,0,0,0,0,0,0,0
.long 0,0,0,0,0,0,0,0
.long 0,0,0,0,0,0,0,0
.long 0,0,0,0,0,0,0,0
.long 12045312,13512704,7851008,6802432,1073741829,5441,5457,1
.long 12569600,13512704,7851008,6802432,1073741829,5473,5489,1
.long 3394560,6799360,6540288,3394560,1073741837,0,0,0
.long 3918848,6799360,6540288,3394560,1073741837,0,0,0
.long 0,0,0,0,0,0,0,0
.long 0,0,0,0,0,0,0,0
.long 0,0,0,0,0,0,0,0
.long 0,0,0,0,0,0,0,0
.long 12045568,13512704,7851264,6802688,1073741829,6593,6609,1
.long 12569856,13512704,7851264,6802688,1073741829,6625,6641,1
.long 3394816,6799360,6540544,3394816,1073741837,0,0,0
.long 3919104,6799360,6540544,3394816,1073741837,0,0,0
.long 0,0,0,0,0,0,0,0
.long 0,0,0,0,0,0,0,0
.long 0,0,0,0,0,0,0,0
.long 0,0,0,0,0,0,0,0
.long 12045824,13512704,7851520,6802944,1073741829,7745,7761,1
.long 12570112,13512704,7851520,6802944,1073741829,7777,7793,1
.long 3395072,6799360,6540800,3395072,1073741837,0,0,0
.long 3919360,6799360,6540800,3395072,1073741837,0,0,0
.long 0,0,0,0,0,0,0,0
.long 0,0,0,0,0,0,0,0
.long 0,0,0,0,0,0,0,0
.long 0,0,0,0,0,0,0,0
.long 12046080,13512704,7851776,6803200,1073741829,8897,8913,1
.long 12570368,13512704,7851776,6803200,1073741829,8929,8945,1
.long 3395328,6799360,6541056,3395328,1073741837,0,0,0
.long 3919616,6799360,6541056,3395328,1073741837,0,0,0
.long 0,0,0,0,0,0,0,0
.long 0,0,0,0,0,0,0,0
.long 0,0,0,0,0,0,0,0
.long 0,0,0,0,0,0,0,0
.long 13090816,13512704,13352960,10207232,654311693,2,18,0
.long 6537216,6799360,6537216,3391488,1073742093,0,0,0
.long 0,0,0,0,0,0,0,0
.long 0,0,0,0,0,0,0,0
.long 0,0,0,0,0,0,0,0
.long 0,0,0,0,0,0,0,0
.long 0,0,0,0,0,0,0,0
.long 0,0,0,0,0,0,0,0
.long 13091072,13512704,13353216,10207488,654311693,1154,1170,0
.long 6537472,6799360,6537472,3391744,1073742093,0,0,0
.long 0,0,0,0,0,0,0,0
.long 0,0,0,0,0,0,0,0
.long 0,0,0,0,0,0,0,0
.long 0,0,0,0,0,0,0,0
.long 0,0,0,0,0,0,0,0
.long 0,0,0,0,0,0,0,0
.long 13091328,13512704,13353472,10207744,654311693,2306,2322,0
.long 6537728,6799360,6537728,3392000,1073742093,0,0,0
.long 0,0,0,0,0,0,0,0
.long 0,0,0,0,0,0,0,0
.long 0,0,0,0,0,0,0,0
.long 0,0,0,0,0,0,0,0
.long 0,0,0,0,0,0,0,0
.long 0,0,0,0,0,0,0,0
.long 13091584,13512704,13353728,10208000,654311693,3458,3474,0
.long 6537984,6799360,6537984,3392256,1073742093,0,0,0
.long 0,0,0,0,0,0,0,0
.long 0,0,0,0,0,0,0,0
.long 0,0,0,0,0,0,0,0
.long 0,0,0,0,0,0,0,0
.long 0,0,0,0,0,0,0,0
.long 0,0,0,0,0,0,0,0
.long 13091840,13512704,13353984,10208256,654311693,4610,4626,0
.long 6538240,6799360,6538240,3392512,1073742093,0,0,0
.long 0,0,0,0,0,0,0,0
.long 0,0,0,0,0,0,0,0
.long 0,0,0,0,0,0,0,0
.long 0,0,0,0,0,0,0,0
.long 0,0,0,0,0,0,0,0
.long 0,0,0,0,0,0,0,0
.long 13092096,13512704,13354240,10208512,654311693,5762,5778,0
.long 6538496,6799360,6538496,3392768,1073742093,0,0,0
.long 0,0,0,0,0,0,0,0
.long 0,0,0,0,0,0,0,0
.long 0,0,0,0,0,0,0,0
.long 0,0,0,0,0,0,0,0
.long 0,0,0,0,0,0,0,0
.long 0,0,0,0,0,0,0,0
.long 13092352,13512704,13354496,10208768,654311693,6914,6930,0
.long 6538752,6799360,6538752,3393024,1073742093,0,0,0
.long 0,0,0,0,0,0,0,0
.long 0,0,0,0,0,0,0,0
.long 0,0,0,0,0,0,0,0
.long 0,0,0,0,0,0,0,0
.long 0,0,0,0,0,0,0,0
.long 0,0,0,0,0,0,0,0
.long 13092608,13512704,13354752,10209024,654311693,8066,8082,0
.long 6539008,6799360,6539008,3393280,1073742093,0,0,0
.long 0,0,0,0,0,0,0,0
.long 0,0,0,0,0,0,0,0
.long 0,0,0,0,0,0,0,0
.long 0,0,0,0,0,0,0,0
.long 0,0,0,0,0,0,0,0
.long 0,0,0,0,0,0,0,0
.long 13092864,13512704,13355008,10209280,654311693,66,82,0
.long 6539264,6799360,6539264,3393536,1073742093,0,0,0
.long 0,0,0,0,0,0,0,0
.long 0,0,0,0,0,0,0,0
.long 0,0,0,0,0,0,0,0
.long 0,0,0,0,0,0,0,0
.long 0,0,0,0,0,0,0,0
.long 0,0,0,0,0,0,0,0
.long 13093120,13512704,13355264,10209536,654311693,1218,1234,0
.long 6539520,6799360,6539520,3393792,1073742093,0,0,0
.long 0,0,0,0,0,0,0,0
.long 0,0,0,0,0,0,0,0
.long 0,0,0,0,0,0,0,0
.long 0,0,0,0,0,0,0,0
.long 0,0,0,0,0,0,0,0
.long 0,0,0,0,0,0,0,0
.long 13093376,13512704,13355520,10209792,654311693,2370,2386,0
.long 6539776,6799360,6539776,3394048,1073742093,0,0,0
.long 0,0,0,0,0,0,0,0
.long 0,0,0,0,0,0,0,0
.long 0,0,0,0,0,0,0,0
.long 0,0,0,0,0,0,0,0
.long 0,0,0,0,0,0,0,0
.long 0,0,0,0,0,0,0,0
.long 13093632,13512704,13355776,10210048,654311693,3522,3538,0
.long 6540032,6799360,6540032,3394304,1073742093,0,0,0
.long 0,0,0,0,0,0,0,0
.long 0,0,0,0,0,0,0,0
.long 0,0,0,0,0,0,0,0
.long 0,0,0,0,0,0,0,0
.long 0,0,0,0,0,0,0,0
.long 0,0,0,0,0,0,0,0
.long 13093888,13512704,13356032,10210304,654311693,4674,4690,0
.long 6540288,6799360,6540288,3394560,1073742093,0,0,0
.long 0,0,0,0,0,0,0,0
.long 0,0,0,0,0,0,0,0
.long 0,0,0,0,0,0,0,0
.long 0,0,0,0,0,0,0,0
.long 0,0,0,0,0,0,0,0
.long 0,0,0,0,0,0,0,0
.long 13094144,13512704,13356288,10210560,654311693,5826,5842,0
.long 6540544,6799360,6540544,3394816,1073742093,0,0,0
.long 0,0,0,0,0,0,0,0
.long 0,0,0,0,0,0,0,0
.long 0,0,0,0,0,0,0,0
.long 0,0,0,0,0,0,0,0
.long 0,0,0,0,0,0,0,0
.long 0,0,0,0,0,0,0,0
.long 13094400,13512704,13356544,10210816,654311693,6978,6994,0
.long 6540800,6799360,6540800,3395072,1073742093,0,0,0
.long 0,0,0,0,0,0,0,0
.long 0,0,0,0,0,0,0,0
.long 0,0,0,0,0,0,0,0
.long 0,0,0,0,0,0,0,0
.long 0,0,0,0,0,0,0,0
.long 0,0,0,0,0,0,0,0
.long 13094656,13512704,13356800,10211072,654311693,8130,8146,0
.long 6541056,6799360,6541056,3395328,1073742093,0,0,0
.long 0,0,0,0,0,0,0,0
.long 0,0,0,0,0,0,0,0
.long 0,0,0,0,0,0,0,0
.long 0,0,0,0,0,0,0,0
.long 0,0,0,0,0,0,0,0
.long 0,0,0,0,0,0,0,0
.long 6799360,13512704,13352960,8896512,654311442,130,146,0
.long 7323648,13512704,13352960,8896512,654311442,162,178,0
.long 0,0,0,0,0,0,0,0
.long 0,0,0,0,0,0,0,0
.long 0,0,0,0,0,0,0,0
.long 0,0,0,0,0,0,0,0
.long 0,0,0,0,0,0,0,0
.long 0,0,0,0,0,0,0,0
.long 6799616,13512704,13353216,8896768,654311442,1282,1298,0
.long 7323904,13512704,13353216,8896768,654311442,1314,1330,0
.long 0,0,0,0,0,0,0,0
.long 0,0,0,0,0,0,0,0
.long 0,0,0,0,0,0,0,0
.long 0,0,0,0,0,0,0,0
.long 0,0,0,0,0,0,0,0
.long 0,0,0,0,0,0,0,0
.long 6799872,13512704,13353472,8897024,654311442,2434,2450,0
.long 7324160,13512704,13353472,8897024,654311442,2466,2482,0
.long 0,0,0,0,0,0,0,0
.long 0,0,0,0,0,0,0,0
.long 0,0,0,0,0,0,0,0
.long 0,0,0,0,0,0,0,0
.long 0,0,0,0,0,0,0,0
.long 0,0,0,0,0,0,0,0
.long 6800128,13512704,13353728,8897280,654311442,3586,3602,0
.long 7324416,13512704,13353728,8897280,654311442,3618,3634,0
.long 0,0,0,0,0,0,0,0
.long 0,0,0,0,0,0,0,0
.long 0,0,0,0,0,0,0,0
.long 0,0,0,0,0,0,0,0
.long 0,0,0,0,0,0,0,0
.long 0,0,0,0,0,0,0,0
.long 6800384,13512704,13353984,8897536,654311442,4738,4754,0
.long 7324672,13512704,13353984,8897536,654311442,4770,4786,0
.long 0,0,0,0,0,0,0,0
.long 0,0,0,0,0,0,0,0
.long 0,0,0,0,0,0,0,0
.long 0,0,0,0,0,0,0,0
.long 0,0,0,0,0,0,0,0
.long 0,0,0,0,0,0,0,0
.long 6800640,13512704,13354240,8897792,654311442,5890,5906,0
.long 7324928,13512704,13354240,8897792,654311442,5922,5938,0
.long 0,0,0,0,0,0,0,0
.long 0,0,0,0,0,0,0,0
.long 0,0,0,0,0,0,0,0
.long 0,0,0,0,0,0,0,0
.long 0,0,0,0,0,0,0,0
.long 0,0,0,0,0,0,0,0
.long 6800896,13512704,13354496,8898048,654311442,7042,7058,0
.long 7325184,13512704,13354496,8898048,654311442,7074,7090,0
.long 0,0,0,0,0,0,0,0
.long 0,0,0,0,0,0,0,0
.long 0,0,0,0,0,0,0,0
.long 0,0,0,0,0,0,0,0
.long 0,0,0,0,0,0,0,0
.long 0,0,0,0,0,0,0,0
.long 6801152,13512704,13354752,8898304,654311442,8194,8210,0
.long 7325440,13512704,13354752,8898304,654311442,8226,8242,0
.long 0,0,0,0,0,0,0,0
.long 0,0,0,0,0,0,0,0
.long 0,0,0,0,0,0,0,0
.long 0,0,0,0,0,0,0,0
.long 0,0,0,0,0,0,0,0
.long 0,0,0,0,0,0,0,0
.long 7847936,13512704,13352960,8896512,654311442,194,210,0
.long 8372224,13512704,13352960,8896512,654311442,226,242,0
.long 0,0,0,0,0,0,0,0
.long 0,0,0,0,0,0,0,0
.long 0,0,0,0,0,0,0,0
.long 0,0,0,0,0,0,0,0
.long 0,0,0,0,0,0,0,0
.long 0,0,0,0,0,0,0,0
.long 7848192,13512704,13353216,8896768,654311442,1346,1362,0
.long 8372480,13512704,13353216,8896768,654311442,1378,1394,0
.long 0,0,0,0,0,0,0,0
.long 0,0,0,0,0,0,0,0
.long 0,0,0,0,0,0,0,0
.long 0,0,0,0,0,0,0,0
.long 0,0,0,0,0,0,0,0
.long 0,0,0,0,0,0,0,0
.long 7848448,13512704,13353472,8897024,654311442,2498,2514,0
.long 8372736,13512704,13353472,8897024,654311442,2530,2546,0
.long 0,0,0,0,0,0,0,0
.long 0,0,0,0,0,0,0,0
.long 0,0,0,0,0,0,0,0
.long 0,0,0,0,0,0,0,0
.long 0,0,0,0,0,0,0,0
.long 0,0,0,0,0,0,0,0
.long 7848704,13512704,13353728,8897280,654311442,3650,3666,0
.long 8372992,13512704,13353728,8897280,654311442,3682,3698,0
.long 0,0,0,0,0,0,0,0
.long 0,0,0,0,0,0,0,0
.long 0,0,0,0,0,0,0,0
.long 0,0,0,0,0,0,0,0
.long 0,0,0,0,0,0,0,0
.long 0,0,0,0,0,0,0,0
.long 7848960,13512704,13353984,8897536,654311442,4802,4818,0
.long 8373248,13512704,13353984,8897536,654311442,4834,4850,0
.long 0,0,0,0,0,0,0,0
.long 0,0,0,0,0,0,0,0
.long 0,0,0,0,0,0,0,0
.long 0,0,0,0,0,0,0,0
.long 0,0,0,0,0,0,0,0
.long 0,0,0,0,0,0,0,0
.long 7849216,13512704,13354240,8897792,654311442,5954,5970,0
.long 8373504,13512704,13354240,8897792,654311442,5986,6002,0
.long 0,0,0,0,0,0,0,0
.long 0,0,0,0,0,0,0,0
.long 0,0,0,0,0,0,0,0
.long 0,0,0,0,0,0,0,0
.long 0,0,0,0,0,0,0,0
.long 0,0,0,0,0,0,0,0
.long 7849472,13512704,13354496,8898048,654311442,7106,7122,0
.long 8373760,13512704,13354496,8898048,654311442,7138,7154,0
.long 0,0,0,0,0,0,0,0
.long 0,0,0,0,0,0,0,0
.long 0,0,0,0,0,0,0,0
.long 0,0,0,0,0,0,0,0
.long 0,0,0,0,0,0,0,0
.long 0,0,0,0,0,0,0,0
.long 7849728,13512704,13354752,8898304,654311442,8258,8274,0
.long 8374016,13512704,13354752,8898304,654311442,8290,8306,0
.long 0,0,0,0,0,0,0,0
.long 0,0,0,0,0,0,0,0
.long 0,0,0,0,0,0,0,0
.long 0,0,0,0,0,0,0,0
.long 0,0,0,0,0,0,0,0
.long 0,0,0,0,0,0,0,0
.long 8896512,13512704,13352960,8896512,654311442,258,274,0
.long 9420800,13512704,13352960,8896512,654311442,290,306,0
.long 0,0,0,0,0,0,0,0
.long 0,0,0,0,0,0,0,0
.long 0,0,0,0,0,0,0,0
.long 0,0,0,0,0,0,0,0
.long 0,0,0,0,0,0,0,0
.long 0,0,0,0,0,0,0,0
.long 8896768,13512704,13353216,8896768,654311442,1410,1426,0
.long 9421056,13512704,13353216,8896768,654311442,1442,1458,0
.long 0,0,0,0,0,0,0,0
.long 0,0,0,0,0,0,0,0
.long 0,0,0,0,0,0,0,0
.long 0,0,0,0,0,0,0,0
.long 0,0,0,0,0,0,0,0
.long 0,0,0,0,0,0,0,0
.long 8897024,13512704,13353472,8897024,654311442,2562,2578,0
.long 9421312,13512704,13353472,8897024,654311442,2594,2610,0
.long 0,0,0,0,0,0,0,0
.long 0,0,0,0,0,0,0,0
.long 0,0,0,0,0,0,0,0
.long 0,0,0,0,0,0,0,0
.long 0,0,0,0,0,0,0,0
.long 0,0,0,0,0,0,0,0
.long 8897280,13512704,13353728,8897280,654311442,3714,3730,0
.long 9421568,13512704,13353728,8897280,654311442,3746,3762,0
.long 0,0,0,0,0,0,0,0
.long 0,0,0,0,0,0,0,0
.long 0,0,0,0,0,0,0,0
.long 0,0,0,0,0,0,0,0
.long 0,0,0,0,0,0,0,0
.long 0,0,0,0,0,0,0,0
.long 8897536,13512704,13353984,8897536,654311442,4866,4882,0
.long 9421824,13512704,13353984,8897536,654311442,4898,4914,0
.long 0,0,0,0,0,0,0,0
.long 0,0,0,0,0,0,0,0
.long 0,0,0,0,0,0,0,0
.long 0,0,0,0,0,0,0,0
.long 0,0,0,0,0,0,0,0
.long 0,0,0,0,0,0,0,0
.long 8897792,13512704,13354240,8897792,654311442,6018,6034,0
.long 9422080,13512704,13354240,8897792,654311442,6050,6066,0
.long 0,0,0,0,0,0,0,0
.long 0,0,0,0,0,0,0,0
.long 0,0,0,0,0,0,0,0
.long 0,0,0,0,0,0,0,0
.long 0,0,0,0,0,0,0,0
.long 0,0,0,0,0,0,0,0
.long 8898048,13512704,13354496,8898048,654311442,7170,7186,0
.long 9422336,13512704,13354496,8898048,654311442,7202,7218,0
.long 0,0,0,0,0,0,0,0
.long 0,0,0,0,0,0,0,0
.long 0,0,0,0,0,0,0,0
.long 0,0,0,0,0,0,0,0
.long 0,0,0,0,0,0,0,0
.long 0,0,0,0,0,0,0,0
.long 8898304,13512704,13354752,8898304,654311442,8322,8338,0
.long 9422592,13512704,13354752,8898304,654311442,8354,8370,0
.long 0,0,0,0,0,0,0,0
.long 0,0,0,0,0,0,0,0
.long 0,0,0,0,0,0,0,0
.long 0,0,0,0,0,0,0,0
.long 0,0,0,0,0,0,0,0
.long 0,0,0,0,0,0,0,0
.long 9945088,13512704,13352960,8896512,654311442,322,338,0
.long 10469376,13512704,13352960,8896512,654311442,354,370,0
.long 0,0,0,0,0,0,0,0
.long 0,0,0,0,0,0,0,0
.long 0,0,0,0,0,0,0,0
.long 0,0,0,0,0,0,0,0
.long 0,0,0,0,0,0,0,0
.long 0,0,0,0,0,0,0,0
.long 9945344,13512704,13353216,8896768,654311442,1474,1490,0
.long 10469632,13512704,13353216,8896768,654311442,1506,1522,0
.long 0,0,0,0,0,0,0,0
.long 0,0,0,0,0,0,0,0
.long 0,0,0,0,0,0,0,0
.long 0,0,0,0,0,0,0,0
.long 0,0,0,0,0,0,0,0
.long 0,0,0,0,0,0,0,0
.long 9945600,13512704,13353472,8897024,654311442,2626,2642,0
.long 10469888,13512704,13353472,8897024,654311442,2658,2674,0
.long 0,0,0,0,0,0,0,0
.long 0,0,0,0,0,0,0,0
.long 0,0,0,0,0,0,0,0
.long 0,0,0,0,0,0,0,0
.long 0,0,0,0,0,0,0,0
.long 0,0,0,0,0,0,0,0
.long 9945856,13512704,13353728,8897280,654311442,3778,3794,0
.long 10470144,13512704,13353728,8897280,654311442,3810,3826,0
.long 0,0,0,0,0,0,0,0
.long 0,0,0,0,0,0,0,0
.long 0,0,0,0,0,0,0,0
.long 0,0,0,0,0,0,0,0
.long 0,0,0,0,0,0,0,0
.long 0,0,0,0,0,0,0,0
.long 9946112,13512704,13353984,8897536,654311442,4930,4946,0
.long 10470400,13512704,13353984,8897536,654311442,4962,4978,0
.long 0,0,0,0,0,0,0,0
.long 0,0,0,0,0,0,0,0
.long 0,0,0,0,0,0,0,0
.long 0,0,0,0,0,0,0,0
.long 0,0,0,0,0,0,0,0
.long 0,0,0,0,0,0,0,0
.long 9946368,13512704,13354240,8897792,654311442,6082,6098,0
.long 10470656,13512704,13354240,8897792,654311442,6114,6130,0
.long 0,0,0,0,0,0,0,0
.long 0,0,0,0,0,0,0,0
.long 0,0,0,0,0,0,0,0
.long 0,0,0,0,0,0,0,0
.long 0,0,0,0,0,0,0,0
.long 0,0,0,0,0,0,0,0
.long 9946624,13512704,13354496,8898048,654311442,7234,7250,0
.long 10470912,13512704,13354496,8898048,654311442,7266,7282,0
.long 0,0,0,0,0,0,0,0
.long 0,0,0,0,0,0,0,0
.long 0,0,0,0,0,0,0,0
.long 0,0,0,0,0,0,0,0
.long 0,0,0,0,0,0,0,0
.long 0,0,0,0,0,0,0,0
.long 9946880,13512704,13354752,8898304,654311442,8386,8402,0
.long 10471168,13512704,13354752,8898304,654311442,8418,8434,0
.long 0,0,0,0,0,0,0,0
.long 0,0,0,0,0,0,0,0
.long 0,0,0,0,0,0,0,0
.long 0,0,0,0,0,0,0,0
.long 0,0,0,0,0,0,0,0
.long 0,0,0,0,0,0,0,0
.long 10993664,13512704,8372224,6799360,1073741831,385,401,1
.long 11517952,13512704,8372224,6799360,1073741831,417,433,1
.long 0,3391488,3145728,1048576,1006632969,898,914,0
.long 524288,3391488,3145728,1048576,1006632969,930,946,0
.long 0,0,0,0,0,0,0,0
.long 0,0,0,0,0,0,0,0
.long 0,0,0,0,0,0,0,0
.long 0,0,0,0,0,0,0,0
.long 10993920,13512704,8372480,6799616,1073741831,1537,1553,1
.long 11518208,13512704,8372480,6799616,1073741831,1569,1585,1
.long 256,3391488,3145984,1048832,1006632969,2050,2066,0
.long 524544,3391488,3145984,1048832,1006632969,2082,2098,0
.long 0,0,0,0,0,0,0,0
.long 0,0,0,0,0,0,0,0
.long 0,0,0,0,0,0,0,0
.long 0,0,0,0,0,0,0,0
.long 10994176,13512704,8372736,6799872,1073741831,2689,2705,1
.long 11518464,13512704,8372736,6799872,1073741831,2721,2737,1
.long 512,3391488,3146240,1049088,1006632969,3202,3218,0
.long 524800,3391488,3146240,1049088,1006632969,3234,3250,0
.long 0,0,0,0,0,0,0,0
.long 0,0,0,0,0,0,0,0
.long 0,0,0,0,0,0,0,0
.long 0,0,0,0,0,0,0,0
.long 10994432,13512704,8372992,6800128,1073741831,3841,3857,1
.long 11518720,13512704,8372992,6800128,1073741831,3873,3889,1
.long 768,3391488,3146496,1049344,1006632969,4354,4370,0
.long 525056,3391488,3146496,1049344,1006632969,4386,4402,0
.long 0,0,0,0,0,0,0,0
.long 0,0,0,0,0,0,0,0
.long 0,0,0,0,0,0,0,0
.long 0,0,0,0,0,0,0,0
.long 10994688,13512704,8373248,6800384,1073741831,4993,5009,1
.long 11518976,13512704,8373248,6800384,1073741831,5025,5041,1
.long 1024,3391488,3146752,1049600,1006632969,5506,5522,0
.long 525312,3391488,3146752,1049600,1006632969,5538,5554,0
.long 0,0,0,0,0,0,0,0
.long 0,0,0,0,0,0,0,0
.long 0,0,0,0,0,0,0,0
.long 0,0,0,0,0,0,0,0
.long 10994944,13512704,8373504,6800640,1073741831,6145,6161,1
.long 11519232,13512704,8373504,6800640,1073741831,6177,6193,1
.long 1280,3391488,3147008,1049856,1006632969,6658,6674,0
.long 525568,3391488,3147008,1049856,1006632969,6690,6706,0
.long 0,0,0,0,0,0,0,0
.long 0,0,0,0,0,0,0,0
.long 0,0,0,0,0,0,0,0
.long 0,0,0,0,0,0,0,0
.long 10995200,13512704,8373760,6800896,1073741831,7297,7313,1
.long 11519488,13512704,8373760,6800896,1073741831,7329,7345,1
.long 1536,3391488,3147264,1050112,1006632969,7810,7826,0
.long 525824,3391488,3147264,1050112,1006632969,7842,7858,0
.long 0,0,0,0,0,0,0,0
.long 0,0,0,0,0,0,0,0
.long 0,0,0,0,0,0,0,0
.long 0,0,0,0,0,0,0,0
.long 10995456,13512704,8374016,6801152,1073741831,8449,8465,1
.long 11519744,13512704,8374016,6801152,1073741831,8481,8497,1
.long 1792,3391488,3147520,1050368,1006632969,8962,8978,0
.long 526080,3391488,3147520,1050368,1006632969,8994,9010,0
.long 0,0,0,0,0,0,0,0
.long 0,0,0,0,0,0,0,0
.long 0,0,0,0,0,0,0,0
.long 0,0,0,0,0,0,0,0
.long 12042240,13512704,8372224,6799360,1073741831,449,465,1
.long 12566528,13512704,8372224,6799360,1073741831,481,497,1
.long 1048576,3391488,3145728,1048576,1006632969,962,978,0
.long 1572864,3391488,3145728,1048576,1006632969,994,1010,0
.long 0,0,0,0,0,0,0,0
.long 0,0,0,0,0,0,0,0
.long 0,0,0,0,0,0,0,0
.long 0,0,0,0,0,0,0,0
.long 12042496,13512704,8372480,6799616,1073741831,1601,1617,1
.long 12566784,13512704,8372480,6799616,1073741831,1633,1649,1
.long 1048832,3391488,3145984,1048832,1006632969,2114,2130,0
.long 1573120,3391488,3145984,1048832,1006632969,2146,2162,0
.long 0,0,0,0,0,0,0,0
.long 0,0,0,0,0,0,0,0
.long 0,0,0,0,0,0,0,0
.long 0,0,0,0,0,0,0,0
.long 12042752,13512704,8372736,6799872,1073741831,2753,2769,1
.long 12567040,13512704,8372736,6799872,1073741831,2785,2801,1
.long 1049088,3391488,3146240,1049088,1006632969,3266,3282,0
.long 1573376,3391488,3146240,1049088,1006632969,3298,3314,0
.long 0,0,0,0,0,0,0,0
.long 0,0,0,0,0,0,0,0
.long 0,0,0,0,0,0,0,0
.long 0,0,0,0,0,0,0,0
.long 12043008,13512704,8372992,6800128,1073741831,3905,3921,1
.long 12567296,13512704,8372992,6800128,1073741831,3937,3953,1
.long 1049344,3391488,3146496,1049344,1006632969,4418,4434,0
.long 1573632,3391488,3146496,1049344,1006632969,4450,4466,0
.long 0,0,0,0,0,0,0,0
.long 0,0,0,0,0,0,0,0
.long 0,0,0,0,0,0,0,0
.long 0,0,0,0,0,0,0,0
.long 12043264,13512704,8373248,6800384,1073741831,5057,5073,1
.long 12567552,13512704,8373248,6800384,1073741831,5089,5105,1
.long 1049600,3391488,3146752,1049600,1006632969,5570,5586,0
.long 1573888,3391488,3146752,1049600,1006632969,5602,5618,0
.long 0,0,0,0,0,0,0,0
.long 0,0,0,0,0,0,0,0
.long 0,0,0,0,0,0,0,0
.long 0,0,0,0,0,0,0,0
.long 12043520,13512704,8373504,6800640,1073741831,6209,6225,1
.long 12567808,13512704,8373504,6800640,1073741831,6241,6257,1
.long 1049856,3391488,3147008,1049856,1006632969,6722,6738,0
.long 1574144,3391488,3147008,1049856,1006632969,6754,6770,0
.long 0,0,0,0,0,0,0,0
.long 0,0,0,0,0,0,0,0
.long 0,0,0,0,0,0,0,0
.long 0,0,0,0,0,0,0,0
.long 12043776,13512704,8373760,6800896,1073741831,7361,7377,1
.long 12568064,13512704,8373760,6800896,1073741831,7393,7409,1
.long 1050112,3391488,3147264,1050112,1006632969,7874,7890,0
.long 1574400,3391488,3147264,1050112,1006632969,7906,7922,0
.long 0,0,0,0,0,0,0,0
.long 0,0,0,0,0,0,0,0
.long 0,0,0,0,0,0,0,0
.long 0,0,0,0,0,0,0,0
.long 12044032,13512704,8374016,6801152,1073741831,8513,8529,1
.long 12568320,13512704,8374016,6801152,1073741831,8545,8561,1
.long 1050368,3391488,3147520,1050368,1006632969,9026,9042,0
.long 1574656,3391488,3147520,1050368,1006632969,9058,9074,0
.long 0,0,0,0,0,0,0,0
.long 0,0,0,0,0,0,0,0
.long 0,0,0,0,0,0,0,0
.long 0,0,0,0,0,0,0,0
.long 6801408,13512704,8374272,6801408,1073741831,513,529,1
.long 7325696,13512704,8374272,6801408,1073741831,545,561,1
.long 2097152,3391488,3145728,1048576,1006632969,1026,1042,0
.long 2621440,3391488,3145728,1048576,1006632969,1058,1074,0
.long 0,0,0,0,0,0,0,0
.long 0,0,0,0,0,0,0,0
.long 0,0,0,0,0,0,0,0
.long 0,0,0,0,0,0,0,0
.long 6801664,13512704,8374528,6801664,1073741831,1665,1681,1
.long 7325952,13512704,8374528,6801664,1073741831,1697,1713,1
.long 2097408,3391488,3145984,1048832,1006632969,2178,2194,0
.long 2621696,3391488,3145984,1048832,1006632969,2210,2226,0
.long 0,0,0,0,0,0,0,0
.long 0,0,0,0,0,0,0,0
.long 0,0,0,0,0,0,0,0
.long 0,0,0,0,0,0,0,0
.long 6801920,13512704,8374784,6801920,1073741831,2817,2833,1
.long 7326208,13512704,8374784,6801920,1073741831,2849,2865,1
.long 2097664,3391488,3146240,1049088,1006632969,3330,3346,0
.long 2621952,3391488,3146240,1049088,1006632969,3362,3378,0
.long 0,0,0,0,0,0,0,0
.long 0,0,0,0,0,0,0,0
.long 0,0,0,0,0,0,0,0
.long 0,0,0,0,0,0,0,0
.long 6802176,13512704,8375040,6802176,1073741831,3969,3985,1
.long 7326464,13512704,8375040,6802176,1073741831,4001,4017,1
.long 2097920,3391488,3146496,1049344,1006632969,4482,4498,0
.long 2622208,3391488,3146496,1049344,1006632969,4514,4530,0
.long 0,0,0,0,0,0,0,0
.long 0,0,0,0,0,0,0,0
.long 0,0,0,0,0,0,0,0
.long 0,0,0,0,0,0,0,0
.long 6802432,13512704,8375296,6802432,1073741831,5121,5137,1
.long 7326720,13512704,8375296,6802432,1073741831,5153,5169,1
.long 2098176,3391488,3146752,1049600,1006632969,5634,5650,0
.long 2622464,3391488,3146752,1049600,1006632969,5666,5682,0
.long 0,0,0,0,0,0,0,0
.long 0,0,0,0,0,0,0,0
.long 0,0,0,0,0,0,0,0
.long 0,0,0,0,0,0,0,0
.long 6802688,13512704,8375552,6802688,1073741831,6273,6289,1
.long 7326976,13512704,8375552,6802688,1073741831,6305,6321,1
.long 2098432,3391488,3147008,1049856,1006632969,6786,6802,0
.long 2622720,3391488,3147008,1049856,1006632969,6818,6834,0
.long 0,0,0,0,0,0,0,0
.long 0,0,0,0,0,0,0,0
.long 0,0,0,0,0,0,0,0
.long 0,0,0,0,0,0,0,0
.long 6802944,13512704,8375808,6802944,1073741831,7425,7441,1
.long 7327232,13512704,8375808,6802944,1073741831,7457,7473,1
.long 2098688,3391488,3147264,1050112,1006632969,7938,7954,0
.long 2622976,3391488,3147264,1050112,1006632969,7970,7986,0
.long 0,0,0,0,0,0,0,0
.long 0,0,0,0,0,0,0,0
.long 0,0,0,0,0,0,0,0
.long 0,0,0,0,0,0,0,0
.long 6803200,13512704,8376064,6803200,1073741831,8577,8593,1
.long 7327488,13512704,8376064,6803200,1073741831,8609,8625,1
.long 2098944,3391488,3147520,1050368,1006632969,9090,9106,0
.long 2623232,3391488,3147520,1050368,1006632969,9122,9138,0
.long 0,0,0,0,0,0,0,0
.long 0,0,0,0,0,0,0,0
.long 0,0,0,0,0,0,0,0
.long 0,0,0,0,0,0,0,0
.long 7849984,13512704,8374272,6801408,1073741831,577,593,1
.long 8374272,13512704,8374272,6801408,1073741831,609,625,1
.long 2048,3391488,3147776,1050624,1006632969,1090,1106,0
.long 526336,3391488,3147776,1050624,1006632969,1122,1138,0
.long 0,0,0,0,0,0,0,0
.long 0,0,0,0,0,0,0,0
.long 0,0,0,0,0,0,0,0
.long 0,0,0,0,0,0,0,0
.long 7850240,13512704,8374528,6801664,1073741831,1729,1745,1
.long 8374528,13512704,8374528,6801664,1073741831,1761,1777,1
.long 2304,3391488,3148032,1050880,1006632969,2242,2258,0
.long 526592,3391488,3148032,1050880,1006632969,2274,2290,0
.long 0,0,0,0,0,0,0,0
.long 0,0,0,0,0,0,0,0
.long 0,0,0,0,0,0,0,0
.long 0,0,0,0,0,0,0,0
.long 7850496,13512704,8374784,6801920,1073741831,2881,2897,1
.long 8374784,13512704,8374784,6801920,1073741831,2913,2929,1
.long 2560,3391488,3148288,1051136,1006632969,3394,3410,0
.long 526848,3391488,3148288,1051136,1006632969,3426,3442,0
.long 0,0,0,0,0,0,0,0
.long 0,0,0,0,0,0,0,0
.long 0,0,0,0,0,0,0,0
.long 0,0,0,0,0,0,0,0
.long 7850752,13512704,8375040,6802176,1073741831,4033,4049,1
.long 8375040,13512704,8375040,6802176,1073741831,4065,4081,1
.long 2816,3391488,3148544,1051392,1006632969,4546,4562,0
.long 527104,3391488,3148544,1051392,1006632969,4578,4594,0
.long 0,0,0,0,0,0,0,0
.long 0,0,0,0,0,0,0,0
.long 0,0,0,0,0,0,0,0
.long 0,0,0,0,0,0,0,0
.long 7851008,13512704,8375296,6802432,1073741831,5185,5201,1
.long 8375296,13512704,8375296,6802432,1073741831,5217,5233,1
.long 3072,3391488,3148800,1051648,1006632969,5698,5714,0
.long 527360,3391488,3148800,1051648,1006632969,5730,5746,0
.long 0,0,0,0,0,0,0,0
.long 0,0,0,0,0,0,0,0
.long 0,0,0,0,0,0,0,0
.long 0,0,0,0,0,0,0,0
.long 7851264,13512704,8375552,6802688,1073741831,6337,6353,1
.long 8375552,13512704,8375552,6802688,1073741831,6369,6385,1
.long 3328,3391488,3149056,1051904,1006632969,6850,6866,0
.long 527616,3391488,3149056,1051904,1006632969,6882,6898,0
.long 0,0,0,0,0,0,0,0
.long 0,0,0,0,0,0,0,0
.long 0,0,0,0,0,0,0,0
.long 0,0,0,0,0,0,0,0
.long 7851520,13512704,8375808,6802944,1073741831,7489,7505,1
.long 8375808,13512704,8375808,6802944,1073741831,7521,7537,1
.long 3584,3391488,3149312,1052160,1006632969,8002,8018,0
.long 527872,3391488,3149312,1052160,1006632969,8034,8050,0
.long 0,0,0,0,0,0,0,0
.long 0,0,0,0,0,0,0,0
.long 0,0,0,0,0,0,0,0
.long 0,0,0,0,0,0,0,0
.long 7851776,13512704,8376064,6803200,1073741831,8641,8657,1
.long 8376064,13512704,8376064,6803200,1073741831,8673,8689,1
.long 3840,3391488,3149568,1052416,1006632969,9154,9170,0
.long 528128,3391488,3149568,1052416,1006632969,9186,9202,0
.long 0,0,0,0,0,0,0,0
.long 0,0,0,0,0,0,0,0
.long 0,0,0,0,0,0,0,0
.long 0,0,0,0,0,0,0,0
.long 8898560,13512704,13355008,8112128,654311445,642,658,0
.long 9422848,13512704,13355008,8112128,654311445,674,690,0
.long 0,0,0,0,0,0,0,0
.long 0,0,0,0,0,0,0,0
.long 0,0,0,0,0,0,0,0
.long 0,0,0,0,0,0,0,0
.long 0,0,0,0,0,0,0,0
.long 0,0,0,0,0,0,0,0
.long 8898816,13512704,13355264,8112384,654311445,1794,1810,0
.long 9423104,13512704,13355264,8112384,654311445,1826,1842,0
.long 0,0,0,0,0,0,0,0
.long 0,0,0,0,0,0,0,0
.long 0,0,0,0,0,0,0,0
.long 0,0,0,0,0,0,0,0
.long 0,0,0,0,0,0,0,0
.long 0,0,0,0,0,0,0,0
.long 8899072,13512704,13355520,8112640,654311445,2946,2962,0
.long 9423360,13512704,13355520,8112640,654311445,2978,2994,0
.long 0,0,0,0,0,0,0,0
.long 0,0,0,0,0,0,0,0
.long 0,0,0,0,0,0,0,0
.long 0,0,0,0,0,0,0,0
.long 0,0,0,0,0,0,0,0
.long 0,0,0,0,0,0,0,0
.long 8899328,13512704,13355776,8112896,654311445,4098,4114,0
.long 9423616,13512704,13355776,8112896,654311445,4130,4146,0
.long 0,0,0,0,0,0,0,0
.long 0,0,0,0,0,0,0,0
.long 0,0,0,0,0,0,0,0
.long 0,0,0,0,0,0,0,0
.long 0,0,0,0,0,0,0,0
.long 0,0,0,0,0,0,0,0
.long 8899584,13512704,13356032,8113152,654311445,5250,5266,0
.long 9423872,13512704,13356032,8113152,654311445,5282,5298,0
.long 0,0,0,0,0,0,0,0
.long 0,0,0,0,0,0,0,0
.long 0,0,0,0,0,0,0,0
.long 0,0,0,0,0,0,0,0
.long 0,0,0,0,0,0,0,0
.long 0,0,0,0,0,0,0,0
.long 8899840,13512704,13356288,8113408,654311445,6402,6418,0
.long 9424128,13512704,13356288,8113408,654311445,6434,6450,0
.long 0,0,0,0,0,0,0,0
.long 0,0,0,0,0,0,0,0
.long 0,0,0,0,0,0,0,0
.long 0,0,0,0,0,0,0,0
.long 0,0,0,0,0,0,0,0
.long 0,0,0,0,0,0,0,0
.long 8900096,13512704,13356544,8113664,654311445,7554,7570,0
.long 9424384,13512704,13356544,8113664,654311445,7586,7602,0
.long 0,0,0,0,0,0,0,0
.long 0,0,0,0,0,0,0,0
.long 0,0,0,0,0,0,0,0
.long 0,0,0,0,0,0,0,0
.long 0,0,0,0,0,0,0,0
.long 0,0,0,0,0,0,0,0
.long 8900352,13512704,13356800,8113920,654311445,8706,8722,0
.long 9424640,13512704,13356800,8113920,654311445,8738,8754,0
.long 0,0,0,0,0,0,0,0
.long 0,0,0,0,0,0,0,0
.long 0,0,0,0,0,0,0,0
.long 0,0,0,0,0,0,0,0
.long 0,0,0,0,0,0,0,0
.long 0,0,0,0,0,0,0,0
.long 9947136,13512704,13355008,8112128,654311445,706,722,0
.long 10471424,13512704,13355008,8112128,654311445,738,754,0
.long 0,0,0,0,0,0,0,0
.long 0,0,0,0,0,0,0,0
.long 0,0,0,0,0,0,0,0
.long 0,0,0,0,0,0,0,0
.long 0,0,0,0,0,0,0,0
.long 0,0,0,0,0,0,0,0
.long 9947392,13512704,13355264,8112384,654311445,1858,1874,0
.long 10471680,13512704,13355264,8112384,654311445,1890,1906,0
.long 0,0,0,0,0,0,0,0
.long 0,0,0,0,0,0,0,0
.long 0,0,0,0,0,0,0,0
.long 0,0,0,0,0,0,0,0
.long 0,0,0,0,0,0,0,0
.long 0,0,0,0,0,0,0,0
.long 9947648,13512704,13355520,8112640,654311445,3010,3026,0
.long 10471936,13512704,13355520,8112640,654311445,3042,3058,0
.long 0,0,0,0,0,0,0,0
.long 0,0,0,0,0,0,0,0
.long 0,0,0,0,0,0,0,0
.long 0,0,0,0,0,0,0,0
.long 0,0,0,0,0,0,0,0
.long 0,0,0,0,0,0,0,0
.long 9947904,13512704,13355776,8112896,654311445,4162,4178,0
.long 10472192,13512704,13355776,8112896,654311445,4194,4210,0
.long 0,0,0,0,0,0,0,0
.long 0,0,0,0,0,0,0,0
.long 0,0,0,0,0,0,0,0
.long 0,0,0,0,0,0,0,0
.long 0,0,0,0,0,0,0,0
.long 0,0,0,0,0,0,0,0
.long 9948160,13512704,13356032,8113152,654311445,5314,5330,0
.long 10472448,13512704,13356032,8113152,654311445,5346,5362,0
.long 0,0,0,0,0,0,0,0
.long 0,0,0,0,0,0,0,0
.long 0,0,0,0,0,0,0,0
.long 0,0,0,0,0,0,0,0
.long 0,0,0,0,0,0,0,0
.long 0,0,0,0,0,0,0,0
.long 9948416,13512704,13356288,8113408,654311445,6466,6482,0
.long 10472704,13512704,13356288,8113408,654311445,6498,6514,0
.long 0,0,0,0,0,0,0,0
.long 0,0,0,0,0,0,0,0
.long 0,0,0,0,0,0,0,0
.long 0,0,0,0,0,0,0,0
.long 0,0,0,0,0,0,0,0
.long 0,0,0,0,0,0,0,0
.long 9948672,13512704,13356544,8113664,654311445,7618,7634,0
.long 10472960,13512704,13356544,8113664,654311445,7650,7666,0
.long 0,0,0,0,0,0,0,0
.long 0,0,0,0,0,0,0,0
.long 0,0,0,0,0,0,0,0
.long 0,0,0,0,0,0,0,0
.long 0,0,0,0,0,0,0,0
.long 0,0,0,0,0,0,0,0
.long 9948928,13512704,13356800,8113920,654311445,8770,8786,0
.long 10473216,13512704,13356800,8113920,654311445,8802,8818,0
.long 0,0,0,0,0,0,0,0
.long 0,0,0,0,0,0,0,0
.long 0,0,0,0,0,0,0,0
.long 0,0,0,0,0,0,0,0
.long 0,0,0,0,0,0,0,0
.long 0,0,0,0,0,0,0,0
.long 10995712,13512704,13355008,8112128,654311445,770,786,0
.long 11520000,13512704,13355008,8112128,654311445,802,818,0
.long 0,0,0,0,0,0,0,0
.long 0,0,0,0,0,0,0,0
.long 0,0,0,0,0,0,0,0
.long 0,0,0,0,0,0,0,0
.long 0,0,0,0,0,0,0,0
.long 0,0,0,0,0,0,0,0
.long 10995968,13512704,13355264,8112384,654311445,1922,1938,0
.long 11520256,13512704,13355264,8112384,654311445,1954,1970,0
.long 0,0,0,0,0,0,0,0
.long 0,0,0,0,0,0,0,0
.long 0,0,0,0,0,0,0,0
.long 0,0,0,0,0,0,0,0
.long 0,0,0,0,0,0,0,0
.long 0,0,0,0,0,0,0,0
.long 10996224,13512704,13355520,8112640,654311445,3074,3090,0
.long 11520512,13512704,13355520,8112640,654311445,3106,3122,0
.long 0,0,0,0,0,0,0,0
.long 0,0,0,0,0,0,0,0
.long 0,0,0,0,0,0,0,0
.long 0,0,0,0,0,0,0,0
.long 0,0,0,0,0,0,0,0
.long 0,0,0,0,0,0,0,0
.long 10996480,13512704,13355776,8112896,654311445,4226,4242,0
.long 11520768,13512704,13355776,8112896,654311445,4258,4274,0
.long 0,0,0,0,0,0,0,0
.long 0,0,0,0,0,0,0,0
.long 0,0,0,0,0,0,0,0
.long 0,0,0,0,0,0,0,0
.long 0,0,0,0,0,0,0,0
.long 0,0,0,0,0,0,0,0
.long 10996736,13512704,13356032,8113152,654311445,5378,5394,0
.long 11521024,13512704,13356032,8113152,654311445,5410,5426,0
.long 0,0,0,0,0,0,0,0
.long 0,0,0,0,0,0,0,0
.long 0,0,0,0,0,0,0,0
.long 0,0,0,0,0,0,0,0
.long 0,0,0,0,0,0,0,0
.long 0,0,0,0,0,0,0,0
.long 10996992,13512704,13356288,8113408,654311445,6530,6546,0
.long 11521280,13512704,13356288,8113408,654311445,6562,6578,0
.long 0,0,0,0,0,0,0,0
.long 0,0,0,0,0,0,0,0
.long 0,0,0,0,0,0,0,0
.long 0,0,0,0,0,0,0,0
.long 0,0,0,0,0,0,0,0
.long 0,0,0,0,0,0,0,0
.long 10997248,13512704,13356544,8113664,654311445,7682,7698,0
.long 11521536,13512704,13356544,8113664,654311445,7714,7730,0
.long 0,0,0,0,0,0,0,0
.long 0,0,0,0,0,0,0,0
.long 0,0,0,0,0,0,0,0
.long 0,0,0,0,0,0,0,0
.long 0,0,0,0,0,0,0,0
.long 0,0,0,0,0,0,0,0
.long 10997504,13512704,13356800,8113920,654311445,8834,8850,0
.long 11521792,13512704,13356800,8113920,654311445,8866,8882,0
.long 0,0,0,0,0,0,0,0
.long 0,0,0,0,0,0,0,0
.long 0,0,0,0,0,0,0,0
.long 0,0,0,0,0,0,0,0
.long 0,0,0,0,0,0,0,0
.long 0,0,0,0,0,0,0,0
.long 12044288,13512704,13355008,8112128,654311445,834,850,0
.long 12568576,13512704,13355008,8112128,654311445,866,882,0
.long 0,0,0,0,0,0,0,0
.long 0,0,0,0,0,0,0,0
.long 0,0,0,0,0,0,0,0
.long 0,0,0,0,0,0,0,0
.long 0,0,0,0,0,0,0,0
.long 0,0,0,0,0,0,0,0
.long 12044544,13512704,13355264,8112384,654311445,1986,2002,0
.long 12568832,13512704,13355264,8112384,654311445,2018,2034,0
.long 0,0,0,0,0,0,0,0
.long 0,0,0,0,0,0,0,0
.long 0,0,0,0,0,0,0,0
.long 0,0,0,0,0,0,0,0
.long 0,0,0,0,0,0,0,0
.long 0,0,0,0,0,0,0,0
.long 12044800,13512704,13355520,8112640,654311445,3138,3154,0
.long 12569088,13512704,13355520,8112640,654311445,3170,3186,0
.long 0,0,0,0,0,0,0,0
.long 0,0,0,0,0,0,0,0
.long 0,0,0,0,0,0,0,0
.long 0,0,0,0,0,0,0,0
.long 0,0,0,0,0,0,0,0
.long 0,0,0,0,0,0,0,0
.long 12045056,13512704,13355776,8112896,654311445,4290,4306,0
.long 12569344,13512704,13355776,8112896,654311445,4322,4338,0
.long 0,0,0,0,0,0,0,0
.long 0,0,0,0,0,0,0,0
.long 0,0,0,0,0,0,0,0
.long 0,0,0,0,0,0,0,0
.long 0,0,0,0,0,0,0,0
.long 0,0,0,0,0,0,0,0
.long 12045312,13512704,13356032,8113152,654311445,5442,5458,0
.long 12569600,13512704,13356032,8113152,654311445,5474,5490,0
.long 0,0,0,0,0,0,0,0
.long 0,0,0,0,0,0,0,0
.long 0,0,0,0,0,0,0,0
.long 0,0,0,0,0,0,0,0
.long 0,0,0,0,0,0,0,0
.long 0,0,0,0,0,0,0,0
.long 12045568,13512704,13356288,8113408,654311445,6594,6610,0
.long 12569856,13512704,13356288,8113408,654311445,6626,6642,0
.long 0,0,0,0,0,0,0,0
.long 0,0,0,0,0,0,0,0
.long 0,0,0,0,0,0,0,0
.long 0,0,0,0,0,0,0,0
.long 0,0,0,0,0,0,0,0
.long 0,0,0,0,0,0,0,0
.long 12045824,13512704,13356544,8113664,654311445,7746,7762,0
.long 12570112,13512704,13356544,8113664,654311445,7778,7794,0
.long 0,0,0,0,0,0,0,0
.long 0,0,0,0,0,0,0,0
.long 0,0,0,0,0,0,0,0
.long 0,0,0,0,0,0,0,0
.long 0,0,0,0,0,0,0,0
.long 0,0,0,0,0,0,0,0
.long 12046080,13512704,13356800,8113920,654311445,8898,8914,0
.long 12570368,13512704,13356800,8113920,654311445,8930,8946,0
.long 0,0,0,0,0,0,0,0
.long 0,0,0,0,0,0,0,0
.long 0,0,0,0,0,0,0,0
.long 0,0,0,0,0,0,0,0
.long 0,0,0,0,0,0,0,0
.long 0,0,0,0,0,0,0,0
.long 10993664,13512704,13352960,8634368,654311443,386,402,0
.long 11517952,13512704,13352960,8634368,654311443,418,434,0
.long 0,0,0,0,0,0,0,0
.long 0,0,0,0,0,0,0,0
.long 0,0,0,0,0,0,0,0
.long 0,0,0,0,0,0,0,0
.long 0,0,0,0,0,0,0,0
.long 0,0,0,0,0,0,0,0
.long 10993920,13512704,13353216,8634624,654311443,1538,1554,0
.long 11518208,13512704,13353216,8634624,654311443,1570,1586,0
.long 0,0,0,0,0,0,0,0
.long 0,0,0,0,0,0,0,0
.long 0,0,0,0,0,0,0,0
.long 0,0,0,0,0,0,0,0
.long 0,0,0,0,0,0,0,0
.long 0,0,0,0,0,0,0,0
.long 10994176,13512704,13353472,8634880,654311443,2690,2706,0
.long 11518464,13512704,13353472,8634880,654311443,2722,2738,0
.long 0,0,0,0,0,0,0,0
.long 0,0,0,0,0,0,0,0
.long 0,0,0,0,0,0,0,0
.long 0,0,0,0,0,0,0,0
.long 0,0,0,0,0,0,0,0
.long 0,0,0,0,0,0,0,0
.long 10994432,13512704,13353728,8635136,654311443,3842,3858,0
.long 11518720,13512704,13353728,8635136,654311443,3874,3890,0
.long 0,0,0,0,0,0,0,0
.long 0,0,0,0,0,0,0,0
.long 0,0,0,0,0,0,0,0
.long 0,0,0,0,0,0,0,0
.long 0,0,0,0,0,0,0,0
.long 0,0,0,0,0,0,0,0
.long 10994688,13512704,13353984,8635392,654311443,4994,5010,0
.long 11518976,13512704,13353984,8635392,654311443,5026,5042,0
.long 0,0,0,0,0,0,0,0
.long 0,0,0,0,0,0,0,0
.long 0,0,0,0,0,0,0,0
.long 0,0,0,0,0,0,0,0
.long 0,0,0,0,0,0,0,0
.long 0,0,0,0,0,0,0,0
.long 10994944,13512704,13354240,8635648,654311443,6146,6162,0
.long 11519232,13512704,13354240,8635648,654311443,6178,6194,0
.long 0,0,0,0,0,0,0,0
.long 0,0,0,0,0,0,0,0
.long 0,0,0,0,0,0,0,0
.long 0,0,0,0,0,0,0,0
.long 0,0,0,0,0,0,0,0
.long 0,0,0,0,0,0,0,0
.long 10995200,13512704,13354496,8635904,654311443,7298,7314,0
.long 11519488,13512704,13354496,8635904,654311443,7330,7346,0
.long 0,0,0,0,0,0,0,0
.long 0,0,0,0,0,0,0,0
.long 0,0,0,0,0,0,0,0
.long 0,0,0,0,0,0,0,0
.long 0,0,0,0,0,0,0,0
.long 0,0,0,0,0,0,0,0
.long 10995456,13512704,13354752,8636160,654311443,8450,8466,0
.long 11519744,13512704,13354752,8636160,654311443,8482,8498,0
.long 0,0,0,0,0,0,0,0
.long 0,0,0,0,0,0,0,0
.long 0,0,0,0,0,0,0,0
.long 0,0,0,0,0,0,0,0
.long 0,0,0,0,0,0,0,0
.long 0,0,0,0,0,0,0,0
.long 12042240,13512704,13352960,8634368,654311443,450,466,0
.long 12566528,13512704,13352960,8634368,654311443,482,498,0
.long 0,0,0,0,0,0,0,0
.long 0,0,0,0,0,0,0,0
.long 0,0,0,0,0,0,0,0
.long 0,0,0,0,0,0,0,0
.long 0,0,0,0,0,0,0,0
.long 0,0,0,0,0,0,0,0
.long 12042496,13512704,13353216,8634624,654311443,1602,1618,0
.long 12566784,13512704,13353216,8634624,654311443,1634,1650,0
.long 0,0,0,0,0,0,0,0
.long 0,0,0,0,0,0,0,0
.long 0,0,0,0,0,0,0,0
.long 0,0,0,0,0,0,0,0
.long 0,0,0,0,0,0,0,0
.long 0,0,0,0,0,0,0,0
.long 12042752,13512704,13353472,8634880,654311443,2754,2770,0
.long 12567040,13512704,13353472,8634880,654311443,2786,2802,0
.long 0,0,0,0,0,0,0,0
.long 0,0,0,0,0,0,0,0
.long 0,0,0,0,0,0,0,0
.long 0,0,0,0,0,0,0,0
.long 0,0,0,0,0,0,0,0
.long 0,0,0,0,0,0,0,0
.long 12043008,13512704,13353728,8635136,654311443,3906,3922,0
.long 12567296,13512704,13353728,8635136,654311443,3938,3954,0
.long 0,0,0,0,0,0,0,0
.long 0,0,0,0,0,0,0,0
.long 0,0,0,0,0,0,0,0
.long 0,0,0,0,0,0,0,0
.long 0,0,0,0,0,0,0,0
.long 0,0,0,0,0,0,0,0
.long 12043264,13512704,13353984,8635392,654311443,5058,5074,0
.long 12567552,13512704,13353984,8635392,654311443,5090,5106,0
.long 0,0,0,0,0,0,0,0
.long 0,0,0,0,0,0,0,0
.long 0,0,0,0,0,0,0,0
.long 0,0,0,0,0,0,0,0
.long 0,0,0,0,0,0,0,0
.long 0,0,0,0,0,0,0,0
.long 12043520,13512704,13354240,8635648,654311443,6210,6226,0
.long 12567808,13512704,13354240,8635648,654311443,6242,6258,0
.long 0,0,0,0,0,0,0,0
.long 0,0,0,0,0,0,0,0
.long 0,0,0,0,0,0,0,0
.long 0,0,0,0,0,0,0,0
.long 0,0,0,0,0,0,0,0
.long 0,0,0,0,0,0,0,0
.long 12043776,13512704,13354496,8635904,654311443,7362,7378,0
.long 12568064,13512704,13354496,8635904,654311443,7394,7410,0
.long 0,0,0,0,0,0,0,0
.long 0,0,0,0,0,0,0,0
.long 0,0,0,0,0,0,0,0
.long 0,0,0,0,0,0,0,0
.long 0,0,0,0,0,0,0,0
.long 0,0,0,0,0,0,0,0
.long 12044032,13512704,13354752,8636160,654311443,8514,8530,0
.long 12568320,13512704,13354752,8636160,654311443,8546,8562,0
.long 0,0,0,0,0,0,0,0
.long 0,0,0,0,0,0,0,0
.long 0,0,0,0,0,0,0,0
.long 0,0,0,0,0,0,0,0
.long 0,0,0,0,0,0,0,0
.long 0,0,0,0,0,0,0,0
.long 6801408,13512704,13355008,8636416,654311443,514,530,0
.long 7325696,13512704,13355008,8636416,654311443,546,562,0
.long 0,0,0,0,0,0,0,0
.long 0,0,0,0,0,0,0,0
.long 0,0,0,0,0,0,0,0
.long 0,0,0,0,0,0,0,0
.long 0,0,0,0,0,0,0,0
.long 0,0,0,0,0,0,0,0
.long 6801664,13512704,13355264,8636672,654311443,1666,1682,0
.long 7325952,13512704,13355264,8636672,654311443,1698,1714,0
.long 0,0,0,0,0,0,0,0
.long 0,0,0,0,0,0,0,0
.long 0,0,0,0,0,0,0,0
.long 0,0,0,0,0,0,0,0
.long 0,0,0,0,0,0,0,0
.long 0,0,0,0,0,0,0,0
.long 6801920,13512704,13355520,8636928,654311443,2818,2834,0
.long 7326208,13512704,13355520,8636928,654311443,2850,2866,0
.long 0,0,0,0,0,0,0,0
.long 0,0,0,0,0,0,0,0
.long 0,0,0,0,0,0,0,0
.long 0,0,0,0,0,0,0,0
.long 0,0,0,0,0,0,0,0
.long 0,0,0,0,0,0,0,0
.long 6802176,13512704,13355776,8637184,654311443,3970,3986,0
.long 7326464,13512704,13355776,8637184,654311443,4002,4018,0
.long 0,0,0,0,0,0,0,0
.long 0,0,0,0,0,0,0,0
.long 0,0,0,0,0,0,0,0
.long 0,0,0,0,0,0,0,0
.long 0,0,0,0,0,0,0,0
.long 0,0,0,0,0,0,0,0
.long 6802432,13512704,13356032,8637440,654311443,5122,5138,0
.long 7326720,13512704,13356032,8637440,654311443,5154,5170,0
.long 0,0,0,0,0,0,0,0
.long 0,0,0,0,0,0,0,0
.long 0,0,0,0,0,0,0,0
.long 0,0,0,0,0,0,0,0
.long 0,0,0,0,0,0,0,0
.long 0,0,0,0,0,0,0,0
.long 6802688,13512704,13356288,8637696,654311443,6274,6290,0
.long 7326976,13512704,13356288,8637696,654311443,6306,6322,0
.long 0,0,0,0,0,0,0,0
.long 0,0,0,0,0,0,0,0
.long 0,0,0,0,0,0,0,0
.long 0,0,0,0,0,0,0,0
.long 0,0,0,0,0,0,0,0
.long 0,0,0,0,0,0,0,0
.long 6802944,13512704,13356544,8637952,654311443,7426,7442,0
.long 7327232,13512704,13356544,8637952,654311443,7458,7474,0
.long 0,0,0,0,0,0,0,0
.long 0,0,0,0,0,0,0,0
.long 0,0,0,0,0,0,0,0
.long 0,0,0,0,0,0,0,0
.long 0,0,0,0,0,0,0,0
.long 0,0,0,0,0,0,0,0
.long 6803200,13512704,13356800,8638208,654311443,8578,8594,0
.long 7327488,13512704,13356800,8638208,654311443,8610,8626,0
.long 0,0,0,0,0,0,0,0
.long 0,0,0,0,0,0,0,0
.long 0,0,0,0,0,0,0,0
.long 0,0,0,0,0,0,0,0
.long 0,0,0,0,0,0,0,0
.long 0,0,0,0,0,0,0,0
.long 7849984,13512704,13355008,8636416,654311443,578,594,0
.long 8374272,13512704,13355008,8636416,654311443,610,626,0
.long 0,0,0,0,0,0,0,0
.long 0,0,0,0,0,0,0,0
.long 0,0,0,0,0,0,0,0
.long 0,0,0,0,0,0,0,0
.long 0,0,0,0,0,0,0,0
.long 0,0,0,0,0,0,0,0
.long 7850240,13512704,13355264,8636672,654311443,1730,1746,0
.long 8374528,13512704,13355264,8636672,654311443,1762,1778,0
.long 0,0,0,0,0,0,0,0
.long 0,0,0,0,0,0,0,0
.long 0,0,0,0,0,0,0,0
.long 0,0,0,0,0,0,0,0
.long 0,0,0,0,0,0,0,0
.long 0,0,0,0,0,0,0,0
.long 7850496,13512704,13355520,8636928,654311443,2882,2898,0
.long 8374784,13512704,13355520,8636928,654311443,2914,2930,0
.long 0,0,0,0,0,0,0,0
.long 0,0,0,0,0,0,0,0
.long 0,0,0,0,0,0,0,0
.long 0,0,0,0,0,0,0,0
.long 0,0,0,0,0,0,0,0
.long 0,0,0,0,0,0,0,0
.long 7850752,13512704,13355776,8637184,654311443,4034,4050,0
.long 8375040,13512704,13355776,8637184,654311443,4066,4082,0
.long 0,0,0,0,0,0,0,0
.long 0,0,0,0,0,0,0,0
.long 0,0,0,0,0,0,0,0
.long 0,0,0,0,0,0,0,0
.long 0,0,0,0,0,0,0,0
.long 0,0,0,0,0,0,0,0
.long 7851008,13512704,13356032,8637440,654311443,5186,5202,0
.long 8375296,13512704,13356032,8637440,654311443,5218,5234,0
.long 0,0,0,0,0,0,0,0
.long 0,0,0,0,0,0,0,0
.long 0,0,0,0,0,0,0,0
.long 0,0,0,0,0,0,0,0
.long 0,0,0,0,0,0,0,0
.long 0,0,0,0,0,0,0,0
.long 7851264,13512704,13356288,8637696,654311443,6338,6354,0
.long 8375552,13512704,13356288,8637696,654311443,6370,6386,0
.long 0,0,0,0,0,0,0,0
.long 0,0,0,0,0,0,0,0
.long 0,0,0,0,0,0,0,0
.long 0,0,0,0,0,0,0,0
.long 0,0,0,0,0,0,0,0
.long 0,0,0,0,0,0,0,0
.long 7851520,13512704,13356544,8637952,654311443,7490,7506,0
.long 8375808,13512704,13356544,8637952,654311443,7522,7538,0
.long 0,0,0,0,0,0,0,0
.long 0,0,0,0,0,0,0,0
.long 0,0,0,0,0,0,0,0
.long 0,0,0,0,0,0,0,0
.long 0,0,0,0,0,0,0,0
.long 0,0,0,0,0,0,0,0
.long 7851776,13512704,13356800,8638208,654311443,8642,8658,0
.long 8376064,13512704,13356800,8638208,654311443,8674,8690,0
.long 0,0,0,0,0,0,0,0
.long 0,0,0,0,0,0,0,0
.long 0,0,0,0,0,0,0,0
.long 0,0,0,0,0,0,0,0
.long 0,0,0,0,0,0,0,0
.long 0,0,0,0,0,0,0,0
.long 0,0,0,0,0,0,0,0,0,0,0,0,0,0,0,0
```
